```python
import torch

def _softmax(x, axis=-1):
    return torch.softmax(x, dim=axis)

def _gelu(x):
    return torch.nn.functional.gelu(x, approximate='tanh')

def _silu(x):
    return torch.nn.functional.silu(x)

def _sigmoid(x):
    return torch.sigmoid(x)

def _layernorm(x, axis=-1, eps=1e-05):
    m = x.mean(dim=axis, keepdim=True)
    v = x.var(dim=axis, keepdim=True, unbiased=False)
    return (x - m) / torch.sqrt(v + eps)

def _scatter_add(tgt, idx, src, axis=0):
    return tgt.clone().index_add_(axis, idx, src)

def _segment_sum(src, seg, n):
    out = torch.zeros((n,) + src.shape[1:], dtype=src.dtype)
    return out.index_add_(0, seg, src)

def _pad(x, pw):
    flat = tuple((v for pair in reversed(pw) for v in pair))
    return torch.nn.functional.pad(x, flat)
kernel_name = 'recurrent_scan__memory_aug_recurrent_mem_tr__glu_gated_swiglu__prompt'

def setup_inputs():

    _w = lambda a: (lambda t: t.to(torch.bfloat16) if t.is_floating_point() else t)(torch.as_tensor(a))

    def _A_setup():
        B, S, Dm = (1, 2048, 640)
        H, Dh = (32, 128)
        M, seg = (8, 32)
        seg = min(seg, S)
        S = S // seg * seg
        return {'x': _w((lambda *s: torch.randn(*s, dtype=torch.bfloat16) * 0.1)(B, S, Dm)), 'mem0': _w((lambda *s: torch.randn(*s, dtype=torch.bfloat16) * 1.6)(B, M, Dm)), 'Wq': _w((lambda *s: torch.randn(*s, dtype=torch.bfloat16) * 0.8)(Dm, H, Dh) * Dm ** (-0.5)), 'Wk': _w((lambda *s: torch.randn(*s, dtype=torch.bfloat16) * 0.8)(Dm, H, Dh) * Dm ** (-0.5)), 'Wv': _w((lambda *s: torch.randn(*s, dtype=torch.bfloat16) * 1.6)(Dm, H, Dh) * Dm ** (-0.5)), 'Wo': _w((lambda *s: torch.randn(*s, dtype=torch.bfloat16) * 1.6)(H, Dh, Dm) * (H * Dh) ** (-0.5)), 'seg_len': seg}
    _A_in = _A_setup()

    def _B_setup():
        B, S, D, F = (1, 2048, 640, 1728)
        return {'x': _w((lambda *s: torch.randn(*s, dtype=torch.bfloat16) * 0.1)(B, S, D)), 'w1': _w((lambda *s: torch.randn(*s, dtype=torch.bfloat16) * 0.4)(D, F) * (2.0 / D) ** 0.5), 'w3': _w((lambda *s: torch.randn(*s, dtype=torch.bfloat16) * 0.4)(D, F) * (2.0 / D) ** 0.5), 'w2': _w((lambda *s: torch.randn(*s, dtype=torch.bfloat16) * 0.4)(F, D) * (2.0 / F) ** 0.5)}
    _B_in = _B_setup()
    return {'A_x': _A_in['x'], 'A_mem0': _A_in['mem0'], 'A_Wq': _A_in['Wq'], 'A_Wk': _A_in['Wk'], 'A_Wv': _A_in['Wv'], 'A_Wo': _A_in['Wo'], 'A_seg_len': _A_in['seg_len'], 'B_x': _B_in['x'], 'B_w1': _B_in['w1'], 'B_w3': _B_in['w3'], 'B_w2': _B_in['w2']}

def reference(A_x, A_mem0, A_Wq, A_Wk, A_Wv, A_Wo, A_seg_len, B_x, B_w1, B_w3, B_w2):

    def _A_ref(x, mem0, Wq, Wk, Wv, Wo, seg_len):
        B, S, Dm = x.shape
        H, Dh = (Wq.shape[1], Wq.shape[2])
        M = mem0.shape[1]
        scale = Dh ** (-0.5)
        n_seg = S // seg_len
        L = M + seg_len
        idx = torch.arange(L)
        mask = (idx[:, None] < M) | (idx[:, None] >= idx[None, :])
        mem = mem0
        outs = []
        for s in range(n_seg):
            xs = x[:, s * seg_len:(s + 1) * seg_len, :].clone()
            h = torch.concatenate([mem, xs], axis=1)
            q = torch.einsum('btd,dhe->bhte', h, Wq)
            k = torch.einsum('btd,dhe->bhte', h, Wk)
            v = torch.einsum('btd,dhe->bhte', h, Wv)
            scores = torch.einsum('bhqe,bhke->bhqk', q, k) * scale
            scores = torch.where(mask[None, None], scores, -1000000000.0)
            p = _softmax(scores, axis=-1)
            o = torch.einsum('bhqk,bhke->bhqe', p, v)
            o = torch.einsum('bhte,hed->btd', o, Wo)
            mem = o[:, :M, :].clone()
            outs.append(o[:, M:, :])
        return torch.concatenate(outs, axis=1)

    def _B_ref(x, w1, w3, w2):
        gate = torch.einsum('bsd,df->bsf', x, w1)
        up = torch.einsum('bsd,df->bsf', x, w3)
        h = _silu(gate) * up
        out = torch.einsum('bsf,fd->bsd', h, w2)
        return out
    x = A_x
    xn = _layernorm(x, axis=-1)
    s = _A_ref(xn, A_mem0, A_Wq, A_Wk, A_Wv, A_Wo, A_seg_len)
    g = _silu(_B_ref(xn, B_w1, B_w3, B_w2))
    return x + s * g
```

```asm
; @launch grid=(256,1,1) block=(256,1,1) lds=163840
.amdgcn_target "amdgcn-amd-amdhsa--gfx950"
.text
.globl recurrent_scan__memory_aug_recurrent_mem_tr__glu_gated_swiglu__prompt_kernel
.p2align 8
.type recurrent_scan__memory_aug_recurrent_mem_tr__glu_gated_swiglu__prompt_kernel,@function
recurrent_scan__memory_aug_recurrent_mem_tr__glu_gated_swiglu__prompt_kernel:
    s_cmp_ge_u32 s2, 256
    s_cbranch_scc1 L_end
    s_load_dwordx4 s[52:55], s[0:1], 16
    s_load_dwordx4 s[56:59], s[0:1], 32
    s_load_dwordx4 s[60:63], s[0:1], 96
    v_lshrrev_b32 v11, 6, v0
    v_and_b32 v0, 63, v0
    v_readfirstlane_b32 s28, v11
    s_waitcnt lgkmcnt(0)
    s_mov_b32 s4, s62
    s_mov_b32 s5, s63
    s_mov_b32 s6, 0x10000000
    s_mov_b32 s7, 0x20000
    s_mov_b32 s8, s52
    s_mov_b32 s9, s53
    s_mov_b32 s10, 0x500000
    s_mov_b32 s11, 0x20000
    s_mov_b32 s12, s54
    s_mov_b32 s13, s55
    s_mov_b32 s14, 0x500000
    s_mov_b32 s15, 0x20000
    s_mov_b32 s16, s56
    s_mov_b32 s17, s57
    s_mov_b32 s18, 0x500000
    s_mov_b32 s19, 0x20000
    s_mov_b32 s20, s58
    s_mov_b32 s21, s59
    s_mov_b32 s22, 0x500000
    s_mov_b32 s23, 0x20000
    s_mov_b32 s24, s60
    s_mov_b32 s25, s61
    s_mov_b32 s26, 0x100
    s_mov_b32 s27, 0x20000
    s_mov_b32 s74, 0
    s_getreg_b32 s52, hwreg(HW_REG_XCC_ID)
    s_and_b32 s52, s52, 7
    s_lshl_b32 s53, s52, 4
    v_mov_b32 v1, 1
    v_mov_b32 v2, s53
    v_mov_b32 v3, 31744
    v_lshlrev_b32 v5, 4, v0
    s_cmp_lg_u32 s28, 0
    s_cbranch_scc1 L_el_done
    s_mov_b64 exec, 1
    buffer_atomic_add v1, v2, s[24:27], 0 offen offset:128 sc0 sc1
    s_waitcnt vmcnt(0)
    v_readfirstlane_b32 s54, v1
    s_nop 3
    s_lshl_b32 s55, s52, 5
    s_add_u32 s55, s55, s54
    s_cmp_lt_u32 s54, 32
    s_cbranch_scc1 L_el_dec
    v_mov_b32 v1, 1
    v_mov_b32 v2, 0
    buffer_atomic_add v1, v2, s[24:27], 0 offen offset:8 sc0 sc1
    s_waitcnt vmcnt(0)
    v_readfirstlane_b32 s54, v1
    s_mov_b64 exec, 0xff
L_el_poll:
    buffer_load_dword v4, v5, s[24:27], 0 offen offset:128 sc1
    s_waitcnt vmcnt(0)
    s_mov_b32 s56, 0
    v_readlane_b32 s64, v4, 0
    v_readlane_b32 s65, v4, 1
    v_readlane_b32 s66, v4, 2
    v_readlane_b32 s67, v4, 3
    v_readlane_b32 s68, v4, 4
    v_readlane_b32 s69, v4, 5
    v_readlane_b32 s70, v4, 6
    v_readlane_b32 s71, v4, 7
    s_nop 3
    s_add_u32 s56, s56, s64
    s_add_u32 s56, s56, s65
    s_add_u32 s56, s56, s66
    s_add_u32 s56, s56, s67
    s_add_u32 s56, s56, s68
    s_add_u32 s56, s56, s69
    s_add_u32 s56, s56, s70
    s_add_u32 s56, s56, s71
    s_cmp_ge_u32 s56, 256
    s_cbranch_scc1 L_el_hole
    s_add_u32 s74, s74, 1
    s_cmp_gt_u32 s74, 60000
    s_cbranch_scc1 L_abort
    s_sleep 4
    s_branch L_el_poll
L_el_hole:
    s_min_u32 s56, s64, 32
    s_sub_u32 s57, 32, s56
    s_add_u32 s55, s56, s54
    s_add_u32 s55, s55, 0
    s_cmp_lt_u32 s54, s57
    s_cbranch_scc1 L_el_dec
    s_sub_u32 s54, s54, s57
    s_min_u32 s56, s65, 32
    s_sub_u32 s57, 32, s56
    s_add_u32 s55, s56, s54
    s_add_u32 s55, s55, 32
    s_cmp_lt_u32 s54, s57
    s_cbranch_scc1 L_el_dec
    s_sub_u32 s54, s54, s57
    s_min_u32 s56, s66, 32
    s_sub_u32 s57, 32, s56
    s_add_u32 s55, s56, s54
    s_add_u32 s55, s55, 64
    s_cmp_lt_u32 s54, s57
    s_cbranch_scc1 L_el_dec
    s_sub_u32 s54, s54, s57
    s_min_u32 s56, s67, 32
    s_sub_u32 s57, 32, s56
    s_add_u32 s55, s56, s54
    s_add_u32 s55, s55, 96
    s_cmp_lt_u32 s54, s57
    s_cbranch_scc1 L_el_dec
    s_sub_u32 s54, s54, s57
    s_min_u32 s56, s68, 32
    s_sub_u32 s57, 32, s56
    s_add_u32 s55, s56, s54
    s_add_u32 s55, s55, 128
    s_cmp_lt_u32 s54, s57
    s_cbranch_scc1 L_el_dec
    s_sub_u32 s54, s54, s57
    s_min_u32 s56, s69, 32
    s_sub_u32 s57, 32, s56
    s_add_u32 s55, s56, s54
    s_add_u32 s55, s55, 160
    s_cmp_lt_u32 s54, s57
    s_cbranch_scc1 L_el_dec
    s_sub_u32 s54, s54, s57
    s_min_u32 s56, s70, 32
    s_sub_u32 s57, 32, s56
    s_add_u32 s55, s56, s54
    s_add_u32 s55, s55, 192
    s_cmp_lt_u32 s54, s57
    s_cbranch_scc1 L_el_dec
    s_sub_u32 s54, s54, s57
    s_min_u32 s56, s71, 32
    s_sub_u32 s57, 32, s56
    s_add_u32 s55, s56, s54
    s_add_u32 s55, s55, 224
    s_cmp_lt_u32 s54, s57
    s_cbranch_scc1 L_el_dec
    s_sub_u32 s54, s54, s57
    s_branch L_abort
L_el_dec:
    s_mov_b64 exec, 1
    v_mov_b32 v1, s55
    ds_write_b32 v3, v1
    s_waitcnt lgkmcnt(0)
    s_mov_b64 exec, -1
L_el_done:
    s_barrier
    ds_read_b32 v4, v3
    s_waitcnt lgkmcnt(0)
    v_readfirstlane_b32 s55, v4
    s_nop 3
    s_barrier
    s_add_u32 s41, s4, 0x71fffff
    s_and_b32 s41, s41, 0xffe00000
    s_sub_u32 s41, s41, s4
    s_cmp_lg_u32 s55, 64
    s_cbranch_scc1 L_pr_done
    s_cmp_lg_u32 s28, 0
    s_cbranch_scc1 L_pr_bar
    s_mov_b64 exec, 1
    v_mov_b32 v12, 0
    v_mov_b32 v13, -1
    s_add_u32 s52, s41, 0xfd800
    s_add_u32 s53, s52, 8192
    s_mov_b32 s56, -1
    s_mov_b32 s57, -1
    s_memtime s[64:65]
    s_waitcnt lgkmcnt(0)
    buffer_store_dword v13, v12, s[4:7], s52 offen sc1
    s_waitcnt vmcnt(0)
    s_memtime s[66:67]
    s_waitcnt lgkmcnt(0)
    s_sub_u32 s68, s66, s64
    s_min_u32 s56, s56, s68
    s_memtime s[64:65]
    s_waitcnt lgkmcnt(0)
    buffer_store_dword v13, v12, s[4:7], s53 offen sc1
    s_waitcnt vmcnt(0)
    s_memtime s[66:67]
    s_waitcnt lgkmcnt(0)
    s_sub_u32 s68, s66, s64
    s_min_u32 s57, s57, s68
    s_memtime s[64:65]
    s_waitcnt lgkmcnt(0)
    buffer_store_dword v13, v12, s[4:7], s52 offen sc1
    s_waitcnt vmcnt(0)
    s_memtime s[66:67]
    s_waitcnt lgkmcnt(0)
    s_sub_u32 s68, s66, s64
    s_min_u32 s56, s56, s68
    s_memtime s[64:65]
    s_waitcnt lgkmcnt(0)
    buffer_store_dword v13, v12, s[4:7], s53 offen sc1
    s_waitcnt vmcnt(0)
    s_memtime s[66:67]
    s_waitcnt lgkmcnt(0)
    s_sub_u32 s68, s66, s64
    s_min_u32 s57, s57, s68
    s_memtime s[64:65]
    s_waitcnt lgkmcnt(0)
    buffer_store_dword v13, v12, s[4:7], s52 offen sc1
    s_waitcnt vmcnt(0)
    s_memtime s[66:67]
    s_waitcnt lgkmcnt(0)
    s_sub_u32 s68, s66, s64
    s_min_u32 s56, s56, s68
    s_memtime s[64:65]
    s_waitcnt lgkmcnt(0)
    buffer_store_dword v13, v12, s[4:7], s53 offen sc1
    s_waitcnt vmcnt(0)
    s_memtime s[66:67]
    s_waitcnt lgkmcnt(0)
    s_sub_u32 s68, s66, s64
    s_min_u32 s57, s57, s68
    s_memtime s[64:65]
    s_waitcnt lgkmcnt(0)
    buffer_store_dword v13, v12, s[4:7], s52 offen sc1
    s_waitcnt vmcnt(0)
    s_memtime s[66:67]
    s_waitcnt lgkmcnt(0)
    s_sub_u32 s68, s66, s64
    s_min_u32 s56, s56, s68
    s_memtime s[64:65]
    s_waitcnt lgkmcnt(0)
    buffer_store_dword v13, v12, s[4:7], s53 offen sc1
    s_waitcnt vmcnt(0)
    s_memtime s[66:67]
    s_waitcnt lgkmcnt(0)
    s_sub_u32 s68, s66, s64
    s_min_u32 s57, s57, s68
    s_cmp_lt_u32 s57, s56
    s_cselect_b32 s52, 2, 1
    v_mov_b32 v13, s52
    buffer_store_dword v13, v12, s[24:27], 0 offen offset:12 sc1
    s_mov_b64 exec, -1
L_pr_bar:
    s_barrier
L_pr_done:
    s_cmp_ge_u32 s55, 64
    s_cbranch_scc1 L_worker
    s_lshr_b32 s29, s55, 5
    s_and_b32 s30, s55, 31
    s_load_dwordx2 s[52:53], s[0:1], 8
    s_lshl_b32 s54, s28, 6
    v_add_u32 v12, s54, v0
    v_lshlrev_b32 v13, 4, v12
    v_mov_b32 v16, -1
    v_mov_b32 v17, -1
    v_mov_b32 v18, -1
    v_mov_b32 v19, -1
    v_mov_b32 v20, -1
    v_mov_b32 v21, -1
    v_mov_b32 v22, -1
    v_mov_b32 v23, -1
    v_mov_b32 v24, -1
    v_mov_b32 v25, -1
    v_mov_b32 v26, -1
    v_mov_b32 v27, -1
    s_waitcnt lgkmcnt(0)
    s_mov_b32 s56, s52
    s_mov_b32 s57, s53
    s_mov_b32 s58, 10240
    s_mov_b32 s59, 0x20000
    s_cmp_lg_u32 s30, 0
    s_cbranch_scc1 L_ti_st
    s_mul_i32 s54, s29, 640
    v_bfe_u32 v14, v12, 1, 3
    v_mul_u32_u24 v14, 1280, v14
    v_bfe_u32 v15, v12, 4, 2
    v_lshl_add_u32 v14, v15, 3, v14
    v_and_b32 v15, 1, v12
    v_lshl_add_u32 v14, v15, 2, v14
    v_lshrrev_b32 v15, 6, v12
    v_lshl_add_u32 v15, v15, 7, v14
    buffer_load_dword v28, v15, s[56:59], s54 offen offset:0
    buffer_load_dword v29, v15, s[56:59], s54 offen offset:32
    buffer_load_dword v30, v15, s[56:59], s54 offen offset:64
    buffer_load_dword v31, v15, s[56:59], s54 offen offset:96
    buffer_load_dword v36, v14, s[56:59], s54 offen offset:512
    buffer_load_dword v37, v14, s[56:59], s54 offen offset:544
    buffer_load_dword v38, v14, s[56:59], s54 offen offset:576
    buffer_load_dword v39, v14, s[56:59], s54 offen offset:608
    s_mov_b32 s52, 0x05040100
    s_mov_b32 s53, 0x07060302
    s_waitcnt vmcnt(0)
    v_perm_b32 v16, v29, v28, s52
    v_perm_b32 v17, v31, v30, s52
    v_perm_b32 v18, v29, v28, s53
    v_perm_b32 v19, v31, v30, s53
    v_min_u32 v16, -2, v16
    v_min_u32 v17, -2, v17
    v_min_u32 v18, -2, v18
    v_min_u32 v19, -2, v19
    s_cmp_lg_u32 s28, 0
    s_cbranch_scc1 L_ti_st
    v_perm_b32 v20, v37, v36, s52
    v_perm_b32 v21, v39, v38, s52
    v_perm_b32 v22, v37, v36, s53
    v_perm_b32 v23, v39, v38, s53
    v_min_u32 v20, -2, v20
    v_min_u32 v21, -2, v21
    v_min_u32 v22, -2, v22
    v_min_u32 v23, -2, v23
L_ti_st:
    s_lshl_b32 s52, s29, 19
    s_mul_i32 s53, s30, 12288
    s_add_u32 s52, s52, s53
    s_add_u32 s53, s52, 0x5800000
    buffer_store_dwordx4 v[16:19], v13, s[4:7], s53 offen sc1
    s_add_u32 s53, s52, 0x5801000
    buffer_store_dwordx4 v[20:23], v13, s[4:7], s53 offen sc1
    s_add_u32 s53, s52, 0x5802000
    buffer_store_dwordx4 v[24:27], v13, s[4:7], s53 offen sc1
    s_lshl_b32 s52, s29, 20
    s_lshl_b32 s53, s30, 15
    s_add_u32 s52, s52, s53
    s_add_u32 s52, s52, s41
    s_add_u32 s53, s52, 0
    buffer_store_dwordx4 v[16:19], v13, s[4:7], s53 offen sc1
    s_add_u32 s53, s52, 4096
    buffer_store_dwordx4 v[20:23], v13, s[4:7], s53 offen sc1
    s_add_u32 s53, s52, 8192
    buffer_store_dwordx4 v[16:19], v13, s[4:7], s53 offen sc1
    s_add_u32 s53, s52, 12288
    buffer_store_dwordx4 v[20:23], v13, s[4:7], s53 offen sc1
    s_add_u32 s53, s52, 16384
    buffer_store_dwordx4 v[24:27], v13, s[4:7], s53 offen sc1
    s_add_u32 s53, s52, 20480
    buffer_store_dwordx4 v[24:27], v13, s[4:7], s53 offen sc1
    s_add_u32 s53, s52, 24576
    buffer_store_dwordx4 v[24:27], v13, s[4:7], s53 offen sc1
    s_add_u32 s53, s52, 28672
    buffer_store_dwordx4 v[24:27], v13, s[4:7], s53 offen sc1
    v_mov_b32 v32, 0
    v_mov_b32 v33, 0
    v_mov_b32 v34, 0
    v_mov_b32 v35, 0
    s_lshl_b32 s52, s29, 18
    s_lshl_b32 s53, s30, 13
    s_add_u32 s52, s52, s53
    s_add_u32 s53, s52, 0x5a00000
    buffer_store_dwordx4 v[32:35], v13, s[4:7], s53 offen sc1
    s_add_u32 s53, s52, 0x5a01000
    buffer_store_dwordx4 v[32:35], v13, s[4:7], s53 offen sc1
    s_lshl_b32 s52, s29, 5
    s_add_u32 s52, s52, s30
    s_lshl_b32 s52, s52, 8
    s_add_u32 s52, s52, 0x5c00000
    v_lshlrev_b32 v14, 2, v0
    buffer_store_dword v32, v14, s[4:7], s52 offen sc1
    v_lshlrev_b32 v1, 4, v0
    v_and_b32 v11, 1, v0
    v_cmp_eq_u32 vcc, 1, v11
    v_mov_b32 v2, 0x4444
    v_mov_b32 v11, 0xeeee
    v_cndmask_b32 v2, v2, v11, vcc
    v_and_b32 v64, 15, v0
    v_lshrrev_b32 v65, 4, v0
    v_bfe_u32 v66, v0, 2, 2
    v_and_b32 v67, 3, v0
    v_and_b32 v68, 1, v66
    v_lshlrev_b32 v3, 4, v68
    v_lshrrev_b32 v69, 1, v65
    v_lshl_add_u32 v3, v69, 2, v3
    v_lshrrev_b32 v69, 1, v66
    v_lshl_add_u32 v3, v69, 1, v3
    v_and_b32 v69, 1, v65
    v_add_u32 v3, v3, v69
    v_lshlrev_b32 v3, 6, v3
    v_lshl_add_u32 v3, v67, 3, v3
    v_lshl_add_u32 v3, v68, 5, v3
    s_mul_i32 s52, s28, 32768
    s_add_u32 s52, s52, 32768
    v_add_u32 v3, s52, v3
    v_xor_b32 v4, 32, v3
    s_lshl_b32 s53, s28, 10
    s_add_u32 s53, s53, 26624
    v_lshlrev_b32 v5, 5, v64
    v_lshl_add_u32 v5, v65, 3, v5
    v_add_u32 v5, s53, v5
    v_lshlrev_b32 v6, 3, v0
    v_lshrrev_b32 v68, 2, v64
    v_and_b32 v69, 1, v64
    v_lshl_add_u32 v68, v68, 1, v69
    v_mul_u32_u24 v7, 320, v68
    v_lshl_add_u32 v7, v65, 3, v7
    s_lshl_b32 s53, s28, 6
    s_add_u32 s53, s53, 21504
    v_add_u32 v7, s53, v7
    v_lshrrev_b32 v68, 1, v64
    v_mul_u32_u24 v8, 320, v68
    v_lshl_add_u32 v8, v65, 5, v8
    v_lshl_add_u32 v8, v69, 4, v8
    v_add_u32 v8, 21504, v8
    v_lshlrev_b32 v9, 13, v65
    v_lshrrev_b32 v68, 3, v64
    v_lshl_add_u32 v9, v68, 12, v9
    v_and_b32 v68, 7, v64
    v_lshl_add_u32 v9, v68, 4, v9
    s_lshl_b32 s42, s28, 5
    s_add_u32 s42, s42, s30
    s_and_b32 s53, s42, 1
    s_lshl_b32 s53, s53, 3
    v_add_u32 v68, s53, v68
    v_lshrrev_b32 v10, 2, v68
    v_lshlrev_b32 v10, 8, v10
    v_bfe_u32 v69, v68, 1, 1
    v_lshl_add_u32 v10, v69, 4, v10
    v_and_b32 v69, 1, v68
    v_lshl_add_u32 v10, v69, 3, v10
    v_and_b32 v69, 1, v65
    v_lshl_add_u32 v10, v69, 5, v10
    s_bfe_u32 s53, s42, 0x20001
    s_lshl_b32 s53, s53, 6
    s_lshr_b32 s54, s42, 3
    s_lshl_b32 s54, s54, 10
    s_add_u32 s53, s53, s54
    v_add_u32 v10, s53, v10
    s_lshl_b32 s53, s29, 18
    s_add_u32 s53, s53, 0x5a00000
    s_lshl_b32 s54, s30, 7
    s_add_u32 s54, s54, s53
    s_lshl_b32 s43, s28, 15
    s_add_u32 s43, s43, s54
    s_lshl_b32 s44, s28, 2
    s_add_u32 s44, s44, s54
    s_add_u32 s44, s44, 0x20000
    s_lshl_b32 s45, s42, 12
    s_add_u32 s45, s45, s53
    s_lshl_b32 s53, s29, 19
    s_add_u32 s38, s53, 0x5800000
    s_lshl_b32 s53, s29, 20
    s_add_u32 s40, s53, s41
    s_xor_b32 s53, s53, 0x100000
    s_add_u32 s39, s53, s41
    s_lshl_b32 s53, s30, 20
    s_lshl_b32 s54, s28, 11
    s_add_u32 s53, s53, s54
    s_add_u32 s46, s53, 0x1400000
    s_add_u32 s47, s46, 8192
    s_lshr_b32 s54, s53, 1
    s_add_u32 s48, s54, 0x6000000
    s_lshl_b32 s53, s30, 19
    s_lshl_b32 s54, s28, 9
    s_add_u32 s49, s53, s54
    s_add_u32 s49, s49, 0x6001000
    s_lshl_b32 s50, s28, 11
    v_lshrrev_b32 v68, 2, v0
    v_lshlrev_b32 v70, 13, v68
    v_lshl_add_u32 v70, v67, 4, v70
    s_lshl_b32 s53, s30, 8
    s_lshl_b32 s54, s28, 6
    s_add_u32 s53, s53, s54
    v_add_u32 v70, s53, v70
    v_xor_b32 v71, 32, v70
    v_lshrrev_b32 v68, 1, v0
    v_mul_u32_u24 v73, 1280, v68
    v_and_b32 v68, 1, v0
    v_lshl_add_u32 v73, v68, 4, v73
    s_mul_i32 s53, s30, 163840
    s_mul_i32 s54, s29, 640
    s_add_u32 s53, s53, s54
    s_lshl_b32 s54, s28, 7
    s_add_u32 s54, s54, s53
    v_add_u32 v72, s54, v73
    s_lshl_b32 s54, s28, 5
    s_add_u32 s54, s54, s53
    s_add_u32 s54, s54, 512
    v_add_u32 v73, s54, v73
    v_lshrrev_b32 v68, 1, v65
    v_lshlrev_b32 v68, 4, v68
    v_lshrrev_b32 v69, 1, v66
    v_lshl_add_u32 v68, v69, 3, v68
    v_and_b32 v69, 1, v65
    v_lshl_add_u32 v68, v69, 2, v68
    v_and_b32 v69, 1, v66
    v_add_u32 v68, v68, v69
    v_lshlrev_b32 v0, 5, v68
    v_lshl_add_u32 v0, v67, 3, v0
    v_add_u32 v0, s52, v0
    s_mul_i32 s53, s29, 5
    s_sub_u32 s54, 5, s53
    s_add_u32 s64, s53, 0
    s_lshl_b32 s64, s64, 19
    s_add_u32 s65, s53, 1
    s_lshl_b32 s65, s65, 19
    s_add_u32 s66, s53, 2
    s_lshl_b32 s66, s66, 19
    s_add_u32 s67, s53, 3
    s_lshl_b32 s67, s67, 19
    s_add_u32 s68, s53, 4
    s_lshl_b32 s68, s68, 19
    s_add_u32 s69, s54, 0
    s_lshl_b32 s69, s69, 19
    s_add_u32 s70, s54, 1
    s_lshl_b32 s70, s70, 19
    s_add_u32 s71, s54, 2
    s_lshl_b32 s71, s71, 19
    s_add_u32 s72, s54, 3
    s_lshl_b32 s72, s72, 19
    s_add_u32 s73, s54, 4
    s_lshl_b32 s73, s73, 19
    v_mov_b32 v21, 0x3f80
    v_mov_b32 v22, 0x3f800000
    v_cmp_gt_u32 vcc, 4, v64
    s_nop 1
    v_cndmask_b32 v21, v22, v21, vcc
    v_cmp_gt_u32 vcc, 8, v64
    s_nop 1
    v_cndmask_b32 v21, 0, v21, vcc
    v_cmp_eq_u32 vcc, 0, v67
    s_nop 1
    v_cndmask_b32 v16, 0, v21, vcc
    v_cmp_eq_u32 vcc, 1, v67
    s_nop 1
    v_cndmask_b32 v17, 0, v21, vcc
    v_cmp_eq_u32 vcc, 2, v67
    s_nop 1
    v_cndmask_b32 v18, 0, v21, vcc
    v_cmp_eq_u32 vcc, 3, v67
    s_nop 1
    v_cndmask_b32 v19, 0, v21, vcc
    ds_write_b128 v1, v[16:19] offset:30720
    s_lshl_b32 s33, s28, 10
    s_lshl_b32 s34, s28, 8
    s_add_u32 s34, s34, 4096
    v_lshlrev_b32 v74, 2, v1
    s_lshl_b32 s54, s30, 14
    s_lshl_b32 s55, s28, 12
    s_add_u32 s55, s55, s54
    s_lshl_b32 s54, s28, 8
    s_add_u32 s54, s54, 31744
    s_add_u32 m0, s52, 0
    s_add_u32 s53, s64, 0
    buffer_load_dwordx4 v70, s[8:11], s53 offen lds
    s_add_u32 m0, s52, 1024
    s_add_u32 s53, s64, 131072
    buffer_load_dwordx4 v71, s[8:11], s53 offen lds
    s_add_u32 m0, s52, 2048
    s_add_u32 s53, s64, 262144
    buffer_load_dwordx4 v70, s[8:11], s53 offen lds
    s_add_u32 m0, s52, 3072
    s_add_u32 s53, s64, 393216
    buffer_load_dwordx4 v71, s[8:11], s53 offen lds
    s_add_u32 m0, s52, 4096
    s_add_u32 s53, s65, 0
    buffer_load_dwordx4 v70, s[8:11], s53 offen lds
    s_add_u32 m0, s52, 5120
    s_add_u32 s53, s65, 131072
    buffer_load_dwordx4 v71, s[8:11], s53 offen lds
    s_add_u32 m0, s52, 6144
    s_add_u32 s53, s65, 262144
    buffer_load_dwordx4 v70, s[8:11], s53 offen lds
    s_add_u32 m0, s52, 7168
    s_add_u32 s53, s65, 393216
    buffer_load_dwordx4 v71, s[8:11], s53 offen lds
    s_add_u32 m0, s52, 8192
    s_add_u32 s53, s66, 0
    buffer_load_dwordx4 v70, s[8:11], s53 offen lds
    s_add_u32 m0, s52, 9216
    s_add_u32 s53, s66, 131072
    buffer_load_dwordx4 v71, s[8:11], s53 offen lds
    s_add_u32 m0, s52, 10240
    s_add_u32 s53, s66, 262144
    buffer_load_dwordx4 v70, s[8:11], s53 offen lds
    s_add_u32 m0, s52, 11264
    s_add_u32 s53, s66, 393216
    buffer_load_dwordx4 v71, s[8:11], s53 offen lds
    s_add_u32 m0, s52, 12288
    s_add_u32 s53, s67, 0
    buffer_load_dwordx4 v70, s[8:11], s53 offen lds
    s_add_u32 m0, s52, 13312
    s_add_u32 s53, s67, 131072
    buffer_load_dwordx4 v71, s[8:11], s53 offen lds
    s_add_u32 m0, s52, 14336
    s_add_u32 s53, s67, 262144
    buffer_load_dwordx4 v70, s[8:11], s53 offen lds
    s_add_u32 m0, s52, 15360
    s_add_u32 s53, s67, 393216
    buffer_load_dwordx4 v71, s[8:11], s53 offen lds
    s_add_u32 m0, s52, 16384
    s_add_u32 s53, s68, 0
    buffer_load_dwordx4 v70, s[8:11], s53 offen lds
    s_add_u32 m0, s52, 17408
    s_add_u32 s53, s68, 131072
    buffer_load_dwordx4 v71, s[8:11], s53 offen lds
    s_add_u32 m0, s52, 18432
    s_add_u32 s53, s68, 262144
    buffer_load_dwordx4 v70, s[8:11], s53 offen lds
    s_add_u32 m0, s52, 19456
    s_add_u32 s53, s68, 393216
    buffer_load_dwordx4 v71, s[8:11], s53 offen lds
    s_add_u32 m0, s52, 20480
    s_add_u32 s53, s70, 0
    buffer_load_dwordx4 v70, s[8:11], s53 offen lds
    s_add_u32 m0, s52, 21504
    s_add_u32 s53, s70, 131072
    buffer_load_dwordx4 v71, s[8:11], s53 offen lds
    s_add_u32 m0, s52, 22528
    s_add_u32 s53, s70, 262144
    buffer_load_dwordx4 v70, s[8:11], s53 offen lds
    s_add_u32 m0, s52, 23552
    s_add_u32 s53, s70, 393216
    buffer_load_dwordx4 v71, s[8:11], s53 offen lds
    s_add_u32 m0, s52, 24576
    s_add_u32 s53, s71, 0
    buffer_load_dwordx4 v70, s[8:11], s53 offen lds
    s_add_u32 m0, s52, 25600
    s_add_u32 s53, s71, 131072
    buffer_load_dwordx4 v71, s[8:11], s53 offen lds
    s_add_u32 m0, s52, 26624
    s_add_u32 s53, s71, 262144
    buffer_load_dwordx4 v70, s[8:11], s53 offen lds
    s_add_u32 m0, s52, 27648
    s_add_u32 s53, s71, 393216
    buffer_load_dwordx4 v71, s[8:11], s53 offen lds
    s_add_u32 m0, s52, 28672
    s_add_u32 s53, s72, 0
    buffer_load_dwordx4 v70, s[8:11], s53 offen lds
    s_add_u32 m0, s52, 29696
    s_add_u32 s53, s72, 131072
    buffer_load_dwordx4 v71, s[8:11], s53 offen lds
    s_add_u32 m0, s52, 30720
    s_add_u32 s53, s72, 262144
    buffer_load_dwordx4 v70, s[8:11], s53 offen lds
    s_add_u32 m0, s52, 31744
    s_add_u32 s53, s72, 393216
    buffer_load_dwordx4 v71, s[8:11], s53 offen lds
    s_waitcnt vmcnt(32)
    s_barrier
    s_cmp_lg_u32 s28, 0
    s_cbranch_scc1 L_ti_done
    s_mov_b64 exec, 1
    v_mov_b32 v14, 4
    v_mov_b32 v15, 1
    buffer_atomic_add v15, v14, s[24:27], 0 offen sc1
    s_mov_b64 exec, -1
L_ti_done:
    s_waitcnt vmcnt(28)
    ds_read_b64_tr_b16 v[80:81], v3 offset:0
    ds_read_b64_tr_b16 v[82:83], v3 offset:2048
    ds_read_b64_tr_b16 v[84:85], v3 offset:512
    ds_read_b64_tr_b16 v[86:87], v3 offset:2560
    ds_read_b64_tr_b16 v[88:89], v4 offset:0
    ds_read_b64_tr_b16 v[90:91], v4 offset:2048
    ds_read_b64_tr_b16 v[92:93], v4 offset:512
    ds_read_b64_tr_b16 v[94:95], v4 offset:2560
    s_waitcnt lgkmcnt(0)
    s_add_u32 m0, s52, 0
    s_add_u32 s53, s73, 0
    buffer_load_dwordx4 v70, s[8:11], s53 offen lds
    s_add_u32 m0, s52, 1024
    s_add_u32 s53, s73, 131072
    buffer_load_dwordx4 v71, s[8:11], s53 offen lds
    s_add_u32 m0, s52, 2048
    s_add_u32 s53, s73, 262144
    buffer_load_dwordx4 v70, s[8:11], s53 offen lds
    s_add_u32 m0, s52, 3072
    s_add_u32 s53, s73, 393216
    buffer_load_dwordx4 v71, s[8:11], s53 offen lds
    s_waitcnt vmcnt(28)
    ds_read_b64_tr_b16 v[96:97], v3 offset:4096
    ds_read_b64_tr_b16 v[98:99], v3 offset:6144
    ds_read_b64_tr_b16 v[100:101], v3 offset:4608
    ds_read_b64_tr_b16 v[102:103], v3 offset:6656
    ds_read_b64_tr_b16 v[104:105], v4 offset:4096
    ds_read_b64_tr_b16 v[106:107], v4 offset:6144
    ds_read_b64_tr_b16 v[108:109], v4 offset:4608
    ds_read_b64_tr_b16 v[110:111], v4 offset:6656
    s_waitcnt lgkmcnt(0)
    s_add_u32 m0, s52, 4096
    s_add_u32 s53, s65, 0
    buffer_load_dwordx4 v70, s[12:15], s53 offen lds
    s_add_u32 m0, s52, 5120
    s_add_u32 s53, s65, 131072
    buffer_load_dwordx4 v71, s[12:15], s53 offen lds
    s_add_u32 m0, s52, 6144
    s_add_u32 s53, s65, 262144
    buffer_load_dwordx4 v70, s[12:15], s53 offen lds
    s_add_u32 m0, s52, 7168
    s_add_u32 s53, s65, 393216
    buffer_load_dwordx4 v71, s[12:15], s53 offen lds
    s_waitcnt vmcnt(28)
    ds_read_b64_tr_b16 v[112:113], v3 offset:8192
    ds_read_b64_tr_b16 v[114:115], v3 offset:10240
    ds_read_b64_tr_b16 v[116:117], v3 offset:8704
    ds_read_b64_tr_b16 v[118:119], v3 offset:10752
    ds_read_b64_tr_b16 v[120:121], v4 offset:8192
    ds_read_b64_tr_b16 v[122:123], v4 offset:10240
    ds_read_b64_tr_b16 v[124:125], v4 offset:8704
    ds_read_b64_tr_b16 v[126:127], v4 offset:10752
    s_waitcnt lgkmcnt(0)
    s_add_u32 m0, s52, 8192
    s_add_u32 s53, s67, 0
    buffer_load_dwordx4 v70, s[12:15], s53 offen lds
    s_add_u32 m0, s52, 9216
    s_add_u32 s53, s67, 131072
    buffer_load_dwordx4 v71, s[12:15], s53 offen lds
    s_add_u32 m0, s52, 10240
    s_add_u32 s53, s67, 262144
    buffer_load_dwordx4 v70, s[12:15], s53 offen lds
    s_add_u32 m0, s52, 11264
    s_add_u32 s53, s67, 393216
    buffer_load_dwordx4 v71, s[12:15], s53 offen lds
    s_waitcnt vmcnt(28)
    ds_read_b64_tr_b16 v[128:129], v3 offset:12288
    ds_read_b64_tr_b16 v[130:131], v3 offset:14336
    ds_read_b64_tr_b16 v[132:133], v3 offset:12800
    ds_read_b64_tr_b16 v[134:135], v3 offset:14848
    ds_read_b64_tr_b16 v[136:137], v4 offset:12288
    ds_read_b64_tr_b16 v[138:139], v4 offset:14336
    ds_read_b64_tr_b16 v[140:141], v4 offset:12800
    ds_read_b64_tr_b16 v[142:143], v4 offset:14848
    s_waitcnt lgkmcnt(0)
    s_add_u32 m0, s52, 12288
    s_add_u32 s53, s69, 0
    buffer_load_dwordx4 v70, s[12:15], s53 offen lds
    s_add_u32 m0, s52, 13312
    s_add_u32 s53, s69, 131072
    buffer_load_dwordx4 v71, s[12:15], s53 offen lds
    s_add_u32 m0, s52, 14336
    s_add_u32 s53, s69, 262144
    buffer_load_dwordx4 v70, s[12:15], s53 offen lds
    s_add_u32 m0, s52, 15360
    s_add_u32 s53, s69, 393216
    buffer_load_dwordx4 v71, s[12:15], s53 offen lds
    s_waitcnt vmcnt(28)
    ds_read_b64_tr_b16 v[144:145], v3 offset:16384
    ds_read_b64_tr_b16 v[146:147], v3 offset:18432
    ds_read_b64_tr_b16 v[148:149], v3 offset:16896
    ds_read_b64_tr_b16 v[150:151], v3 offset:18944
    ds_read_b64_tr_b16 v[152:153], v4 offset:16384
    ds_read_b64_tr_b16 v[154:155], v4 offset:18432
    ds_read_b64_tr_b16 v[156:157], v4 offset:16896
    ds_read_b64_tr_b16 v[158:159], v4 offset:18944
    s_waitcnt lgkmcnt(0)
    s_add_u32 m0, s52, 16384
    s_add_u32 s53, s70, 0
    buffer_load_dwordx4 v70, s[12:15], s53 offen lds
    s_add_u32 m0, s52, 17408
    s_add_u32 s53, s70, 131072
    buffer_load_dwordx4 v71, s[12:15], s53 offen lds
    s_add_u32 m0, s52, 18432
    s_add_u32 s53, s70, 262144
    buffer_load_dwordx4 v70, s[12:15], s53 offen lds
    s_add_u32 m0, s52, 19456
    s_add_u32 s53, s70, 393216
    buffer_load_dwordx4 v71, s[12:15], s53 offen lds
    s_waitcnt vmcnt(28)
    ds_read_b64_tr_b16 v[160:161], v3 offset:20480
    ds_read_b64_tr_b16 v[162:163], v3 offset:22528
    ds_read_b64_tr_b16 v[164:165], v3 offset:20992
    ds_read_b64_tr_b16 v[166:167], v3 offset:23040
    ds_read_b64_tr_b16 v[168:169], v4 offset:20480
    ds_read_b64_tr_b16 v[170:171], v4 offset:22528
    ds_read_b64_tr_b16 v[172:173], v4 offset:20992
    ds_read_b64_tr_b16 v[174:175], v4 offset:23040
    s_waitcnt lgkmcnt(0)
    s_add_u32 m0, s52, 20480
    s_add_u32 s53, s71, 0
    buffer_load_dwordx4 v70, s[12:15], s53 offen lds
    s_add_u32 m0, s52, 21504
    s_add_u32 s53, s71, 131072
    buffer_load_dwordx4 v71, s[12:15], s53 offen lds
    s_add_u32 m0, s52, 22528
    s_add_u32 s53, s71, 262144
    buffer_load_dwordx4 v70, s[12:15], s53 offen lds
    s_add_u32 m0, s52, 23552
    s_add_u32 s53, s71, 393216
    buffer_load_dwordx4 v71, s[12:15], s53 offen lds
    s_waitcnt vmcnt(28)
    ds_read_b64_tr_b16 v[176:177], v3 offset:24576
    ds_read_b64_tr_b16 v[178:179], v3 offset:26624
    ds_read_b64_tr_b16 v[180:181], v3 offset:25088
    ds_read_b64_tr_b16 v[182:183], v3 offset:27136
    ds_read_b64_tr_b16 v[184:185], v4 offset:24576
    ds_read_b64_tr_b16 v[186:187], v4 offset:26624
    ds_read_b64_tr_b16 v[188:189], v4 offset:25088
    ds_read_b64_tr_b16 v[190:191], v4 offset:27136
    s_waitcnt lgkmcnt(0)
    s_add_u32 m0, s52, 24576
    s_add_u32 s53, s72, 0
    buffer_load_dwordx4 v70, s[12:15], s53 offen lds
    s_add_u32 m0, s52, 25600
    s_add_u32 s53, s72, 131072
    buffer_load_dwordx4 v71, s[12:15], s53 offen lds
    s_add_u32 m0, s52, 26624
    s_add_u32 s53, s72, 262144
    buffer_load_dwordx4 v70, s[12:15], s53 offen lds
    s_add_u32 m0, s52, 27648
    s_add_u32 s53, s72, 393216
    buffer_load_dwordx4 v71, s[12:15], s53 offen lds
    s_waitcnt vmcnt(28)
    ds_read_b64_tr_b16 v[192:193], v3 offset:28672
    ds_read_b64_tr_b16 v[194:195], v3 offset:30720
    ds_read_b64_tr_b16 v[196:197], v3 offset:29184
    ds_read_b64_tr_b16 v[198:199], v3 offset:31232
    ds_read_b64_tr_b16 v[200:201], v4 offset:28672
    ds_read_b64_tr_b16 v[202:203], v4 offset:30720
    ds_read_b64_tr_b16 v[204:205], v4 offset:29184
    ds_read_b64_tr_b16 v[206:207], v4 offset:31232
    s_waitcnt lgkmcnt(0)
    s_add_u32 m0, s52, 28672
    s_add_u32 s53, s73, 0
    buffer_load_dwordx4 v70, s[12:15], s53 offen lds
    s_add_u32 m0, s52, 29696
    s_add_u32 s53, s73, 131072
    buffer_load_dwordx4 v71, s[12:15], s53 offen lds
    s_add_u32 m0, s52, 30720
    s_add_u32 s53, s73, 262144
    buffer_load_dwordx4 v70, s[12:15], s53 offen lds
    s_add_u32 m0, s52, 31744
    s_add_u32 s53, s73, 393216
    buffer_load_dwordx4 v71, s[12:15], s53 offen lds
    s_waitcnt vmcnt(28)
    ds_read_b64_tr_b16 v[208:209], v3 offset:0
    ds_read_b64_tr_b16 v[210:211], v3 offset:2048
    ds_read_b64_tr_b16 v[212:213], v3 offset:512
    ds_read_b64_tr_b16 v[214:215], v3 offset:2560
    ds_read_b64_tr_b16 v[216:217], v4 offset:0
    ds_read_b64_tr_b16 v[218:219], v4 offset:2048
    ds_read_b64_tr_b16 v[220:221], v4 offset:512
    ds_read_b64_tr_b16 v[222:223], v4 offset:2560
    s_waitcnt lgkmcnt(0)
    s_add_u32 m0, s52, 0
    s_add_u32 s53, s64, 0
    buffer_load_dwordx4 v70, s[16:19], s53 offen lds
    s_add_u32 m0, s52, 1024
    s_add_u32 s53, s64, 131072
    buffer_load_dwordx4 v71, s[16:19], s53 offen lds
    s_add_u32 m0, s52, 2048
    s_add_u32 s53, s64, 262144
    buffer_load_dwordx4 v70, s[16:19], s53 offen lds
    s_add_u32 m0, s52, 3072
    s_add_u32 s53, s64, 393216
    buffer_load_dwordx4 v71, s[16:19], s53 offen lds
    s_waitcnt vmcnt(28)
    ds_read_b64_tr_b16 v[224:225], v3 offset:4096
    ds_read_b64_tr_b16 v[226:227], v3 offset:6144
    ds_read_b64_tr_b16 v[228:229], v3 offset:4608
    ds_read_b64_tr_b16 v[230:231], v3 offset:6656
    ds_read_b64_tr_b16 v[232:233], v4 offset:4096
    ds_read_b64_tr_b16 v[234:235], v4 offset:6144
    ds_read_b64_tr_b16 v[236:237], v4 offset:4608
    ds_read_b64_tr_b16 v[238:239], v4 offset:6656
    s_waitcnt lgkmcnt(0)
    s_add_u32 m0, s52, 4096
    s_add_u32 s53, s66, 0
    buffer_load_dwordx4 v70, s[16:19], s53 offen lds
    s_add_u32 m0, s52, 5120
    s_add_u32 s53, s66, 131072
    buffer_load_dwordx4 v71, s[16:19], s53 offen lds
    s_add_u32 m0, s52, 6144
    s_add_u32 s53, s66, 262144
    buffer_load_dwordx4 v70, s[16:19], s53 offen lds
    s_add_u32 m0, s52, 7168
    s_add_u32 s53, s66, 393216
    buffer_load_dwordx4 v71, s[16:19], s53 offen lds
    s_waitcnt vmcnt(28)
    ds_read_b64_tr_b16 v[240:241], v3 offset:8192
    ds_read_b64_tr_b16 v[242:243], v3 offset:10240
    ds_read_b64_tr_b16 v[244:245], v3 offset:8704
    ds_read_b64_tr_b16 v[246:247], v3 offset:10752
    ds_read_b64_tr_b16 v[248:249], v4 offset:8192
    ds_read_b64_tr_b16 v[250:251], v4 offset:10240
    ds_read_b64_tr_b16 v[252:253], v4 offset:8704
    ds_read_b64_tr_b16 v[254:255], v4 offset:10752
    s_waitcnt lgkmcnt(0)
    s_add_u32 m0, s52, 8192
    s_add_u32 s53, s68, 0
    buffer_load_dwordx4 v70, s[16:19], s53 offen lds
    s_add_u32 m0, s52, 9216
    s_add_u32 s53, s68, 131072
    buffer_load_dwordx4 v71, s[16:19], s53 offen lds
    s_add_u32 m0, s52, 10240
    s_add_u32 s53, s68, 262144
    buffer_load_dwordx4 v70, s[16:19], s53 offen lds
    s_add_u32 m0, s52, 11264
    s_add_u32 s53, s68, 393216
    buffer_load_dwordx4 v71, s[16:19], s53 offen lds
    s_waitcnt vmcnt(28)
    ds_read_b64_tr_b16 a[0:1], v3 offset:12288
    ds_read_b64_tr_b16 a[2:3], v3 offset:14336
    ds_read_b64_tr_b16 a[4:5], v3 offset:12800
    ds_read_b64_tr_b16 a[6:7], v3 offset:14848
    ds_read_b64_tr_b16 a[8:9], v4 offset:12288
    ds_read_b64_tr_b16 a[10:11], v4 offset:14336
    ds_read_b64_tr_b16 a[12:13], v4 offset:12800
    ds_read_b64_tr_b16 a[14:15], v4 offset:14848
    s_waitcnt lgkmcnt(0)
    s_add_u32 m0, s52, 12288
    s_add_u32 s53, s69, 0
    buffer_load_dwordx4 v70, s[16:19], s53 offen lds
    s_add_u32 m0, s52, 13312
    s_add_u32 s53, s69, 131072
    buffer_load_dwordx4 v71, s[16:19], s53 offen lds
    s_add_u32 m0, s52, 14336
    s_add_u32 s53, s69, 262144
    buffer_load_dwordx4 v70, s[16:19], s53 offen lds
    s_add_u32 m0, s52, 15360
    s_add_u32 s53, s69, 393216
    buffer_load_dwordx4 v71, s[16:19], s53 offen lds
    s_waitcnt vmcnt(28)
    ds_read_b64_tr_b16 a[16:17], v3 offset:16384
    ds_read_b64_tr_b16 a[18:19], v3 offset:18432
    ds_read_b64_tr_b16 a[20:21], v3 offset:16896
    ds_read_b64_tr_b16 a[22:23], v3 offset:18944
    ds_read_b64_tr_b16 a[24:25], v4 offset:16384
    ds_read_b64_tr_b16 a[26:27], v4 offset:18432
    ds_read_b64_tr_b16 a[28:29], v4 offset:16896
    ds_read_b64_tr_b16 a[30:31], v4 offset:18944
    s_waitcnt lgkmcnt(0)
    s_add_u32 m0, s52, 16384
    s_add_u32 s53, s70, 0
    buffer_load_dwordx4 v70, s[16:19], s53 offen lds
    s_add_u32 m0, s52, 17408
    s_add_u32 s53, s70, 131072
    buffer_load_dwordx4 v71, s[16:19], s53 offen lds
    s_add_u32 m0, s52, 18432
    s_add_u32 s53, s70, 262144
    buffer_load_dwordx4 v70, s[16:19], s53 offen lds
    s_add_u32 m0, s52, 19456
    s_add_u32 s53, s70, 393216
    buffer_load_dwordx4 v71, s[16:19], s53 offen lds
    s_waitcnt vmcnt(28)
    ds_read_b64_tr_b16 a[32:33], v3 offset:20480
    ds_read_b64_tr_b16 a[34:35], v3 offset:22528
    ds_read_b64_tr_b16 a[36:37], v3 offset:20992
    ds_read_b64_tr_b16 a[38:39], v3 offset:23040
    ds_read_b64_tr_b16 a[40:41], v4 offset:20480
    ds_read_b64_tr_b16 a[42:43], v4 offset:22528
    ds_read_b64_tr_b16 a[44:45], v4 offset:20992
    ds_read_b64_tr_b16 a[46:47], v4 offset:23040
    s_waitcnt lgkmcnt(0)
    s_add_u32 m0, s52, 20480
    s_add_u32 s53, s71, 0
    buffer_load_dwordx4 v70, s[16:19], s53 offen lds
    s_add_u32 m0, s52, 21504
    s_add_u32 s53, s71, 131072
    buffer_load_dwordx4 v71, s[16:19], s53 offen lds
    s_add_u32 m0, s52, 22528
    s_add_u32 s53, s71, 262144
    buffer_load_dwordx4 v70, s[16:19], s53 offen lds
    s_add_u32 m0, s52, 23552
    s_add_u32 s53, s71, 393216
    buffer_load_dwordx4 v71, s[16:19], s53 offen lds
    s_waitcnt vmcnt(28)
    ds_read_b64_tr_b16 a[48:49], v3 offset:24576
    ds_read_b64_tr_b16 a[50:51], v3 offset:26624
    ds_read_b64_tr_b16 a[52:53], v3 offset:25088
    ds_read_b64_tr_b16 a[54:55], v3 offset:27136
    ds_read_b64_tr_b16 a[56:57], v4 offset:24576
    ds_read_b64_tr_b16 a[58:59], v4 offset:26624
    ds_read_b64_tr_b16 a[60:61], v4 offset:25088
    ds_read_b64_tr_b16 a[62:63], v4 offset:27136
    s_waitcnt lgkmcnt(0)
    s_add_u32 m0, s52, 24576
    s_add_u32 s53, s72, 0
    buffer_load_dwordx4 v70, s[16:19], s53 offen lds
    s_add_u32 m0, s52, 25600
    s_add_u32 s53, s72, 131072
    buffer_load_dwordx4 v71, s[16:19], s53 offen lds
    s_add_u32 m0, s52, 26624
    s_add_u32 s53, s72, 262144
    buffer_load_dwordx4 v70, s[16:19], s53 offen lds
    s_add_u32 m0, s52, 27648
    s_add_u32 s53, s72, 393216
    buffer_load_dwordx4 v71, s[16:19], s53 offen lds
    s_waitcnt vmcnt(28)
    ds_read_b64_tr_b16 a[64:65], v3 offset:28672
    ds_read_b64_tr_b16 a[66:67], v3 offset:30720
    ds_read_b64_tr_b16 a[68:69], v3 offset:29184
    ds_read_b64_tr_b16 a[70:71], v3 offset:31232
    ds_read_b64_tr_b16 a[72:73], v4 offset:28672
    ds_read_b64_tr_b16 a[74:75], v4 offset:30720
    ds_read_b64_tr_b16 a[76:77], v4 offset:29184
    ds_read_b64_tr_b16 a[78:79], v4 offset:31232
    s_waitcnt lgkmcnt(0)
    s_add_u32 m0, s52, 28672
    s_add_u32 s53, s73, 0
    buffer_load_dwordx4 v70, s[16:19], s53 offen lds
    s_add_u32 m0, s52, 29696
    s_add_u32 s53, s73, 131072
    buffer_load_dwordx4 v71, s[16:19], s53 offen lds
    s_add_u32 m0, s52, 30720
    s_add_u32 s53, s73, 262144
    buffer_load_dwordx4 v70, s[16:19], s53 offen lds
    s_add_u32 m0, s52, 31744
    s_add_u32 s53, s73, 393216
    buffer_load_dwordx4 v71, s[16:19], s53 offen lds
    s_waitcnt vmcnt(28)
    ds_read_b64_tr_b16 a[80:81], v3 offset:0
    ds_read_b64_tr_b16 a[82:83], v3 offset:2048
    ds_read_b64_tr_b16 a[84:85], v3 offset:512
    ds_read_b64_tr_b16 a[86:87], v3 offset:2560
    ds_read_b64_tr_b16 a[88:89], v4 offset:0
    ds_read_b64_tr_b16 a[90:91], v4 offset:2048
    ds_read_b64_tr_b16 a[92:93], v4 offset:512
    ds_read_b64_tr_b16 a[94:95], v4 offset:2560
    s_waitcnt lgkmcnt(0)
    s_add_u32 m0, s52, 0
    s_mov_b32 s53, 0
    buffer_load_dwordx4 v72, s[20:23], s53 offen lds
    s_add_u32 m0, s52, 1024
    s_mov_b32 s53, 40960
    buffer_load_dwordx4 v72, s[20:23], s53 offen lds
    s_add_u32 m0, s52, 2048
    s_mov_b32 s53, 81920
    buffer_load_dwordx4 v72, s[20:23], s53 offen lds
    s_add_u32 m0, s52, 3072
    s_mov_b32 s53, 122880
    buffer_load_dwordx4 v72, s[20:23], s53 offen lds
    s_waitcnt vmcnt(28)
    ds_read_b64_tr_b16 a[96:97], v3 offset:4096
    ds_read_b64_tr_b16 a[98:99], v3 offset:6144
    ds_read_b64_tr_b16 a[100:101], v3 offset:4608
    ds_read_b64_tr_b16 a[102:103], v3 offset:6656
    ds_read_b64_tr_b16 a[104:105], v4 offset:4096
    ds_read_b64_tr_b16 a[106:107], v4 offset:6144
    ds_read_b64_tr_b16 a[108:109], v4 offset:4608
    ds_read_b64_tr_b16 a[110:111], v4 offset:6656
    s_waitcnt lgkmcnt(0)
    s_add_u32 m0, s52, 4096
    s_mov_b32 s53, 32
    buffer_load_dwordx4 v72, s[20:23], s53 offen lds
    s_add_u32 m0, s52, 5120
    s_mov_b32 s53, 40992
    buffer_load_dwordx4 v72, s[20:23], s53 offen lds
    s_add_u32 m0, s52, 6144
    s_mov_b32 s53, 81952
    buffer_load_dwordx4 v72, s[20:23], s53 offen lds
    s_add_u32 m0, s52, 7168
    s_mov_b32 s53, 122912
    buffer_load_dwordx4 v72, s[20:23], s53 offen lds
    s_waitcnt vmcnt(28)
    ds_read_b64_tr_b16 a[112:113], v3 offset:8192
    ds_read_b64_tr_b16 a[114:115], v3 offset:10240
    ds_read_b64_tr_b16 a[116:117], v3 offset:8704
    ds_read_b64_tr_b16 a[118:119], v3 offset:10752
    ds_read_b64_tr_b16 a[120:121], v4 offset:8192
    ds_read_b64_tr_b16 a[122:123], v4 offset:10240
    ds_read_b64_tr_b16 a[124:125], v4 offset:8704
    ds_read_b64_tr_b16 a[126:127], v4 offset:10752
    s_waitcnt lgkmcnt(0)
    s_add_u32 m0, s52, 8192
    s_mov_b32 s53, 64
    buffer_load_dwordx4 v72, s[20:23], s53 offen lds
    s_add_u32 m0, s52, 9216
    s_mov_b32 s53, 41024
    buffer_load_dwordx4 v72, s[20:23], s53 offen lds
    s_add_u32 m0, s52, 10240
    s_mov_b32 s53, 81984
    buffer_load_dwordx4 v72, s[20:23], s53 offen lds
    s_add_u32 m0, s52, 11264
    s_mov_b32 s53, 122944
    buffer_load_dwordx4 v72, s[20:23], s53 offen lds
    s_waitcnt vmcnt(28)
    ds_read_b64_tr_b16 a[128:129], v3 offset:12288
    ds_read_b64_tr_b16 a[130:131], v3 offset:14336
    ds_read_b64_tr_b16 a[132:133], v3 offset:12800
    ds_read_b64_tr_b16 a[134:135], v3 offset:14848
    ds_read_b64_tr_b16 a[136:137], v4 offset:12288
    ds_read_b64_tr_b16 a[138:139], v4 offset:14336
    ds_read_b64_tr_b16 a[140:141], v4 offset:12800
    ds_read_b64_tr_b16 a[142:143], v4 offset:14848
    s_waitcnt lgkmcnt(0)
    s_add_u32 m0, s52, 12288
    s_add_u32 s53, s65, 0
    buffer_load_dwordx4 v70, s[16:19], s53 offen lds
    s_add_u32 m0, s52, 13312
    s_add_u32 s53, s65, 131072
    buffer_load_dwordx4 v71, s[16:19], s53 offen lds
    s_add_u32 m0, s52, 14336
    s_add_u32 s53, s65, 262144
    buffer_load_dwordx4 v70, s[16:19], s53 offen lds
    s_add_u32 m0, s52, 15360
    s_add_u32 s53, s65, 393216
    buffer_load_dwordx4 v71, s[16:19], s53 offen lds
    s_waitcnt vmcnt(28)
    ds_read_b64_tr_b16 a[144:145], v3 offset:16384
    ds_read_b64_tr_b16 a[146:147], v3 offset:18432
    ds_read_b64_tr_b16 a[148:149], v3 offset:16896
    ds_read_b64_tr_b16 a[150:151], v3 offset:18944
    ds_read_b64_tr_b16 a[152:153], v4 offset:16384
    ds_read_b64_tr_b16 a[154:155], v4 offset:18432
    ds_read_b64_tr_b16 a[156:157], v4 offset:16896
    ds_read_b64_tr_b16 a[158:159], v4 offset:18944
    s_waitcnt lgkmcnt(0)
    s_add_u32 m0, s52, 16384
    s_add_u32 s53, s67, 0
    buffer_load_dwordx4 v70, s[16:19], s53 offen lds
    s_add_u32 m0, s52, 17408
    s_add_u32 s53, s67, 131072
    buffer_load_dwordx4 v71, s[16:19], s53 offen lds
    s_add_u32 m0, s52, 18432
    s_add_u32 s53, s67, 262144
    buffer_load_dwordx4 v70, s[16:19], s53 offen lds
    s_add_u32 m0, s52, 19456
    s_add_u32 s53, s67, 393216
    buffer_load_dwordx4 v71, s[16:19], s53 offen lds
    s_waitcnt vmcnt(28)
    ds_read_b64_tr_b16 a[160:161], v3 offset:20480
    ds_read_b64_tr_b16 a[162:163], v3 offset:22528
    ds_read_b64_tr_b16 a[164:165], v3 offset:20992
    ds_read_b64_tr_b16 a[166:167], v3 offset:23040
    ds_read_b64_tr_b16 a[168:169], v4 offset:20480
    ds_read_b64_tr_b16 a[170:171], v4 offset:22528
    ds_read_b64_tr_b16 a[172:173], v4 offset:20992
    ds_read_b64_tr_b16 a[174:175], v4 offset:23040
    s_waitcnt lgkmcnt(0)
    s_add_u32 m0, s52, 20480
    s_add_u32 s53, s69, 0
    buffer_load_dwordx4 v70, s[8:11], s53 offen lds
    s_add_u32 m0, s52, 21504
    s_add_u32 s53, s69, 131072
    buffer_load_dwordx4 v71, s[8:11], s53 offen lds
    s_add_u32 m0, s52, 22528
    s_add_u32 s53, s69, 262144
    buffer_load_dwordx4 v70, s[8:11], s53 offen lds
    s_add_u32 m0, s52, 23552
    s_add_u32 s53, s69, 393216
    buffer_load_dwordx4 v71, s[8:11], s53 offen lds
    s_waitcnt vmcnt(28)
    ds_read_b64_tr_b16 a[176:177], v3 offset:24576
    ds_read_b64_tr_b16 a[178:179], v3 offset:26624
    ds_read_b64_tr_b16 a[180:181], v3 offset:25088
    ds_read_b64_tr_b16 a[182:183], v3 offset:27136
    ds_read_b64_tr_b16 a[184:185], v4 offset:24576
    ds_read_b64_tr_b16 a[186:187], v4 offset:26624
    ds_read_b64_tr_b16 a[188:189], v4 offset:25088
    ds_read_b64_tr_b16 a[190:191], v4 offset:27136
    s_waitcnt lgkmcnt(0)
    s_add_u32 m0, s52, 24576
    s_mov_b32 s53, 96
    buffer_load_dwordx4 v72, s[20:23], s53 offen lds
    s_add_u32 m0, s52, 25600
    s_mov_b32 s53, 41056
    buffer_load_dwordx4 v72, s[20:23], s53 offen lds
    s_add_u32 m0, s52, 26624
    s_mov_b32 s53, 82016
    buffer_load_dwordx4 v72, s[20:23], s53 offen lds
    s_add_u32 m0, s52, 27648
    s_mov_b32 s53, 122976
    buffer_load_dwordx4 v72, s[20:23], s53 offen lds
    s_waitcnt vmcnt(28)
    ds_read_b64_tr_b16 a[192:193], v3 offset:28672
    ds_read_b64_tr_b16 a[194:195], v3 offset:30720
    ds_read_b64_tr_b16 a[196:197], v3 offset:29184
    ds_read_b64_tr_b16 a[198:199], v3 offset:31232
    ds_read_b64_tr_b16 a[200:201], v4 offset:28672
    ds_read_b64_tr_b16 a[202:203], v4 offset:30720
    ds_read_b64_tr_b16 a[204:205], v4 offset:29184
    ds_read_b64_tr_b16 a[206:207], v4 offset:31232
    s_waitcnt lgkmcnt(0)
    s_add_u32 m0, s52, 28672
    s_mov_b32 s53, 0
    buffer_load_dwordx4 v73, s[20:23], s53 offen lds
    s_add_u32 m0, s52, 29696
    s_mov_b32 s53, 40960
    buffer_load_dwordx4 v73, s[20:23], s53 offen lds
    s_add_u32 m0, s52, 30720
    s_mov_b32 s53, 81920
    buffer_load_dwordx4 v73, s[20:23], s53 offen lds
    s_add_u32 m0, s52, 31744
    s_mov_b32 s53, 122880
    buffer_load_dwordx4 v73, s[20:23], s53 offen lds
    s_waitcnt vmcnt(28)
    ds_read_b64_tr_b16 a[208:209], v0 offset:0
    ds_read_b64_tr_b16 a[210:211], v0 offset:64
    ds_read_b64_tr_b16 a[212:213], v0 offset:1024
    ds_read_b64_tr_b16 a[214:215], v0 offset:1088
    ds_read_b64_tr_b16 a[216:217], v0 offset:2048
    ds_read_b64_tr_b16 a[218:219], v0 offset:2112
    ds_read_b64_tr_b16 a[220:221], v0 offset:3072
    ds_read_b64_tr_b16 a[222:223], v0 offset:3136
    s_waitcnt lgkmcnt(0)
    s_add_u32 m0, s52, 0
    s_add_u32 s53, s64, 0
    buffer_load_dwordx4 v70, s[12:15], s53 offen lds
    s_add_u32 m0, s52, 1024
    s_add_u32 s53, s64, 131072
    buffer_load_dwordx4 v71, s[12:15], s53 offen lds
    s_add_u32 m0, s52, 2048
    s_add_u32 s53, s64, 262144
    buffer_load_dwordx4 v70, s[12:15], s53 offen lds
    s_add_u32 m0, s52, 3072
    s_add_u32 s53, s64, 393216
    buffer_load_dwordx4 v71, s[12:15], s53 offen lds
    s_waitcnt vmcnt(28)
    ds_read_b64_tr_b16 a[224:225], v0 offset:4096
    ds_read_b64_tr_b16 a[226:227], v0 offset:4160
    ds_read_b64_tr_b16 a[228:229], v0 offset:5120
    ds_read_b64_tr_b16 a[230:231], v0 offset:5184
    ds_read_b64_tr_b16 a[232:233], v0 offset:6144
    ds_read_b64_tr_b16 a[234:235], v0 offset:6208
    ds_read_b64_tr_b16 a[236:237], v0 offset:7168
    ds_read_b64_tr_b16 a[238:239], v0 offset:7232
    s_waitcnt lgkmcnt(0)
    s_add_u32 m0, s52, 4096
    s_add_u32 s53, s66, 0
    buffer_load_dwordx4 v70, s[12:15], s53 offen lds
    s_add_u32 m0, s52, 5120
    s_add_u32 s53, s66, 131072
    buffer_load_dwordx4 v71, s[12:15], s53 offen lds
    s_add_u32 m0, s52, 6144
    s_add_u32 s53, s66, 262144
    buffer_load_dwordx4 v70, s[12:15], s53 offen lds
    s_add_u32 m0, s52, 7168
    s_add_u32 s53, s66, 393216
    buffer_load_dwordx4 v71, s[12:15], s53 offen lds
    s_waitcnt vmcnt(28)
    ds_read_b64_tr_b16 a[240:241], v0 offset:8192
    ds_read_b64_tr_b16 a[242:243], v0 offset:8256
    ds_read_b64_tr_b16 a[244:245], v0 offset:9216
    ds_read_b64_tr_b16 a[246:247], v0 offset:9280
    ds_read_b64_tr_b16 a[248:249], v0 offset:10240
    ds_read_b64_tr_b16 a[250:251], v0 offset:10304
    ds_read_b64_tr_b16 a[252:253], v0 offset:11264
    ds_read_b64_tr_b16 a[254:255], v0 offset:11328
    s_waitcnt lgkmcnt(0)
    s_add_u32 m0, s52, 8192
    s_add_u32 s53, s68, 0
    buffer_load_dwordx4 v70, s[12:15], s53 offen lds
    s_add_u32 m0, s52, 9216
    s_add_u32 s53, s68, 131072
    buffer_load_dwordx4 v71, s[12:15], s53 offen lds
    s_add_u32 m0, s52, 10240
    s_add_u32 s53, s68, 262144
    buffer_load_dwordx4 v70, s[12:15], s53 offen lds
    s_add_u32 m0, s52, 11264
    s_add_u32 s53, s68, 393216
    buffer_load_dwordx4 v71, s[12:15], s53 offen lds
    v_add_u32 v11, s52, v1
    s_waitcnt vmcnt(28)
    ds_read_b64_tr_b16 v[16:17], v3 offset:12288
    ds_read_b64_tr_b16 v[18:19], v3 offset:14336
    ds_read_b64_tr_b16 v[20:21], v3 offset:12800
    ds_read_b64_tr_b16 v[22:23], v3 offset:14848
    ds_read_b64_tr_b16 v[24:25], v4 offset:12288
    ds_read_b64_tr_b16 v[26:27], v4 offset:14336
    ds_read_b64_tr_b16 v[28:29], v4 offset:12800
    ds_read_b64_tr_b16 v[30:31], v4 offset:14848
    s_waitcnt lgkmcnt(0)
    ds_write_b128 v11, v[16:19] offset:12288
    ds_write_b128 v11, v[20:23] offset:13312
    ds_write_b128 v11, v[24:27] offset:14336
    ds_write_b128 v11, v[28:31] offset:15360
    s_waitcnt vmcnt(24)
    ds_read_b64_tr_b16 v[16:17], v3 offset:16384
    ds_read_b64_tr_b16 v[18:19], v3 offset:18432
    ds_read_b64_tr_b16 v[20:21], v3 offset:16896
    ds_read_b64_tr_b16 v[22:23], v3 offset:18944
    ds_read_b64_tr_b16 v[24:25], v4 offset:16384
    ds_read_b64_tr_b16 v[26:27], v4 offset:18432
    ds_read_b64_tr_b16 v[28:29], v4 offset:16896
    ds_read_b64_tr_b16 v[30:31], v4 offset:18944
    s_waitcnt lgkmcnt(0)
    ds_write_b128 v11, v[16:19] offset:16384
    ds_write_b128 v11, v[20:23] offset:17408
    ds_write_b128 v11, v[24:27] offset:18432
    ds_write_b128 v11, v[28:31] offset:19456
    s_waitcnt vmcnt(20)
    ds_read_b64_tr_b16 v[16:17], v3 offset:20480
    ds_read_b64_tr_b16 v[18:19], v3 offset:22528
    ds_read_b64_tr_b16 v[20:21], v3 offset:20992
    ds_read_b64_tr_b16 v[22:23], v3 offset:23040
    ds_read_b64_tr_b16 v[24:25], v4 offset:20480
    ds_read_b64_tr_b16 v[26:27], v4 offset:22528
    ds_read_b64_tr_b16 v[28:29], v4 offset:20992
    ds_read_b64_tr_b16 v[30:31], v4 offset:23040
    s_waitcnt lgkmcnt(0)
    ds_write_b128 v11, v[16:19] offset:20480
    ds_write_b128 v11, v[20:23] offset:21504
    ds_write_b128 v11, v[24:27] offset:22528
    ds_write_b128 v11, v[28:31] offset:23552
    s_waitcnt vmcnt(16)
    ds_read_b64_tr_b16 v[16:17], v0 offset:24576
    ds_read_b64_tr_b16 v[18:19], v0 offset:24640
    ds_read_b64_tr_b16 v[20:21], v0 offset:25600
    ds_read_b64_tr_b16 v[22:23], v0 offset:25664
    ds_read_b64_tr_b16 v[24:25], v0 offset:26624
    ds_read_b64_tr_b16 v[26:27], v0 offset:26688
    ds_read_b64_tr_b16 v[28:29], v0 offset:27648
    ds_read_b64_tr_b16 v[30:31], v0 offset:27712
    s_waitcnt lgkmcnt(0)
    ds_write_b128 v11, v[16:19] offset:24576
    ds_write_b128 v11, v[20:23] offset:25600
    ds_write_b128 v11, v[24:27] offset:26624
    ds_write_b128 v11, v[28:31] offset:27648
    s_waitcnt vmcnt(12)
    ds_read_b64_tr_b16 v[16:17], v0 offset:28672
    ds_read_b64_tr_b16 v[18:19], v0 offset:28736
    ds_read_b64_tr_b16 v[20:21], v0 offset:29696
    ds_read_b64_tr_b16 v[22:23], v0 offset:29760
    ds_read_b64_tr_b16 v[24:25], v0 offset:30720
    ds_read_b64_tr_b16 v[26:27], v0 offset:30784
    ds_read_b64_tr_b16 v[28:29], v0 offset:31744
    ds_read_b64_tr_b16 v[30:31], v0 offset:31808
    s_waitcnt lgkmcnt(0)
    ds_write_b128 v11, v[16:19] offset:28672
    ds_write_b128 v11, v[20:23] offset:29696
    ds_write_b128 v11, v[24:27] offset:30720
    ds_write_b128 v11, v[28:31] offset:31744
    s_waitcnt vmcnt(8)
    ds_read_b64_tr_b16 v[16:17], v3 offset:0
    ds_read_b64_tr_b16 v[18:19], v3 offset:2048
    ds_read_b64_tr_b16 v[20:21], v3 offset:512
    ds_read_b64_tr_b16 v[22:23], v3 offset:2560
    ds_read_b64_tr_b16 v[24:25], v4 offset:0
    ds_read_b64_tr_b16 v[26:27], v4 offset:2048
    ds_read_b64_tr_b16 v[28:29], v4 offset:512
    ds_read_b64_tr_b16 v[30:31], v4 offset:2560
    s_waitcnt lgkmcnt(0)
    ds_write_b128 v11, v[16:19] offset:0
    ds_write_b128 v11, v[20:23] offset:1024
    ds_write_b128 v11, v[24:27] offset:2048
    ds_write_b128 v11, v[28:31] offset:3072
    s_waitcnt vmcnt(4)
    ds_read_b64_tr_b16 v[16:17], v3 offset:4096
    ds_read_b64_tr_b16 v[18:19], v3 offset:6144
    ds_read_b64_tr_b16 v[20:21], v3 offset:4608
    ds_read_b64_tr_b16 v[22:23], v3 offset:6656
    ds_read_b64_tr_b16 v[24:25], v4 offset:4096
    ds_read_b64_tr_b16 v[26:27], v4 offset:6144
    ds_read_b64_tr_b16 v[28:29], v4 offset:4608
    ds_read_b64_tr_b16 v[30:31], v4 offset:6656
    s_waitcnt lgkmcnt(0)
    ds_write_b128 v11, v[16:19] offset:4096
    ds_write_b128 v11, v[20:23] offset:5120
    ds_write_b128 v11, v[24:27] offset:6144
    ds_write_b128 v11, v[28:31] offset:7168
    s_waitcnt vmcnt(0)
    ds_read_b64_tr_b16 v[16:17], v3 offset:8192
    ds_read_b64_tr_b16 v[18:19], v3 offset:10240
    ds_read_b64_tr_b16 v[20:21], v3 offset:8704
    ds_read_b64_tr_b16 v[22:23], v3 offset:10752
    ds_read_b64_tr_b16 v[24:25], v4 offset:8192
    ds_read_b64_tr_b16 v[26:27], v4 offset:10240
    ds_read_b64_tr_b16 v[28:29], v4 offset:8704
    ds_read_b64_tr_b16 v[30:31], v4 offset:10752
    s_waitcnt lgkmcnt(0)
    ds_write_b128 v11, v[16:19] offset:8192
    ds_write_b128 v11, v[20:23] offset:9216
    ds_write_b128 v11, v[24:27] offset:10240
    ds_write_b128 v11, v[28:31] offset:11264
    v_mov_b32 v3, v11
    v_lshrrev_b32 v0, 2, v1
    v_lshlrev_b32 v4, 2, v1
    s_mov_b32 s35, 31744
    s_lshl_b32 s37, s28, 7
    s_add_u32 s37, s37, 32000
    v_add_u32 v11, s37, v0
    v_mov_b32 v12, 0
    s_mov_b32 exec_hi, 0
    ds_write_b32 v11, v12
    s_mov_b32 exec_hi, -1
    s_mov_b32 s36, s38
    s_lshl_b32 s50, s28, 12
    s_lshl_b32 s46, s30, 20
    s_add_u32 s46, s46, s50
    s_add_u32 s46, s46, 0x1400000
    s_lshl_b32 s56, s28, 10
    s_lshl_b32 s57, s28, 9
    s_add_u32 s54, s57, 4096
    s_cmp_eq_u32 s29, 0
    s_cselect_b32 s54, s56, s54
    s_lshl_b32 s48, s30, 19
    s_add_u32 s48, s48, s54
    s_add_u32 s48, s48, 0x6000000
    s_mov_b32 s62, 0
    s_lshl_b32 s47, s28, 11
    s_add_u32 s47, s47, 8192
    s_and_b32 s60, s28, 1
    s_lshl_b32 s60, s60, 13
    s_sub_u32 s61, s60, s50
    s_lshl_b32 s63, s29, 7
    s_add_u32 s63, s63, s42
    s_xor_b32 s63, s63, 116
    s_cmp_eq_u32 s28, 2
    s_cselect_b32 s59, 59, 64
    s_cmp_eq_u32 s63, 0
    s_cmov_b32 s59, 6
    v_mov_b32 v40, 0
    v_mov_b32 v41, 0
    v_mov_b32 v42, 0
    v_mov_b32 v43, 0
    v_mov_b32 v44, 0
    v_mov_b32 v45, 0
    v_mov_b32 v46, 0
    v_mov_b32 v47, 0
    v_mov_b32 v48, 0
    v_mov_b32 v49, 0
    v_mov_b32 v50, 0
    v_mov_b32 v51, 0
    v_mov_b32 v52, 0
    v_mov_b32 v53, 0
    v_mov_b32 v54, 0
    v_mov_b32 v55, 0
    v_mov_b32 v56, 0
    v_mov_b32 v57, 0
    v_mov_b32 v58, 0
    v_mov_b32 v59, 0
    v_mov_b32 v60, 0
    v_mov_b32 v61, 0
    v_mov_b32 v62, 0
    v_mov_b32 v63, 0
    s_mov_b32 s32, 0
    s_mov_b32 s51, 0x3e0293ee
L_md_poll:
    buffer_load_dword v11, v0, s[24:27], 0 offen sc1
    s_waitcnt vmcnt(0)
    v_readlane_b32 s64, v11, 32
    v_readlane_b32 s65, v11, 36
    v_readlane_b32 s66, v11, 40
    v_readlane_b32 s67, v11, 44
    v_readlane_b32 s68, v11, 48
    v_readlane_b32 s69, v11, 52
    v_readlane_b32 s70, v11, 56
    v_readlane_b32 s71, v11, 60
    v_readlane_b32 s72, v11, 1
    v_readlane_b32 s73, v11, 3
    v_and_b32 v11, 0x3ff, v11
    v_cmp_le_u32 vcc, 128, v11
    s_nop 3
    s_lshr_b32 s49, vcc_lo, 16
    s_ff0_i32_b32 s49, s49
    s_cmp_eq_u32 s49, 16
    s_cmov_b32 s49, 18
    s_cmp_eq_u32 s73, 0
    s_cbranch_scc1 L_md_no
    s_cmp_lt_u32 s72, 64
    s_cbranch_scc1 L_md_no
    s_cmp_eq_u32 s49, 0
    s_cbranch_scc1 L_md_no
    s_mov_b32 s31, 0
    s_min_u32 s53, s64, s65
    s_cmp_ge_u32 s53, 32
    s_cbranch_scc1 L_md_ok
    s_mov_b32 s31, 1
    s_mov_b32 s53, 0
    s_add_u32 s53, s53, s64
    s_add_u32 s53, s53, s65
    s_add_u32 s53, s53, s66
    s_add_u32 s53, s53, s67
    s_add_u32 s53, s53, s68
    s_add_u32 s53, s53, s69
    s_add_u32 s53, s53, s70
    s_add_u32 s53, s53, s71
    s_cmp_ge_u32 s53, 256
    s_cbranch_scc1 L_md_ok
L_md_no:
    s_add_u32 s74, s74, 1
    s_cmp_gt_u32 s74, 60000
    s_cbranch_scc1 L_abort
    s_sleep 4
    s_branch L_md_poll
L_md_ok:
    s_lshl_b32 s58, s49, 2
    s_sub_u32 s58, s58, 5
    s_sub_u32 s73, s73, 1
    s_lshl_b32 s73, s73, 13
    s_add_u32 s39, s39, s73
    s_add_u32 s40, s40, s73
    s_waitcnt vmcnt(0)
    s_barrier
    s_mov_b32 m0, s50
    s_nop 0
    buffer_load_dwordx4 v1, s[4:7], s46 offen offset:0 sc1 lds
    buffer_load_dwordx4 v1, s[4:7], s46 offen offset:1024 sc1 lds
    buffer_load_dwordx4 v1, s[4:7], s46 offen offset:2048 sc1 lds
    buffer_load_dwordx4 v1, s[4:7], s46 offen offset:3072 sc1 lds
    s_lshl_b32 s53, s31, 1
    s_add_u32 s53, s53, s29
    s_cmp_eq_u32 s53, 1
    s_cbranch_scc1 L_loop_fast1
    s_cmp_eq_u32 s53, 2
    s_cbranch_scc1 L_loop_slow0
    s_cmp_eq_u32 s53, 3
    s_cbranch_scc1 L_loop_slow1
L_loop_fast0:
    v_add_u32 v37, s33, v1
    v_add_u32 v38, s34, v0
    s_sleep 3
    buffer_load_dwordx4 v[12:15], v37, s[4:7], s38 offen sc1
    buffer_load_dword v16, v38, s[4:7], s38 offen sc1
    s_sleep 2
    s_mov_b32 m0, s50
    buffer_load_dwordx4 v[20:23], v37, s[4:7], s38 offen sc1
    buffer_load_dword v24, v38, s[4:7], s38 offen sc1
    s_waitcnt vmcnt(2)
Lgl_1:
    v_max3_u32 v11, v12, v13, v14
    v_max3_u32 v11, v11, v15, v16
    v_cmp_eq_u32 vcc, -1, v11
    s_cbranch_vccnz Lglre_5
    ds_write_b128 v37, v[12:15] offset:16384
    ds_write_b32 v38, v16 offset:16384
Lglok_4:
    ds_read_b128 v[64:67], v3 offset:0
    ds_read_b128 v[68:71], v3 offset:1024
    ds_read_b128 v[72:75], v3 offset:2048
    ds_read_b128 v[76:79], v3 offset:3072
    s_waitcnt lgkmcnt(4)
    s_barrier
    s_waitcnt vmcnt(0)
    ds_read_b128 v[12:15], v1 offset:16384
    ds_read_b128 v[16:19], v1 offset:17408
    ds_read_b128 v[20:23], v1 offset:18432
    ds_read_b128 v[24:27], v1 offset:19456
    ds_read_b128 v[28:31], v1 offset:20480
    buffer_load_dwordx4 v[32:35], v37, s[4:7], s39 offen sc1
    buffer_load_dword v36, v38, s[4:7], s39 offen sc1
    s_waitcnt lgkmcnt(4)
    v_smfmac_f32_16x16x64_bf16 v[48:51], v[12:15], v[64:71], v2
    ds_read_b128 v[64:67], v3 offset:4096
    ds_read_b128 v[68:71], v3 offset:5120
    v_smfmac_f32_16x16x64_bf16 v[40:43], v[12:15], v[80:87], v2
    v_smfmac_f32_16x16x64_bf16 v[44:47], v[12:15], v[88:95], v2
    v_smfmac_f32_16x16x64_bf16 v[52:55], v[12:15], v[72:79], v2
    ds_read_b128 v[72:75], v3 offset:6144
    ds_read_b128 v[76:79], v3 offset:7168
    s_waitcnt lgkmcnt(7)
    v_smfmac_f32_16x16x64_bf16 v[40:43], v[16:19], v[96:103], v2
    v_smfmac_f32_16x16x64_bf16 v[48:51], v[16:19], v[224:231], v2
    v_smfmac_f32_16x16x64_bf16 v[44:47], v[16:19], v[104:111], v2
    v_smfmac_f32_16x16x64_bf16 v[52:55], v[16:19], v[232:239], v2
    s_waitcnt lgkmcnt(6)
    s_waitcnt lgkmcnt(2)
    v_smfmac_f32_16x16x64_bf16 v[48:51], v[20:23], v[64:71], v2
    ds_read_b128 v[64:67], v3 offset:8192
    ds_read_b128 v[68:71], v3 offset:9216
    v_smfmac_f32_16x16x64_bf16 v[40:43], v[20:23], v[112:119], v2
    v_smfmac_f32_16x16x64_bf16 v[44:47], v[20:23], v[120:127], v2
    s_waitcnt lgkmcnt(2)
    v_smfmac_f32_16x16x64_bf16 v[52:55], v[20:23], v[72:79], v2
    ds_read_b128 v[72:75], v3 offset:10240
    ds_read_b128 v[76:79], v3 offset:11264
    v_smfmac_f32_16x16x64_bf16 v[40:43], v[24:27], v[128:135], v2
    v_smfmac_f32_16x16x64_bf16 v[48:51], v[24:27], v[240:247], v2
    v_smfmac_f32_16x16x64_bf16 v[44:47], v[24:27], v[136:143], v2
    v_smfmac_f32_16x16x64_bf16 v[52:55], v[24:27], v[248:255], v2
    s_waitcnt lgkmcnt(2)
    v_smfmac_f32_16x16x64_bf16 v[48:51], v[28:31], v[64:71], v2
    ds_read_b128 v[64:67], v3 offset:12288
    ds_read_b128 v[68:71], v3 offset:13312
    v_smfmac_f32_16x16x64_bf16 v[40:43], v[28:31], v[144:151], v2
    v_smfmac_f32_16x16x64_bf16 v[44:47], v[28:31], v[152:159], v2
    s_waitcnt lgkmcnt(2)
    v_smfmac_f32_16x16x64_bf16 v[52:55], v[28:31], v[72:79], v2
    ds_read_b128 v[72:75], v3 offset:14336
    ds_read_b128 v[76:79], v3 offset:15360
    s_waitcnt vmcnt(0)
Lgr_6:
    v_max3_u32 v11, v32, v33, v34
    v_max3_u32 v11, v11, v35, v36
    v_cmp_eq_u32 vcc, -1, v11
    s_cbranch_vccnz Lgrre_7
    ds_write_b128 v37, v[32:35] offset:21504
    ds_write_b32 v38, v36 offset:21504
    v_smfmac_f32_16x16x64_bf16 v[56:59], v[12:15], a[80:87], v2
    s_mov_b32 m0, s35
    s_add_u32 s46, s46, 0x4000
    s_add_u32 s53, s46, 0x4000
    buffer_load_dword v4, s[4:7], s53 offen sc1 lds
    s_waitcnt lgkmcnt(4)
    v_smfmac_f32_16x16x64_bf16 v[56:59], v[16:19], v[64:71], v2
    ds_read_b128 v[64:67], v3 offset:16384
    ds_read_b128 v[68:71], v3 offset:17408
    v_smfmac_f32_16x16x64_bf16 v[60:63], v[12:15], a[88:95], v2
    s_waitcnt lgkmcnt(4)
    v_smfmac_f32_16x16x64_bf16 v[60:63], v[16:19], v[72:79], v2
    ds_read_b128 v[72:75], v3 offset:18432
    ds_read_b128 v[76:79], v3 offset:19456
    s_waitcnt lgkmcnt(4)
    s_barrier
    ds_read_b128 v[12:15], v1 offset:21504
    ds_read_b128 v[16:19], v1 offset:22528
    s_cmp_ge_u32 s32, s59
    s_cbranch_scc1 Lxt_8
Lxr_9:
    v_smfmac_f32_16x16x64_bf16 v[56:59], v[20:23], a[96:103], v2
    v_smfmac_f32_16x16x64_bf16 v[60:63], v[20:23], a[104:111], v2
    ds_read_b128 v[20:23], v1 offset:23552
    v_smfmac_f32_16x16x64_bf16 v[56:59], v[28:31], a[112:119], v2
    v_smfmac_f32_16x16x64_bf16 v[60:63], v[28:31], a[120:127], v2
    ds_read_b128 v[28:31], v1 offset:25600
    s_waitcnt lgkmcnt(6)
    v_smfmac_f32_16x16x64_bf16 v[56:59], v[24:27], v[64:71], v2
    ds_read_b128 v[64:67], v3 offset:20480
    ds_read_b128 v[68:71], v3 offset:21504
    s_waitcnt lgkmcnt(6)
    v_smfmac_f32_16x16x64_bf16 v[60:63], v[24:27], v[72:79], v2
    ds_read_b128 v[72:75], v3 offset:22528
    ds_read_b128 v[76:79], v3 offset:23552
    ds_read_b128 v[24:27], v1 offset:24576
    v_add_u32 v36, s56, v6
    ds_read_b64_tr_b16 v[32:33], v36 offset:26624
    ds_read_b64_tr_b16 v[34:35], v36 offset:27136
    s_waitcnt lgkmcnt(9)
    v_smfmac_f32_16x16x64_bf16 v[40:43], v[16:19], v[160:167], v2
    v_smfmac_f32_16x16x64_bf16 v[44:47], v[16:19], v[168:175], v2
    s_waitcnt lgkmcnt(8)
    v_smfmac_f32_16x16x64_bf16 v[40:43], v[20:23], v[176:183], v2
    v_smfmac_f32_16x16x64_bf16 v[44:47], v[20:23], v[184:191], v2
    s_waitcnt lgkmcnt(7)
    v_smfmac_f32_16x16x64_bf16 v[40:43], v[28:31], v[208:215], v2
    v_smfmac_f32_16x16x64_bf16 v[44:47], v[28:31], v[216:223], v2
    s_waitcnt lgkmcnt(0)
    buffer_store_dwordx4 v[32:35], v1, s[4:7], s48 offen sc1
    s_add_u32 s48, s48, s62
    s_mov_b32 s62, 0x2000
    v_smfmac_f32_16x16x64_bf16 v[40:43], v[12:15], v[64:71], v2
    v_smfmac_f32_16x16x64_bf16 v[44:47], v[12:15], v[72:79], v2
    v_smfmac_f32_16x16x64_bf16 v[40:43], v[24:27], v[192:199], v2
    v_smfmac_f32_16x16x64_bf16 v[44:47], v[24:27], v[200:207], v2
    v_smfmac_f32_16x16x64_bf16 v[48:51], v[12:15], a[0:7], v2
    ds_read_b128 v[64:67], v1 offset:4096
    v_smfmac_f32_16x16x64_bf16 v[52:55], v[12:15], a[8:15], v2
    ds_read_b128 v[68:71], v1 offset:5120
    v_smfmac_f32_16x16x64_bf16 v[48:51], v[16:19], a[16:23], v2
    ds_read_b128 v[72:75], v1 offset:6144
    v_smfmac_f32_16x16x64_bf16 v[52:55], v[16:19], a[24:31], v2
    ds_read_b128 v[76:79], v1 offset:7168
    v_smfmac_f32_16x16x64_bf16 v[48:51], v[20:23], a[32:39], v2
    v_smfmac_f32_16x16x64_bf16 v[52:55], v[20:23], a[40:47], v2
    v_smfmac_f32_16x16x64_bf16 v[48:51], v[24:27], a[48:55], v2
    v_add_f32 v40, v40, v41
    v_add_f32 v42, v42, v43
    v_smfmac_f32_16x16x64_bf16 v[52:55], v[24:27], a[56:63], v2
    v_add_f32 v44, v44, v45
    v_add_f32 v46, v46, v47
    v_smfmac_f32_16x16x64_bf16 v[48:51], v[28:31], a[64:71], v2
    v_cvt_pk_bf16_f32 v41, v40, v42
    v_smfmac_f32_16x16x64_bf16 v[52:55], v[28:31], a[72:79], v2
    v_cvt_pk_bf16_f32 v45, v44, v46
    v_smfmac_f32_16x16x64_bf16 v[56:59], v[12:15], a[128:135], v2
    v_smfmac_f32_16x16x64_bf16 v[60:63], v[12:15], a[136:143], v2
    v_smfmac_f32_16x16x64_bf16 v[56:59], v[16:19], a[144:151], v2
    v_smfmac_f32_16x16x64_bf16 v[60:63], v[16:19], a[152:159], v2
    s_nop 1
    v_add_f32 v48, v48, v49
    v_add_f32 v50, v50, v51
    v_cvt_pk_bf16_f32 v40, v48, v50
    ds_write_b64 v5, v[40:41] offset:0
    v_add_f32 v52, v52, v53
    v_add_f32 v54, v54, v55
    v_cvt_pk_bf16_f32 v44, v52, v54
    ds_write_b64 v5, v[44:45] offset:512
    v_smfmac_f32_16x16x64_bf16 v[56:59], v[20:23], a[160:167], v2
    v_smfmac_f32_16x16x64_bf16 v[60:63], v[20:23], a[168:175], v2
    v_smfmac_f32_16x16x64_bf16 v[56:59], v[24:27], a[176:183], v2
    v_smfmac_f32_16x16x64_bf16 v[60:63], v[24:27], a[184:191], v2
    s_waitcnt lgkmcnt(0)
    s_barrier
    ds_read_b64_tr_b16 v[12:13], v6 offset:26624
    ds_read_b64_tr_b16 v[14:15], v6 offset:27136
    ds_read_b64_tr_b16 v[16:17], v6 offset:27648
    ds_read_b64_tr_b16 v[18:19], v6 offset:28160
    v_smfmac_f32_16x16x64_bf16 v[56:59], v[28:31], a[192:199], v2
    ds_read_b64_tr_b16 v[20:21], v6 offset:28672
    ds_read_b64_tr_b16 v[22:23], v6 offset:29184
    ds_read_b64_tr_b16 v[24:25], v6 offset:29696
    ds_read_b64_tr_b16 v[26:27], v6 offset:30208
    v_smfmac_f32_16x16x64_bf16 v[60:63], v[28:31], a[200:207], v2
    ds_read_b128 v[40:43], v1 offset:0
    ds_read_b128 v[44:47], v1 offset:1024
    ds_read_b128 v[48:51], v1 offset:2048
    ds_read_b128 v[52:55], v1 offset:3072
    v_add_u32 v11, s47, v1
    ds_read_b128 v[32:35], v11
    ds_read_b128 v[36:39], v11 offset:1024
    s_waitcnt lgkmcnt(12)
    v_mfma_f32_16x16x32_bf16 v[28:31], v[64:67], v[12:15], 0
    s_waitcnt lgkmcnt(10)
    v_mfma_f32_16x16x32_bf16 v[28:31], v[68:71], v[16:19], v[28:31]
    s_waitcnt lgkmcnt(8)
    v_mfma_f32_16x16x32_bf16 v[28:31], v[72:75], v[20:23], v[28:31]
    s_waitcnt lgkmcnt(6)
    v_mfma_f32_16x16x32_bf16 v[28:31], v[76:79], v[24:27], v[28:31]
    v_mfma_f32_16x16x32_bf16 v[64:67], v[12:15], v[12:15], 0
    v_mfma_f32_16x16x32_bf16 v[64:67], v[16:19], v[16:19], v[64:67]
    v_mfma_f32_16x16x32_bf16 v[64:67], v[20:23], v[20:23], v[64:67]
    v_mfma_f32_16x16x32_bf16 v[64:67], v[24:27], v[24:27], v[64:67]
    s_waitcnt lgkmcnt(0)
    s_mov_b32 m0, s50
    s_barrier
    v_mfma_f32_16x16x32_bf16 v[68:71], v[40:43], v[12:15], 0
    v_add_f32 v56, v56, v57
    v_add_f32 v58, v58, v59
    v_mfma_f32_16x16x32_bf16 v[68:71], v[44:47], v[16:19], v[68:71]
    v_add_f32 v60, v60, v61
    v_add_f32 v62, v62, v63
    v_mfma_f32_16x16x32_bf16 v[68:71], v[48:51], v[20:23], v[68:71]
    buffer_load_dwordx4 v1, s[4:7], s46 offen offset:2048 sc1 lds
    v_cvt_pk_bf16_f32 v76, v56, v58
    v_mov_b32 v77, 0
    v_mfma_f32_16x16x32_bf16 v[68:71], v[52:55], v[24:27], v[68:71]
    buffer_load_dwordx4 v1, s[4:7], s46 offen offset:3072 sc1 lds
    v_cvt_pk_bf16_f32 v78, v60, v62
    v_mov_b32 v79, 0
    ds_read_b128 v[40:43], v3 offset:28672
    ds_read_b128 v[44:47], v3 offset:29696
    ds_read_b128 v[48:51], v3 offset:30720
    ds_read_b128 v[52:55], v3 offset:31744
    v_max3_f32 v11, v28, v29, v30
    v_max3_f32 v11, v11, v31, v64
    v_max3_f32 v11, v11, v65, v68
    v_max3_f32 v11, v11, v69, v70
    v_max_f32 v11, v11, v71
    v_mov_b32 v66, v11
    v_mov_b32 v20, 0x3f803f80
    v_mov_b32 v21, 0x3f803f80
    v_permlane16_swap_b32 v11, v66
    v_max_f32 v11, v11, v66
    v_mov_b32 v66, v11
    v_mov_b64 v[22:23], v[20:21]
    v_mov_b32 v17, 0
    v_permlane32_swap_b32 v11, v66
    v_max_f32 v11, v11, v66
    v_mul_f32 v11, s51, v11
    v_fma_f32 v64, v64, s51, -v11
    v_fma_f32 v65, v65, s51, -v11
    v_exp_f32 v64, v64
    v_fma_f32 v68, v68, s51, -v11
    v_exp_f32 v65, v65
    v_fma_f32 v69, v69, s51, -v11
    v_exp_f32 v68, v68
    v_cvt_pk_bf16_f32 v16, v64, v65
    v_fma_f32 v70, v70, s51, -v11
    v_exp_f32 v69, v69
    v_fma_f32 v71, v71, s51, -v11
    v_exp_f32 v70, v70
    v_cvt_pk_bf16_f32 v12, v68, v69
    v_mfma_f32_16x16x16_bf16 v[24:27], v[20:21], v[16:17], 0
    v_fma_f32 v28, v28, s51, -v11
    v_exp_f32 v71, v71
    v_mfma_f32_16x16x16_bf16 v[56:59], v[76:77], v[16:17], 0
    v_fma_f32 v29, v29, s51, -v11
    v_exp_f32 v28, v28
    v_cvt_pk_bf16_f32 v13, v70, v71
    v_mfma_f32_16x16x16_bf16 v[60:63], v[78:79], v[16:17], 0
    v_fma_f32 v30, v30, s51, -v11
    v_exp_f32 v29, v29
    v_fma_f32 v31, v31, s51, -v11
    v_exp_f32 v30, v30
    v_exp_f32 v31, v31
    v_cvt_pk_bf16_f32 v14, v28, v29
    v_cvt_pk_bf16_f32 v15, v30, v31
    s_nop 1
    v_mfma_f32_16x16x32_bf16 v[24:27], v[20:23], v[12:15], v[24:27]
    v_mfma_f32_16x16x32_bf16 v[56:59], v[32:35], v[12:15], v[56:59]
    v_mfma_f32_16x16x32_bf16 v[60:63], v[36:39], v[12:15], v[60:63]
    v_mov_b64 v[12:13], 0
    v_mov_b64 v[14:15], 0
    v_mov_b64 v[16:17], 0
    v_mov_b64 v[18:19], 0
    v_mov_b64 v[20:21], 0
    v_mov_b64 v[22:23], 0
    v_rcp_f32 v11, v24
    s_mov_b32 exec_lo, 0xcccccccc
    s_mov_b32 exec_hi, 0xcccccccc
    v_mul_f32 v56, v56, v11
    v_mul_f32 v57, v57, v11
    v_mul_f32 v58, v58, v11
    v_mul_f32 v59, v59, v11
    v_cvt_pk_bf16_f32 v56, v56, v57
    v_cvt_pk_bf16_f32 v57, v58, v59
    ds_write_b64 v7, v[56:57] offset:0
    v_mul_f32 v60, v60, v11
    v_mul_f32 v61, v61, v11
    v_mul_f32 v62, v62, v11
    v_mul_f32 v63, v63, v11
    v_cvt_pk_bf16_f32 v60, v60, v61
    v_cvt_pk_bf16_f32 v61, v62, v63
    ds_write_b64 v7, v[60:61] offset:32
    s_mov_b64 exec, -1
    ds_read_b128 v[32:35], v3 offset:24576
    ds_read_b128 v[36:39], v3 offset:25600
    ds_read_b128 v[64:67], v3 offset:26624
    ds_read_b128 v[68:71], v3 offset:27648
    v_mov_b64 v[24:25], 0
    v_mov_b64 v[26:27], 0
    v_mov_b64 v[28:29], 0
    v_mov_b64 v[30:31], 0
    buffer_load_dwordx4 v1, s[4:7], s46 offen offset:0 sc1 lds
    buffer_load_dwordx4 v1, s[4:7], s46 offen offset:1024 sc1 lds
    s_waitcnt lgkmcnt(4)
    s_barrier
    ds_read_b128 v[56:59], v8 offset:0
    ds_read_b128 v[60:63], v8 offset:128
    s_waitcnt lgkmcnt(1)
    v_smfmac_f32_16x16x64_bf16 v[28:31], v[56:59], v[40:47], v2
    s_waitcnt lgkmcnt(0)
    v_smfmac_f32_16x16x64_bf16 v[28:31], v[60:63], v[48:55], v2
    v_smfmac_f32_16x16x64_bf16 v[12:15], v[56:59], a[208:215], v2
    v_smfmac_f32_16x16x64_bf16 v[12:15], v[60:63], a[216:223], v2
    v_smfmac_f32_16x16x64_bf16 v[16:19], v[56:59], a[224:231], v2
    v_smfmac_f32_16x16x64_bf16 v[16:19], v[60:63], a[232:239], v2
    v_smfmac_f32_16x16x64_bf16 v[20:23], v[56:59], a[240:247], v2
    v_smfmac_f32_16x16x64_bf16 v[20:23], v[60:63], a[248:255], v2
    s_nop 1
    v_add_f32 v28, v28, v29
    v_add_f32 v30, v30, v31
    v_smfmac_f32_16x16x64_bf16 v[24:27], v[56:59], v[32:39], v2
    v_cvt_pk_bf16_f32 v44, v28, v30
    v_or_b32 v44, 1, v44
    v_smfmac_f32_16x16x64_bf16 v[24:27], v[60:63], v[64:71], v2
    buffer_store_dword v44, v9, s[4:7], s44 offen
    v_add_f32 v12, v12, v13
    v_add_f32 v14, v14, v15
    v_cvt_pk_bf16_f32 v40, v12, v14
    v_or_b32 v40, 1, v40
    v_add_f32 v16, v16, v17
    v_add_f32 v18, v18, v19
    v_cvt_pk_bf16_f32 v41, v16, v18
    v_or_b32 v41, 1, v41
    v_add_f32 v20, v20, v21
    v_add_f32 v22, v22, v23
    v_cvt_pk_bf16_f32 v42, v20, v22
    v_or_b32 v42, 1, v42
    v_add_f32 v24, v24, v25
    v_add_f32 v26, v26, v27
    v_cvt_pk_bf16_f32 v43, v24, v26
    v_or_b32 v43, 1, v43
    buffer_store_dwordx4 v[40:43], v9, s[4:7], s43 offen
    s_add_u32 s53, s32, 1
    s_and_b32 s53, s53, 3
    s_lshl_b32 s53, s53, 13
    s_add_u32 s38, s36, s53
    s_xor_b32 s53, s53, 0x4000
    s_add_u32 s55, s36, s53
    s_add_u32 s39, s39, 16384
    s_add_u32 s40, s40, 16384
    ds_read_b128 v[28:31], v1 offset:30720
    v_mov_b64 v[40:41], 0
    v_mov_b64 v[42:43], 0
    v_mov_b64 v[44:45], 0
    v_mov_b64 v[46:47], 0
    v_mov_b64 v[48:49], 0
    v_mov_b64 v[50:51], 0
    v_mov_b64 v[52:53], 0
    v_mov_b64 v[54:55], 0
    v_mov_b64 v[56:57], 0
    v_mov_b64 v[58:59], 0
    v_mov_b64 v[60:61], 0
    v_mov_b64 v[62:63], 0
    s_cmp_ge_u32 s42, 40
    s_cbranch_scc1 Lnored_12
    s_sleep 4
    buffer_load_dwordx4 v[64:67], v1, s[4:7], s45 offen offset:0 sc1
    buffer_load_dwordx4 v[68:71], v1, s[4:7], s45 offen offset:1024 sc1
    buffer_load_dwordx4 v[72:75], v1, s[4:7], s45 offen offset:2048 sc1
    buffer_load_dwordx4 v[76:79], v1, s[4:7], s45 offen offset:3072 sc1
    s_sleep 2
    buffer_load_dwordx4 v[12:15], v1, s[4:7], s45 offen offset:0 sc1
    buffer_load_dwordx4 v[16:19], v1, s[4:7], s45 offen offset:1024 sc1
    buffer_load_dwordx4 v[20:23], v1, s[4:7], s45 offen offset:2048 sc1
    buffer_load_dwordx4 v[24:27], v1, s[4:7], s45 offen offset:3072 sc1
    s_waitcnt lgkmcnt(0)
Lrd_14:
    v_mov_b32 v11, 1
    s_waitcnt vmcnt(7)
    v_mfma_f32_16x16x32_bf16 v[32:35], v[28:31], v[64:67], 0
    v_bitop3_b32 v11, v11, v64, v65 bitop3:0x80
    v_bitop3_b32 v11, v11, v66, v67 bitop3:0x80
    s_waitcnt vmcnt(6)
    v_mfma_f32_16x16x32_bf16 v[32:35], v[28:31], v[68:71], v[32:35]
    v_bitop3_b32 v11, v11, v68, v69 bitop3:0x80
    v_bitop3_b32 v11, v11, v70, v71 bitop3:0x80
    s_waitcnt vmcnt(5)
    v_mfma_f32_16x16x32_bf16 v[32:35], v[28:31], v[72:75], v[32:35]
    v_bitop3_b32 v11, v11, v72, v73 bitop3:0x80
    v_bitop3_b32 v11, v11, v74, v75 bitop3:0x80
    s_waitcnt vmcnt(4)
    v_mfma_f32_16x16x32_bf16 v[32:35], v[28:31], v[76:79], v[32:35]
    v_bitop3_b32 v11, v11, v76, v77 bitop3:0x80
    v_bitop3_b32 v11, v11, v78, v79 bitop3:0x80
    v_and_b32 v11, 1, v11
    v_cmp_ne_u32 vcc, 1, v11
    s_cbranch_vccnz Lrd2_16
Lrdok_15:
    s_nop 2
    v_add_f32_dpp v36, v32, v32 row_ror:8 row_mask:0xf bank_mask:0xf
    v_add_f32_dpp v37, v33, v33 row_ror:8 row_mask:0xf bank_mask:0xf
    v_add_f32_dpp v38, v34, v34 row_ror:8 row_mask:0xf bank_mask:0xf
    v_add_f32_dpp v39, v35, v35 row_ror:8 row_mask:0xf bank_mask:0xf
    s_mov_b32 exec_lo, 0x00ff00ff
    s_mov_b32 exec_hi, 0
    v_cvt_pk_bf16_f32 v32, v36, v37
    v_cvt_pk_bf16_f32 v33, v38, v39
    v_min_u32 v32, -2, v32
    v_min_u32 v33, -2, v33
    buffer_store_dwordx2 v[32:33], v10, s[4:7], s38 offen
    buffer_store_dwordx2 v[32:33], v10, s[4:7], s40 offen sc1
    v_mov_b64 v[34:35], -1
    buffer_store_dwordx2 v[34:35], v10, s[4:7], s55 offen
    s_mov_b64 exec, -1
Ljoin_13:
    s_barrier
    s_add_u32 s32, s32, 1
    v_add_u32 v37, s33, v1
    v_add_u32 v38, s34, v0
    s_sleep 3
    buffer_load_dwordx4 v[12:15], v37, s[4:7], s38 offen sc1
    buffer_load_dword v16, v38, s[4:7], s38 offen sc1
    s_sleep 2
    s_mov_b32 m0, s50
    buffer_load_dwordx4 v[20:23], v37, s[4:7], s38 offen sc1
    buffer_load_dword v24, v38, s[4:7], s38 offen sc1
    s_waitcnt vmcnt(2)
Lgl_17:
    v_max3_u32 v11, v12, v13, v14
    v_max3_u32 v11, v11, v15, v16
    v_cmp_eq_u32 vcc, -1, v11
    s_cbranch_vccnz Lglre_21
    ds_write_b128 v37, v[12:15] offset:16384
    ds_write_b32 v38, v16 offset:16384
Lglok_20:
    ds_read_b128 v[64:67], v3 offset:0
    ds_read_b128 v[68:71], v3 offset:1024
    ds_read_b128 v[72:75], v3 offset:2048
    ds_read_b128 v[76:79], v3 offset:3072
    s_waitcnt lgkmcnt(4)
    s_barrier
    s_waitcnt vmcnt(0)
    ds_read_b128 v[12:15], v1 offset:16384
    ds_read_b128 v[16:19], v1 offset:17408
    ds_read_b128 v[20:23], v1 offset:18432
    ds_read_b128 v[24:27], v1 offset:19456
    ds_read_b128 v[28:31], v1 offset:20480
    buffer_load_dwordx4 v[32:35], v37, s[4:7], s39 offen sc1
    buffer_load_dword v36, v38, s[4:7], s39 offen sc1
    s_waitcnt lgkmcnt(4)
    v_smfmac_f32_16x16x64_bf16 v[48:51], v[12:15], v[64:71], v2
    ds_read_b128 v[64:67], v3 offset:4096
    ds_read_b128 v[68:71], v3 offset:5120
    v_smfmac_f32_16x16x64_bf16 v[40:43], v[12:15], v[80:87], v2
    v_smfmac_f32_16x16x64_bf16 v[44:47], v[12:15], v[88:95], v2
    v_smfmac_f32_16x16x64_bf16 v[52:55], v[12:15], v[72:79], v2
    ds_read_b128 v[72:75], v3 offset:6144
    ds_read_b128 v[76:79], v3 offset:7168
    s_waitcnt lgkmcnt(7)
    v_smfmac_f32_16x16x64_bf16 v[40:43], v[16:19], v[96:103], v2
    v_smfmac_f32_16x16x64_bf16 v[48:51], v[16:19], v[224:231], v2
    v_smfmac_f32_16x16x64_bf16 v[44:47], v[16:19], v[104:111], v2
    v_smfmac_f32_16x16x64_bf16 v[52:55], v[16:19], v[232:239], v2
    s_waitcnt lgkmcnt(6)
    s_waitcnt lgkmcnt(2)
    v_smfmac_f32_16x16x64_bf16 v[48:51], v[20:23], v[64:71], v2
    ds_read_b128 v[64:67], v3 offset:8192
    ds_read_b128 v[68:71], v3 offset:9216
    v_smfmac_f32_16x16x64_bf16 v[40:43], v[20:23], v[112:119], v2
    v_smfmac_f32_16x16x64_bf16 v[44:47], v[20:23], v[120:127], v2
    s_waitcnt lgkmcnt(2)
    v_smfmac_f32_16x16x64_bf16 v[52:55], v[20:23], v[72:79], v2
    ds_read_b128 v[72:75], v3 offset:10240
    ds_read_b128 v[76:79], v3 offset:11264
    v_smfmac_f32_16x16x64_bf16 v[40:43], v[24:27], v[128:135], v2
    v_smfmac_f32_16x16x64_bf16 v[48:51], v[24:27], v[240:247], v2
    v_smfmac_f32_16x16x64_bf16 v[44:47], v[24:27], v[136:143], v2
    v_smfmac_f32_16x16x64_bf16 v[52:55], v[24:27], v[248:255], v2
    s_waitcnt lgkmcnt(2)
    v_smfmac_f32_16x16x64_bf16 v[48:51], v[28:31], v[64:71], v2
    ds_read_b128 v[64:67], v3 offset:12288
    ds_read_b128 v[68:71], v3 offset:13312
    v_smfmac_f32_16x16x64_bf16 v[40:43], v[28:31], v[144:151], v2
    v_smfmac_f32_16x16x64_bf16 v[44:47], v[28:31], v[152:159], v2
    s_waitcnt lgkmcnt(2)
    v_smfmac_f32_16x16x64_bf16 v[52:55], v[28:31], v[72:79], v2
    ds_read_b128 v[72:75], v3 offset:14336
    ds_read_b128 v[76:79], v3 offset:15360
    s_waitcnt vmcnt(0)
Lgr_22:
    v_max3_u32 v11, v32, v33, v34
    v_max3_u32 v11, v11, v35, v36
    v_cmp_eq_u32 vcc, -1, v11
    s_cbranch_vccnz Lgrre_23
    ds_write_b128 v37, v[32:35] offset:21504
    ds_write_b32 v38, v36 offset:21504
    v_smfmac_f32_16x16x64_bf16 v[56:59], v[12:15], a[80:87], v2
    s_cmp_ge_i32 s32, s58
    s_cbranch_scc1 Lkvo_28
Lkvok_25:
    s_mov_b32 m0, s35
    s_add_u32 s46, s46, 0x4000
    s_add_u32 s53, s46, 0x4000
    buffer_load_dword v4, s[4:7], s53 offen sc1 lds
    s_waitcnt lgkmcnt(4)
    v_smfmac_f32_16x16x64_bf16 v[56:59], v[16:19], v[64:71], v2
    ds_read_b128 v[64:67], v3 offset:16384
    ds_read_b128 v[68:71], v3 offset:17408
    v_smfmac_f32_16x16x64_bf16 v[60:63], v[12:15], a[88:95], v2
    s_waitcnt lgkmcnt(4)
    v_smfmac_f32_16x16x64_bf16 v[60:63], v[16:19], v[72:79], v2
    ds_read_b128 v[72:75], v3 offset:18432
    ds_read_b128 v[76:79], v3 offset:19456
    s_waitcnt lgkmcnt(4)
    s_barrier
    ds_read_b128 v[12:15], v1 offset:21504
    ds_read_b128 v[16:19], v1 offset:22528
    s_cmp_ge_u32 s32, s59
    s_cbranch_scc1 Lxt_29
Lxr_30:
    v_smfmac_f32_16x16x64_bf16 v[56:59], v[20:23], a[96:103], v2
    v_smfmac_f32_16x16x64_bf16 v[60:63], v[20:23], a[104:111], v2
    ds_read_b128 v[20:23], v1 offset:23552
    v_smfmac_f32_16x16x64_bf16 v[56:59], v[28:31], a[112:119], v2
    v_smfmac_f32_16x16x64_bf16 v[60:63], v[28:31], a[120:127], v2
    ds_read_b128 v[28:31], v1 offset:25600
    s_waitcnt lgkmcnt(6)
    v_smfmac_f32_16x16x64_bf16 v[56:59], v[24:27], v[64:71], v2
    ds_read_b128 v[64:67], v3 offset:20480
    ds_read_b128 v[68:71], v3 offset:21504
    s_waitcnt lgkmcnt(6)
    v_smfmac_f32_16x16x64_bf16 v[60:63], v[24:27], v[72:79], v2
    ds_read_b128 v[72:75], v3 offset:22528
    ds_read_b128 v[76:79], v3 offset:23552
    ds_read_b128 v[24:27], v1 offset:24576
    v_add_u32 v36, s56, v6
    ds_read_b64_tr_b16 v[32:33], v36 offset:26624
    ds_read_b64_tr_b16 v[34:35], v36 offset:27136
    s_waitcnt lgkmcnt(9)
    v_smfmac_f32_16x16x64_bf16 v[40:43], v[16:19], v[160:167], v2
    v_smfmac_f32_16x16x64_bf16 v[44:47], v[16:19], v[168:175], v2
    s_waitcnt lgkmcnt(8)
    v_smfmac_f32_16x16x64_bf16 v[40:43], v[20:23], v[176:183], v2
    v_smfmac_f32_16x16x64_bf16 v[44:47], v[20:23], v[184:191], v2
    s_waitcnt lgkmcnt(7)
    v_smfmac_f32_16x16x64_bf16 v[40:43], v[28:31], v[208:215], v2
    v_smfmac_f32_16x16x64_bf16 v[44:47], v[28:31], v[216:223], v2
    s_waitcnt lgkmcnt(0)
    buffer_store_dwordx4 v[32:35], v1, s[4:7], s48 offen sc1
    s_add_u32 s48, s48, s62
    s_mov_b32 s62, 0x2000
    v_smfmac_f32_16x16x64_bf16 v[40:43], v[12:15], v[64:71], v2
    v_smfmac_f32_16x16x64_bf16 v[44:47], v[12:15], v[72:79], v2
    v_smfmac_f32_16x16x64_bf16 v[40:43], v[24:27], v[192:199], v2
    v_smfmac_f32_16x16x64_bf16 v[44:47], v[24:27], v[200:207], v2
    v_smfmac_f32_16x16x64_bf16 v[48:51], v[12:15], a[0:7], v2
    ds_read_b128 v[64:67], v1 offset:4096
    v_smfmac_f32_16x16x64_bf16 v[52:55], v[12:15], a[8:15], v2
    ds_read_b128 v[68:71], v1 offset:5120
    v_smfmac_f32_16x16x64_bf16 v[48:51], v[16:19], a[16:23], v2
    ds_read_b128 v[72:75], v1 offset:6144
    v_smfmac_f32_16x16x64_bf16 v[52:55], v[16:19], a[24:31], v2
    ds_read_b128 v[76:79], v1 offset:7168
    v_smfmac_f32_16x16x64_bf16 v[48:51], v[20:23], a[32:39], v2
    v_smfmac_f32_16x16x64_bf16 v[52:55], v[20:23], a[40:47], v2
    v_smfmac_f32_16x16x64_bf16 v[48:51], v[24:27], a[48:55], v2
    v_add_f32 v40, v40, v41
    v_add_f32 v42, v42, v43
    v_smfmac_f32_16x16x64_bf16 v[52:55], v[24:27], a[56:63], v2
    v_add_f32 v44, v44, v45
    v_add_f32 v46, v46, v47
    v_smfmac_f32_16x16x64_bf16 v[48:51], v[28:31], a[64:71], v2
    v_cvt_pk_bf16_f32 v41, v40, v42
    v_smfmac_f32_16x16x64_bf16 v[52:55], v[28:31], a[72:79], v2
    v_cvt_pk_bf16_f32 v45, v44, v46
    v_smfmac_f32_16x16x64_bf16 v[56:59], v[12:15], a[128:135], v2
    v_smfmac_f32_16x16x64_bf16 v[60:63], v[12:15], a[136:143], v2
    v_smfmac_f32_16x16x64_bf16 v[56:59], v[16:19], a[144:151], v2
    v_smfmac_f32_16x16x64_bf16 v[60:63], v[16:19], a[152:159], v2
    s_nop 1
    v_add_f32 v48, v48, v49
    v_add_f32 v50, v50, v51
    v_cvt_pk_bf16_f32 v40, v48, v50
    ds_write_b64 v5, v[40:41] offset:0
    v_add_f32 v52, v52, v53
    v_add_f32 v54, v54, v55
    v_cvt_pk_bf16_f32 v44, v52, v54
    ds_write_b64 v5, v[44:45] offset:512
    v_smfmac_f32_16x16x64_bf16 v[56:59], v[20:23], a[160:167], v2
    v_smfmac_f32_16x16x64_bf16 v[60:63], v[20:23], a[168:175], v2
    v_smfmac_f32_16x16x64_bf16 v[56:59], v[24:27], a[176:183], v2
    v_smfmac_f32_16x16x64_bf16 v[60:63], v[24:27], a[184:191], v2
    s_waitcnt lgkmcnt(0)
    s_barrier
    ds_read_b64_tr_b16 v[12:13], v6 offset:26624
    ds_read_b64_tr_b16 v[14:15], v6 offset:27136
    ds_read_b64_tr_b16 v[16:17], v6 offset:27648
    ds_read_b64_tr_b16 v[18:19], v6 offset:28160
    v_smfmac_f32_16x16x64_bf16 v[56:59], v[28:31], a[192:199], v2
    ds_read_b64_tr_b16 v[20:21], v6 offset:28672
    ds_read_b64_tr_b16 v[22:23], v6 offset:29184
    ds_read_b64_tr_b16 v[24:25], v6 offset:29696
    ds_read_b64_tr_b16 v[26:27], v6 offset:30208
    v_smfmac_f32_16x16x64_bf16 v[60:63], v[28:31], a[200:207], v2
    ds_read_b128 v[40:43], v1 offset:0
    ds_read_b128 v[44:47], v1 offset:1024
    ds_read_b128 v[48:51], v1 offset:2048
    ds_read_b128 v[52:55], v1 offset:3072
    v_add_u32 v11, s47, v1
    ds_read_b128 v[32:35], v11
    ds_read_b128 v[36:39], v11 offset:1024
    s_waitcnt lgkmcnt(12)
    v_mfma_f32_16x16x32_bf16 v[28:31], v[64:67], v[12:15], 0
    s_waitcnt lgkmcnt(10)
    v_mfma_f32_16x16x32_bf16 v[28:31], v[68:71], v[16:19], v[28:31]
    s_waitcnt lgkmcnt(8)
    v_mfma_f32_16x16x32_bf16 v[28:31], v[72:75], v[20:23], v[28:31]
    s_waitcnt lgkmcnt(6)
    v_mfma_f32_16x16x32_bf16 v[28:31], v[76:79], v[24:27], v[28:31]
    v_mfma_f32_16x16x32_bf16 v[64:67], v[12:15], v[12:15], 0
    v_mfma_f32_16x16x32_bf16 v[64:67], v[16:19], v[16:19], v[64:67]
    v_mfma_f32_16x16x32_bf16 v[64:67], v[20:23], v[20:23], v[64:67]
    v_mfma_f32_16x16x32_bf16 v[64:67], v[24:27], v[24:27], v[64:67]
    s_waitcnt lgkmcnt(0)
    s_mov_b32 m0, s50
    s_barrier
    v_mfma_f32_16x16x32_bf16 v[68:71], v[40:43], v[12:15], 0
    v_add_f32 v56, v56, v57
    v_add_f32 v58, v58, v59
    v_mfma_f32_16x16x32_bf16 v[68:71], v[44:47], v[16:19], v[68:71]
    v_add_f32 v60, v60, v61
    v_add_f32 v62, v62, v63
    v_mfma_f32_16x16x32_bf16 v[68:71], v[48:51], v[20:23], v[68:71]
    buffer_load_dwordx4 v1, s[4:7], s46 offen offset:2048 sc1 lds
    v_cvt_pk_bf16_f32 v76, v56, v58
    v_mov_b32 v77, 0
    v_mfma_f32_16x16x32_bf16 v[68:71], v[52:55], v[24:27], v[68:71]
    buffer_load_dwordx4 v1, s[4:7], s46 offen offset:3072 sc1 lds
    v_cvt_pk_bf16_f32 v78, v60, v62
    v_mov_b32 v79, 0
    s_cmp_eq_u32 s32, 63
    s_cbranch_scc1 L_rec_last
    ds_read_b128 v[40:43], v3 offset:28672
    ds_read_b128 v[44:47], v3 offset:29696
    ds_read_b128 v[48:51], v3 offset:30720
    ds_read_b128 v[52:55], v3 offset:31744
    v_max3_f32 v11, v28, v29, v30
    v_max3_f32 v11, v11, v31, v64
    v_max3_f32 v11, v11, v65, v68
    v_max3_f32 v11, v11, v69, v70
    v_max_f32 v11, v11, v71
    v_mov_b32 v66, v11
    v_mov_b32 v20, 0x3f803f80
    v_mov_b32 v21, 0x3f803f80
    v_permlane16_swap_b32 v11, v66
    v_max_f32 v11, v11, v66
    v_mov_b32 v66, v11
    v_mov_b64 v[22:23], v[20:21]
    v_mov_b32 v17, 0
    v_permlane32_swap_b32 v11, v66
    v_max_f32 v11, v11, v66
    v_mul_f32 v11, s51, v11
    v_fma_f32 v64, v64, s51, -v11
    v_fma_f32 v65, v65, s51, -v11
    v_exp_f32 v64, v64
    v_fma_f32 v68, v68, s51, -v11
    v_exp_f32 v65, v65
    v_fma_f32 v69, v69, s51, -v11
    v_exp_f32 v68, v68
    v_cvt_pk_bf16_f32 v16, v64, v65
    v_fma_f32 v70, v70, s51, -v11
    v_exp_f32 v69, v69
    v_fma_f32 v71, v71, s51, -v11
    v_exp_f32 v70, v70
    v_cvt_pk_bf16_f32 v12, v68, v69
    v_mfma_f32_16x16x16_bf16 v[24:27], v[20:21], v[16:17], 0
    v_fma_f32 v28, v28, s51, -v11
    v_exp_f32 v71, v71
    v_mfma_f32_16x16x16_bf16 v[56:59], v[76:77], v[16:17], 0
    v_fma_f32 v29, v29, s51, -v11
    v_exp_f32 v28, v28
    v_cvt_pk_bf16_f32 v13, v70, v71
    v_mfma_f32_16x16x16_bf16 v[60:63], v[78:79], v[16:17], 0
    v_fma_f32 v30, v30, s51, -v11
    v_exp_f32 v29, v29
    v_fma_f32 v31, v31, s51, -v11
    v_exp_f32 v30, v30
    v_exp_f32 v31, v31
    v_cvt_pk_bf16_f32 v14, v28, v29
    v_cvt_pk_bf16_f32 v15, v30, v31
    s_nop 1
    v_mfma_f32_16x16x32_bf16 v[24:27], v[20:23], v[12:15], v[24:27]
    v_mfma_f32_16x16x32_bf16 v[56:59], v[32:35], v[12:15], v[56:59]
    v_mfma_f32_16x16x32_bf16 v[60:63], v[36:39], v[12:15], v[60:63]
    v_mov_b64 v[12:13], 0
    v_mov_b64 v[14:15], 0
    v_mov_b64 v[16:17], 0
    v_mov_b64 v[18:19], 0
    v_mov_b64 v[20:21], 0
    v_mov_b64 v[22:23], 0
    v_rcp_f32 v11, v24
    s_mov_b32 exec_lo, 0xcccccccc
    s_mov_b32 exec_hi, 0xcccccccc
    v_mul_f32 v56, v56, v11
    v_mul_f32 v57, v57, v11
    v_mul_f32 v58, v58, v11
    v_mul_f32 v59, v59, v11
    v_cvt_pk_bf16_f32 v56, v56, v57
    v_cvt_pk_bf16_f32 v57, v58, v59
    ds_write_b64 v7, v[56:57] offset:0
    v_mul_f32 v60, v60, v11
    v_mul_f32 v61, v61, v11
    v_mul_f32 v62, v62, v11
    v_mul_f32 v63, v63, v11
    v_cvt_pk_bf16_f32 v60, v60, v61
    v_cvt_pk_bf16_f32 v61, v62, v63
    ds_write_b64 v7, v[60:61] offset:32
    s_mov_b64 exec, -1
    ds_read_b128 v[32:35], v3 offset:24576
    ds_read_b128 v[36:39], v3 offset:25600
    ds_read_b128 v[64:67], v3 offset:26624
    ds_read_b128 v[68:71], v3 offset:27648
    v_mov_b64 v[24:25], 0
    v_mov_b64 v[26:27], 0
    v_mov_b64 v[28:29], 0
    v_mov_b64 v[30:31], 0
    buffer_load_dwordx4 v1, s[4:7], s46 offen offset:0 sc1 lds
    buffer_load_dwordx4 v1, s[4:7], s46 offen offset:1024 sc1 lds
    s_waitcnt lgkmcnt(4)
    s_barrier
    ds_read_b128 v[56:59], v8 offset:0
    ds_read_b128 v[60:63], v8 offset:128
    s_waitcnt lgkmcnt(1)
    v_smfmac_f32_16x16x64_bf16 v[28:31], v[56:59], v[40:47], v2
    s_waitcnt lgkmcnt(0)
    v_smfmac_f32_16x16x64_bf16 v[28:31], v[60:63], v[48:55], v2
    v_smfmac_f32_16x16x64_bf16 v[12:15], v[56:59], a[208:215], v2
    v_smfmac_f32_16x16x64_bf16 v[12:15], v[60:63], a[216:223], v2
    v_smfmac_f32_16x16x64_bf16 v[16:19], v[56:59], a[224:231], v2
    v_smfmac_f32_16x16x64_bf16 v[16:19], v[60:63], a[232:239], v2
    v_smfmac_f32_16x16x64_bf16 v[20:23], v[56:59], a[240:247], v2
    v_smfmac_f32_16x16x64_bf16 v[20:23], v[60:63], a[248:255], v2
    s_nop 1
    v_add_f32 v28, v28, v29
    v_add_f32 v30, v30, v31
    v_smfmac_f32_16x16x64_bf16 v[24:27], v[56:59], v[32:39], v2
    v_cvt_pk_bf16_f32 v44, v28, v30
    v_and_b32 v44, -2, v44
    v_smfmac_f32_16x16x64_bf16 v[24:27], v[60:63], v[64:71], v2
    buffer_store_dword v44, v9, s[4:7], s44 offen
    v_add_f32 v12, v12, v13
    v_add_f32 v14, v14, v15
    v_cvt_pk_bf16_f32 v40, v12, v14
    v_and_b32 v40, -2, v40
    v_add_f32 v16, v16, v17
    v_add_f32 v18, v18, v19
    v_cvt_pk_bf16_f32 v41, v16, v18
    v_and_b32 v41, -2, v41
    v_add_f32 v20, v20, v21
    v_add_f32 v22, v22, v23
    v_cvt_pk_bf16_f32 v42, v20, v22
    v_and_b32 v42, -2, v42
    v_add_f32 v24, v24, v25
    v_add_f32 v26, v26, v27
    v_cvt_pk_bf16_f32 v43, v24, v26
    v_and_b32 v43, -2, v43
    buffer_store_dwordx4 v[40:43], v9, s[4:7], s43 offen
    s_add_u32 s53, s32, 1
    s_and_b32 s53, s53, 3
    s_lshl_b32 s53, s53, 13
    s_add_u32 s38, s36, s53
    s_xor_b32 s53, s53, 0x4000
    s_add_u32 s55, s36, s53
    s_add_u32 s39, s39, 16384
    s_add_u32 s40, s40, 16384
    ds_read_b128 v[28:31], v1 offset:30720
    v_mov_b64 v[40:41], 0
    v_mov_b64 v[42:43], 0
    v_mov_b64 v[44:45], 0
    v_mov_b64 v[46:47], 0
    v_mov_b64 v[48:49], 0
    v_mov_b64 v[50:51], 0
    v_mov_b64 v[52:53], 0
    v_mov_b64 v[54:55], 0
    v_mov_b64 v[56:57], 0
    v_mov_b64 v[58:59], 0
    v_mov_b64 v[60:61], 0
    v_mov_b64 v[62:63], 0
    s_cmp_ge_u32 s42, 40
    s_cbranch_scc1 Lnored_33
    s_sleep 4
    buffer_load_dwordx4 v[64:67], v1, s[4:7], s45 offen offset:0 sc1
    buffer_load_dwordx4 v[68:71], v1, s[4:7], s45 offen offset:1024 sc1
    buffer_load_dwordx4 v[72:75], v1, s[4:7], s45 offen offset:2048 sc1
    buffer_load_dwordx4 v[76:79], v1, s[4:7], s45 offen offset:3072 sc1
    s_sleep 2
    buffer_load_dwordx4 v[12:15], v1, s[4:7], s45 offen offset:0 sc1
    buffer_load_dwordx4 v[16:19], v1, s[4:7], s45 offen offset:1024 sc1
    buffer_load_dwordx4 v[20:23], v1, s[4:7], s45 offen offset:2048 sc1
    buffer_load_dwordx4 v[24:27], v1, s[4:7], s45 offen offset:3072 sc1
    s_waitcnt lgkmcnt(0)
Lrd_35:
    v_mov_b32 v11, 0
    s_waitcnt vmcnt(7)
    v_mfma_f32_16x16x32_bf16 v[32:35], v[28:31], v[64:67], 0
    v_or3_b32 v11, v11, v64, v65
    v_or3_b32 v11, v11, v66, v67
    s_waitcnt vmcnt(6)
    v_mfma_f32_16x16x32_bf16 v[32:35], v[28:31], v[68:71], v[32:35]
    v_or3_b32 v11, v11, v68, v69
    v_or3_b32 v11, v11, v70, v71
    s_waitcnt vmcnt(5)
    v_mfma_f32_16x16x32_bf16 v[32:35], v[28:31], v[72:75], v[32:35]
    v_or3_b32 v11, v11, v72, v73
    v_or3_b32 v11, v11, v74, v75
    s_waitcnt vmcnt(4)
    v_mfma_f32_16x16x32_bf16 v[32:35], v[28:31], v[76:79], v[32:35]
    v_or3_b32 v11, v11, v76, v77
    v_or3_b32 v11, v11, v78, v79
    v_and_b32 v11, 1, v11
    v_cmp_ne_u32 vcc, 0, v11
    s_cbranch_vccnz Lrd2_37
Lrdok_36:
    s_nop 2
    v_add_f32_dpp v36, v32, v32 row_ror:8 row_mask:0xf bank_mask:0xf
    v_add_f32_dpp v37, v33, v33 row_ror:8 row_mask:0xf bank_mask:0xf
    v_add_f32_dpp v38, v34, v34 row_ror:8 row_mask:0xf bank_mask:0xf
    v_add_f32_dpp v39, v35, v35 row_ror:8 row_mask:0xf bank_mask:0xf
    s_mov_b32 exec_lo, 0x00ff00ff
    s_mov_b32 exec_hi, 0
    v_cvt_pk_bf16_f32 v32, v36, v37
    v_cvt_pk_bf16_f32 v33, v38, v39
    v_min_u32 v32, -2, v32
    v_min_u32 v33, -2, v33
    buffer_store_dwordx2 v[32:33], v10, s[4:7], s38 offen
    buffer_store_dwordx2 v[32:33], v10, s[4:7], s40 offen sc1
    v_mov_b64 v[34:35], -1
    buffer_store_dwordx2 v[34:35], v10, s[4:7], s55 offen
    s_mov_b64 exec, -1
Ljoin_34:
    s_barrier
    s_add_u32 s32, s32, 1
    s_branch L_loop_fast0
L_ool_fast0:
Lrd2_16:
    buffer_load_dwordx4 v[64:67], v1, s[4:7], s45 offen offset:0 sc1
    buffer_load_dwordx4 v[68:71], v1, s[4:7], s45 offen offset:1024 sc1
    buffer_load_dwordx4 v[72:75], v1, s[4:7], s45 offen offset:2048 sc1
    buffer_load_dwordx4 v[76:79], v1, s[4:7], s45 offen offset:3072 sc1
    v_mov_b32 v11, 1
    s_waitcnt vmcnt(7)
    v_mfma_f32_16x16x32_bf16 v[32:35], v[28:31], v[12:15], 0
    v_bitop3_b32 v11, v11, v12, v13 bitop3:0x80
    v_bitop3_b32 v11, v11, v14, v15 bitop3:0x80
    s_waitcnt vmcnt(6)
    v_mfma_f32_16x16x32_bf16 v[32:35], v[28:31], v[16:19], v[32:35]
    v_bitop3_b32 v11, v11, v16, v17 bitop3:0x80
    v_bitop3_b32 v11, v11, v18, v19 bitop3:0x80
    s_waitcnt vmcnt(5)
    v_mfma_f32_16x16x32_bf16 v[32:35], v[28:31], v[20:23], v[32:35]
    v_bitop3_b32 v11, v11, v20, v21 bitop3:0x80
    v_bitop3_b32 v11, v11, v22, v23 bitop3:0x80
    s_waitcnt vmcnt(4)
    v_mfma_f32_16x16x32_bf16 v[32:35], v[28:31], v[24:27], v[32:35]
    v_bitop3_b32 v11, v11, v24, v25 bitop3:0x80
    v_bitop3_b32 v11, v11, v26, v27 bitop3:0x80
    v_and_b32 v11, 1, v11
    v_cmp_ne_u32 vcc, 1, v11
    s_cbranch_vccz Lrdok_15
    buffer_load_dwordx4 v[12:15], v1, s[4:7], s45 offen offset:0 sc1
    buffer_load_dwordx4 v[16:19], v1, s[4:7], s45 offen offset:1024 sc1
    buffer_load_dwordx4 v[20:23], v1, s[4:7], s45 offen offset:2048 sc1
    buffer_load_dwordx4 v[24:27], v1, s[4:7], s45 offen offset:3072 sc1
    s_add_u32 s74, s74, 1
    s_cmp_gt_u32 s74, 60000
    s_cbranch_scc1 L_abort
    s_branch Lrd_14
Lglre_5:
    buffer_load_dwordx4 v[12:15], v37, s[4:7], s38 offen sc1
    buffer_load_dword v16, v38, s[4:7], s38 offen sc1
    s_waitcnt vmcnt(2)
    v_max3_u32 v11, v20, v21, v22
    v_max3_u32 v11, v11, v23, v24
    v_cmp_eq_u32 vcc, -1, v11
    s_cbranch_vccz LglB_3
    buffer_load_dwordx4 v[20:23], v37, s[4:7], s38 offen sc1
    buffer_load_dword v24, v38, s[4:7], s38 offen sc1
    s_add_u32 s74, s74, 1
    s_cmp_gt_u32 s74, 60000
    s_cbranch_scc1 L_abort
    s_waitcnt vmcnt(2)
    s_branch Lgl_1
LglB_3:
    ds_write_b128 v37, v[20:23] offset:16384
    ds_write_b32 v38, v24 offset:16384
    s_branch Lglok_4
Lgrre_7:
    buffer_load_dwordx4 v[32:35], v37, s[4:7], s39 offen sc1
    buffer_load_dword v36, v38, s[4:7], s39 offen sc1
    s_add_u32 s74, s74, 1
    s_cmp_gt_u32 s74, 60000
    s_cbranch_scc1 L_abort
    s_waitcnt vmcnt(0)
    s_branch Lgr_6
Lnored_12:
    s_waitcnt lgkmcnt(0)
    s_branch Ljoin_13
Lxt_8:
    s_cmp_lg_u32 s63, 0
    s_cbranch_scc1 Lsg_38
    s_max_u32 s53, s32, 2
    s_sub_u32 s53, s53, 2
    s_mov_b64 exec, 1
    v_mov_b32 v11, s53
    s_mov_b32 s53, 0x5c00000
    buffer_store_dword v11, v0, s[4:7], s53 offen sc1
    s_mov_b64 exec, -1
Lsg_38:
    s_add_u32 s59, s32, 4
    s_min_u32 s59, s59, 59
    s_cmp_lt_u32 s32, 59
    s_cbranch_scc1 Lxr_9
    s_cmp_lg_u32 s28, 2
    s_cbranch_scc1 Lsg_39
    s_lshl_b32 s53, s30, 7
    s_lshl_b32 s54, s29, 2
    s_add_u32 s53, s53, s54
    s_add_u32 s53, s53, 0x5c00080
    s_sub_u32 s54, s32, 1
    s_mov_b64 exec, 1
    v_mov_b32 v11, s54
    buffer_store_dword v11, v0, s[4:7], s53 offen sc1
    s_mov_b64 exec, -1
Lsg_39:
    s_branch Lxr_9
Lrd2_37:
    buffer_load_dwordx4 v[64:67], v1, s[4:7], s45 offen offset:0 sc1
    buffer_load_dwordx4 v[68:71], v1, s[4:7], s45 offen offset:1024 sc1
    buffer_load_dwordx4 v[72:75], v1, s[4:7], s45 offen offset:2048 sc1
    buffer_load_dwordx4 v[76:79], v1, s[4:7], s45 offen offset:3072 sc1
    v_mov_b32 v11, 0
    s_waitcnt vmcnt(7)
    v_mfma_f32_16x16x32_bf16 v[32:35], v[28:31], v[12:15], 0
    v_or3_b32 v11, v11, v12, v13
    v_or3_b32 v11, v11, v14, v15
    s_waitcnt vmcnt(6)
    v_mfma_f32_16x16x32_bf16 v[32:35], v[28:31], v[16:19], v[32:35]
    v_or3_b32 v11, v11, v16, v17
    v_or3_b32 v11, v11, v18, v19
    s_waitcnt vmcnt(5)
    v_mfma_f32_16x16x32_bf16 v[32:35], v[28:31], v[20:23], v[32:35]
    v_or3_b32 v11, v11, v20, v21
    v_or3_b32 v11, v11, v22, v23
    s_waitcnt vmcnt(4)
    v_mfma_f32_16x16x32_bf16 v[32:35], v[28:31], v[24:27], v[32:35]
    v_or3_b32 v11, v11, v24, v25
    v_or3_b32 v11, v11, v26, v27
    v_and_b32 v11, 1, v11
    v_cmp_ne_u32 vcc, 0, v11
    s_cbranch_vccz Lrdok_36
    buffer_load_dwordx4 v[12:15], v1, s[4:7], s45 offen offset:0 sc1
    buffer_load_dwordx4 v[16:19], v1, s[4:7], s45 offen offset:1024 sc1
    buffer_load_dwordx4 v[20:23], v1, s[4:7], s45 offen offset:2048 sc1
    buffer_load_dwordx4 v[24:27], v1, s[4:7], s45 offen offset:3072 sc1
    s_add_u32 s74, s74, 1
    s_cmp_gt_u32 s74, 60000
    s_cbranch_scc1 L_abort
    s_branch Lrd_35
Lglre_21:
    buffer_load_dwordx4 v[12:15], v37, s[4:7], s38 offen sc1
    buffer_load_dword v16, v38, s[4:7], s38 offen sc1
    s_waitcnt vmcnt(2)
    v_max3_u32 v11, v20, v21, v22
    v_max3_u32 v11, v11, v23, v24
    v_cmp_eq_u32 vcc, -1, v11
    s_cbranch_vccz LglB_19
    buffer_load_dwordx4 v[20:23], v37, s[4:7], s38 offen sc1
    buffer_load_dword v24, v38, s[4:7], s38 offen sc1
    s_add_u32 s74, s74, 1
    s_cmp_gt_u32 s74, 60000
    s_cbranch_scc1 L_abort
    s_waitcnt vmcnt(2)
    s_branch Lgl_17
LglB_19:
    ds_write_b128 v37, v[20:23] offset:16384
    ds_write_b32 v38, v24 offset:16384
    s_branch Lglok_20
Lgrre_23:
    buffer_load_dwordx4 v[32:35], v37, s[4:7], s39 offen sc1
    buffer_load_dword v36, v38, s[4:7], s39 offen sc1
    s_add_u32 s74, s74, 1
    s_cmp_gt_u32 s74, 60000
    s_cbranch_scc1 L_abort
    s_waitcnt vmcnt(0)
    s_branch Lgr_22
Lnored_33:
    s_waitcnt lgkmcnt(0)
    s_branch Ljoin_34
Lkvo_28:
    s_add_u32 s54, s32, 3
    s_lshr_b32 s54, s54, 2
    s_cmp_ge_u32 s54, s49
    s_cbranch_scc1 Lkvn_27
    s_mov_b32 m0, s37
    s_mov_b32 exec_hi, 0
    buffer_load_dword v0, s[24:27], 0 offen sc1 lds
    s_mov_b32 exec_hi, -1
    s_branch Lkvok_25
Lkvn_27:
    v_add_u32 v11, s37, v0
    ds_read_b32 v11, v11
    s_waitcnt lgkmcnt(0)
    s_branch Lkvu_26
Lkv_24:
    buffer_load_dword v11, v0, s[24:27], 0 offen sc1
    s_waitcnt vmcnt(0)
Lkvu_26:
    v_and_b32 v11, 0x3ff, v11
    v_cmp_le_u32 vcc, 128, v11
    s_nop 3
    s_lshr_b32 s49, vcc_lo, 16
    s_ff0_i32_b32 s49, s49
    s_cmp_eq_u32 s49, 16
    s_cmov_b32 s49, 18
    s_lshl_b32 s58, s49, 2
    s_sub_u32 s58, s58, 5
    s_cmp_lt_u32 s54, s49
    s_cbranch_scc1 Lkvok_25
    s_add_u32 s74, s74, 1
    s_cmp_gt_u32 s74, 60000
    s_cbranch_scc1 L_abort
    s_sleep 2
    s_branch Lkv_24
Lxt_29:
    s_cmp_lg_u32 s63, 0
    s_cbranch_scc1 Lsg_40
    s_max_u32 s53, s32, 2
    s_sub_u32 s53, s53, 2
    s_mov_b64 exec, 1
    v_mov_b32 v11, s53
    s_mov_b32 s53, 0x5c00000
    buffer_store_dword v11, v0, s[4:7], s53 offen sc1
    s_mov_b64 exec, -1
Lsg_40:
    s_add_u32 s59, s32, 4
    s_min_u32 s59, s59, 59
    s_cmp_lt_u32 s32, 59
    s_cbranch_scc1 Lxr_30
    s_cmp_lg_u32 s28, 2
    s_cbranch_scc1 Lsg_41
    s_lshl_b32 s53, s30, 7
    s_lshl_b32 s54, s29, 2
    s_add_u32 s53, s53, s54
    s_add_u32 s53, s53, 0x5c00080
    s_sub_u32 s54, s32, 1
    s_mov_b64 exec, 1
    v_mov_b32 v11, s54
    buffer_store_dword v11, v0, s[4:7], s53 offen sc1
    s_mov_b64 exec, -1
Lsg_41:
    s_branch Lxr_30
L_loop_fast1:
    v_add_u32 v37, s33, v1
    v_add_u32 v38, s34, v0
    s_sleep 3
    buffer_load_dwordx4 v[12:15], v37, s[4:7], s38 offen sc1
    buffer_load_dword v16, v38, s[4:7], s38 offen sc1
    s_sleep 2
    s_mov_b32 m0, s50
    buffer_load_dwordx4 v[20:23], v37, s[4:7], s38 offen sc1
    buffer_load_dword v24, v38, s[4:7], s38 offen sc1
    s_waitcnt vmcnt(2)
Lgl_42:
    v_max3_u32 v11, v12, v13, v14
    v_max3_u32 v11, v11, v15, v16
    v_cmp_eq_u32 vcc, -1, v11
    s_cbranch_vccnz Lglre_46
    ds_write_b128 v37, v[12:15] offset:16384
    ds_write_b32 v38, v16 offset:16384
Lglok_45:
    ds_read_b128 v[64:67], v3 offset:0
    ds_read_b128 v[68:71], v3 offset:1024
    ds_read_b128 v[72:75], v3 offset:2048
    ds_read_b128 v[76:79], v3 offset:3072
    s_waitcnt lgkmcnt(4)
    s_barrier
    s_waitcnt vmcnt(0)
    ds_read_b128 v[12:15], v1 offset:16384
    ds_read_b128 v[16:19], v1 offset:17408
    ds_read_b128 v[20:23], v1 offset:18432
    ds_read_b128 v[24:27], v1 offset:19456
    ds_read_b128 v[28:31], v1 offset:20480
    buffer_load_dwordx4 v[32:35], v37, s[4:7], s39 offen sc1
    buffer_load_dword v36, v38, s[4:7], s39 offen sc1
    s_waitcnt lgkmcnt(4)
    v_smfmac_f32_16x16x64_bf16 v[48:51], v[12:15], v[64:71], v2
    ds_read_b128 v[64:67], v3 offset:4096
    ds_read_b128 v[68:71], v3 offset:5120
    v_smfmac_f32_16x16x64_bf16 v[40:43], v[12:15], v[80:87], v2
    v_smfmac_f32_16x16x64_bf16 v[44:47], v[12:15], v[88:95], v2
    v_smfmac_f32_16x16x64_bf16 v[52:55], v[12:15], v[72:79], v2
    ds_read_b128 v[72:75], v3 offset:6144
    ds_read_b128 v[76:79], v3 offset:7168
    s_waitcnt lgkmcnt(7)
    v_smfmac_f32_16x16x64_bf16 v[40:43], v[16:19], v[96:103], v2
    v_smfmac_f32_16x16x64_bf16 v[48:51], v[16:19], v[224:231], v2
    v_smfmac_f32_16x16x64_bf16 v[44:47], v[16:19], v[104:111], v2
    v_smfmac_f32_16x16x64_bf16 v[52:55], v[16:19], v[232:239], v2
    s_waitcnt lgkmcnt(6)
    s_waitcnt lgkmcnt(2)
    v_smfmac_f32_16x16x64_bf16 v[48:51], v[20:23], v[64:71], v2
    ds_read_b128 v[64:67], v3 offset:8192
    ds_read_b128 v[68:71], v3 offset:9216
    v_smfmac_f32_16x16x64_bf16 v[40:43], v[20:23], v[112:119], v2
    v_smfmac_f32_16x16x64_bf16 v[44:47], v[20:23], v[120:127], v2
    s_waitcnt lgkmcnt(2)
    v_smfmac_f32_16x16x64_bf16 v[52:55], v[20:23], v[72:79], v2
    ds_read_b128 v[72:75], v3 offset:10240
    ds_read_b128 v[76:79], v3 offset:11264
    v_smfmac_f32_16x16x64_bf16 v[40:43], v[24:27], v[128:135], v2
    v_smfmac_f32_16x16x64_bf16 v[48:51], v[24:27], v[240:247], v2
    v_smfmac_f32_16x16x64_bf16 v[44:47], v[24:27], v[136:143], v2
    v_smfmac_f32_16x16x64_bf16 v[52:55], v[24:27], v[248:255], v2
    s_waitcnt lgkmcnt(2)
    v_smfmac_f32_16x16x64_bf16 v[48:51], v[28:31], v[64:71], v2
    ds_read_b128 v[64:67], v3 offset:12288
    ds_read_b128 v[68:71], v3 offset:13312
    v_smfmac_f32_16x16x64_bf16 v[40:43], v[28:31], v[144:151], v2
    v_smfmac_f32_16x16x64_bf16 v[44:47], v[28:31], v[152:159], v2
    s_waitcnt lgkmcnt(2)
    v_smfmac_f32_16x16x64_bf16 v[52:55], v[28:31], v[72:79], v2
    ds_read_b128 v[72:75], v3 offset:14336
    ds_read_b128 v[76:79], v3 offset:15360
    s_waitcnt vmcnt(0)
Lgr_47:
    v_max3_u32 v11, v32, v33, v34
    v_max3_u32 v11, v11, v35, v36
    v_cmp_eq_u32 vcc, -1, v11
    s_cbranch_vccnz Lgrre_48
    ds_write_b128 v37, v[32:35] offset:21504
    ds_write_b32 v38, v36 offset:21504
    v_smfmac_f32_16x16x64_bf16 v[56:59], v[12:15], a[80:87], v2
    s_mov_b32 m0, s35
    s_add_u32 s46, s46, 0x4000
    s_add_u32 s53, s46, 0x4000
    buffer_load_dword v4, s[4:7], s53 offen sc1 lds
    s_waitcnt lgkmcnt(4)
    v_smfmac_f32_16x16x64_bf16 v[56:59], v[16:19], v[64:71], v2
    ds_read_b128 v[64:67], v3 offset:16384
    ds_read_b128 v[68:71], v3 offset:17408
    v_smfmac_f32_16x16x64_bf16 v[60:63], v[12:15], a[88:95], v2
    s_waitcnt lgkmcnt(4)
    v_smfmac_f32_16x16x64_bf16 v[60:63], v[16:19], v[72:79], v2
    ds_read_b128 v[72:75], v3 offset:18432
    ds_read_b128 v[76:79], v3 offset:19456
    s_waitcnt lgkmcnt(4)
    s_barrier
    ds_read_b128 v[12:15], v1 offset:21504
    ds_read_b128 v[16:19], v1 offset:22528
    s_cmp_ge_u32 s32, s59
    s_cbranch_scc1 Lxt_49
Lxr_50:
    v_smfmac_f32_16x16x64_bf16 v[56:59], v[20:23], a[96:103], v2
    v_smfmac_f32_16x16x64_bf16 v[60:63], v[20:23], a[104:111], v2
    ds_read_b128 v[20:23], v1 offset:23552
    v_smfmac_f32_16x16x64_bf16 v[56:59], v[28:31], a[112:119], v2
    v_smfmac_f32_16x16x64_bf16 v[60:63], v[28:31], a[120:127], v2
    ds_read_b128 v[28:31], v1 offset:25600
    s_waitcnt lgkmcnt(6)
    v_smfmac_f32_16x16x64_bf16 v[56:59], v[24:27], v[64:71], v2
    ds_read_b128 v[64:67], v3 offset:20480
    ds_read_b128 v[68:71], v3 offset:21504
    s_waitcnt lgkmcnt(6)
    v_smfmac_f32_16x16x64_bf16 v[60:63], v[24:27], v[72:79], v2
    ds_read_b128 v[72:75], v3 offset:22528
    ds_read_b128 v[76:79], v3 offset:23552
    ds_read_b128 v[24:27], v1 offset:24576
    v_add_u32 v36, s56, v6
    ds_read_b64 v[38:39], v36 offset:26624
    s_waitcnt lgkmcnt(8)
    v_smfmac_f32_16x16x64_bf16 v[40:43], v[16:19], v[160:167], v2
    v_smfmac_f32_16x16x64_bf16 v[44:47], v[16:19], v[168:175], v2
    s_waitcnt lgkmcnt(7)
    v_smfmac_f32_16x16x64_bf16 v[40:43], v[20:23], v[176:183], v2
    v_smfmac_f32_16x16x64_bf16 v[44:47], v[20:23], v[184:191], v2
    s_waitcnt lgkmcnt(6)
    v_smfmac_f32_16x16x64_bf16 v[40:43], v[28:31], v[208:215], v2
    v_smfmac_f32_16x16x64_bf16 v[44:47], v[28:31], v[216:223], v2
    s_waitcnt lgkmcnt(0)
    buffer_store_dwordx2 v[38:39], v6, s[4:7], s48 offen sc1
    s_add_u32 s48, s48, s62
    s_mov_b32 s62, 0x2000
    v_smfmac_f32_16x16x64_bf16 v[40:43], v[12:15], v[64:71], v2
    v_smfmac_f32_16x16x64_bf16 v[44:47], v[12:15], v[72:79], v2
    v_smfmac_f32_16x16x64_bf16 v[40:43], v[24:27], v[192:199], v2
    v_smfmac_f32_16x16x64_bf16 v[44:47], v[24:27], v[200:207], v2
    v_smfmac_f32_16x16x64_bf16 v[48:51], v[12:15], a[0:7], v2
    ds_read_b128 v[64:67], v1 offset:4096
    v_smfmac_f32_16x16x64_bf16 v[52:55], v[12:15], a[8:15], v2
    ds_read_b128 v[68:71], v1 offset:5120
    v_smfmac_f32_16x16x64_bf16 v[48:51], v[16:19], a[16:23], v2
    ds_read_b128 v[72:75], v1 offset:6144
    v_smfmac_f32_16x16x64_bf16 v[52:55], v[16:19], a[24:31], v2
    ds_read_b128 v[76:79], v1 offset:7168
    v_smfmac_f32_16x16x64_bf16 v[48:51], v[20:23], a[32:39], v2
    v_smfmac_f32_16x16x64_bf16 v[52:55], v[20:23], a[40:47], v2
    v_smfmac_f32_16x16x64_bf16 v[48:51], v[24:27], a[48:55], v2
    v_add_f32 v40, v40, v41
    v_add_f32 v42, v42, v43
    v_smfmac_f32_16x16x64_bf16 v[52:55], v[24:27], a[56:63], v2
    v_add_f32 v44, v44, v45
    v_add_f32 v46, v46, v47
    v_smfmac_f32_16x16x64_bf16 v[48:51], v[28:31], a[64:71], v2
    v_cvt_pk_bf16_f32 v41, v40, v42
    v_smfmac_f32_16x16x64_bf16 v[52:55], v[28:31], a[72:79], v2
    v_cvt_pk_bf16_f32 v45, v44, v46
    v_smfmac_f32_16x16x64_bf16 v[56:59], v[12:15], a[128:135], v2
    v_smfmac_f32_16x16x64_bf16 v[60:63], v[12:15], a[136:143], v2
    v_smfmac_f32_16x16x64_bf16 v[56:59], v[16:19], a[144:151], v2
    v_smfmac_f32_16x16x64_bf16 v[60:63], v[16:19], a[152:159], v2
    s_nop 1
    v_add_f32 v48, v48, v49
    v_add_f32 v50, v50, v51
    v_cvt_pk_bf16_f32 v40, v48, v50
    ds_write_b64 v5, v[40:41] offset:0
    v_add_f32 v52, v52, v53
    v_add_f32 v54, v54, v55
    v_cvt_pk_bf16_f32 v44, v52, v54
    ds_write_b64 v5, v[44:45] offset:512
    v_smfmac_f32_16x16x64_bf16 v[56:59], v[20:23], a[160:167], v2
    v_smfmac_f32_16x16x64_bf16 v[60:63], v[20:23], a[168:175], v2
    v_smfmac_f32_16x16x64_bf16 v[56:59], v[24:27], a[176:183], v2
    v_smfmac_f32_16x16x64_bf16 v[60:63], v[24:27], a[184:191], v2
    s_waitcnt lgkmcnt(0)
    s_barrier
    ds_read_b64_tr_b16 v[12:13], v6 offset:26624
    ds_read_b64_tr_b16 v[14:15], v6 offset:27136
    ds_read_b64_tr_b16 v[16:17], v6 offset:27648
    ds_read_b64_tr_b16 v[18:19], v6 offset:28160
    v_smfmac_f32_16x16x64_bf16 v[56:59], v[28:31], a[192:199], v2
    ds_read_b64_tr_b16 v[20:21], v6 offset:28672
    ds_read_b64_tr_b16 v[22:23], v6 offset:29184
    ds_read_b64_tr_b16 v[24:25], v6 offset:29696
    ds_read_b64_tr_b16 v[26:27], v6 offset:30208
    v_smfmac_f32_16x16x64_bf16 v[60:63], v[28:31], a[200:207], v2
    ds_read_b128 v[40:43], v1 offset:0
    ds_read_b128 v[44:47], v1 offset:1024
    ds_read_b128 v[48:51], v1 offset:2048
    ds_read_b128 v[52:55], v1 offset:3072
    v_add_u32 v11, s47, v1
    ds_read_b128 v[32:35], v11
    ds_read_b128 v[36:39], v11 offset:1024
    s_waitcnt lgkmcnt(12)
    v_mfma_f32_16x16x32_bf16 v[28:31], v[64:67], v[12:15], 0
    s_waitcnt lgkmcnt(10)
    v_mfma_f32_16x16x32_bf16 v[28:31], v[68:71], v[16:19], v[28:31]
    s_waitcnt lgkmcnt(8)
    v_mfma_f32_16x16x32_bf16 v[28:31], v[72:75], v[20:23], v[28:31]
    s_waitcnt lgkmcnt(6)
    v_mfma_f32_16x16x32_bf16 v[28:31], v[76:79], v[24:27], v[28:31]
    v_mfma_f32_16x16x32_bf16 v[64:67], v[12:15], v[12:15], 0
    v_mfma_f32_16x16x32_bf16 v[64:67], v[16:19], v[16:19], v[64:67]
    v_mfma_f32_16x16x32_bf16 v[64:67], v[20:23], v[20:23], v[64:67]
    v_mfma_f32_16x16x32_bf16 v[64:67], v[24:27], v[24:27], v[64:67]
    s_waitcnt lgkmcnt(0)
    s_mov_b32 m0, s50
    s_barrier
    v_mfma_f32_16x16x32_bf16 v[68:71], v[40:43], v[12:15], 0
    v_add_f32 v56, v56, v57
    v_add_f32 v58, v58, v59
    v_mfma_f32_16x16x32_bf16 v[68:71], v[44:47], v[16:19], v[68:71]
    v_add_f32 v60, v60, v61
    v_add_f32 v62, v62, v63
    v_mfma_f32_16x16x32_bf16 v[68:71], v[48:51], v[20:23], v[68:71]
    buffer_load_dwordx4 v1, s[4:7], s46 offen offset:2048 sc1 lds
    v_cvt_pk_bf16_f32 v76, v56, v58
    v_mov_b32 v77, 0
    v_mfma_f32_16x16x32_bf16 v[68:71], v[52:55], v[24:27], v[68:71]
    buffer_load_dwordx4 v1, s[4:7], s46 offen offset:3072 sc1 lds
    v_cvt_pk_bf16_f32 v78, v60, v62
    v_mov_b32 v79, 0
    ds_read_b128 v[40:43], v3 offset:28672
    ds_read_b128 v[44:47], v3 offset:29696
    ds_read_b128 v[48:51], v3 offset:30720
    ds_read_b128 v[52:55], v3 offset:31744
    v_max3_f32 v11, v28, v29, v30
    v_max3_f32 v11, v11, v31, v64
    v_max3_f32 v11, v11, v65, v68
    v_max3_f32 v11, v11, v69, v70
    v_max_f32 v11, v11, v71
    v_mov_b32 v66, v11
    v_mov_b32 v20, 0x3f803f80
    v_mov_b32 v21, 0x3f803f80
    v_permlane16_swap_b32 v11, v66
    v_max_f32 v11, v11, v66
    v_mov_b32 v66, v11
    v_mov_b64 v[22:23], v[20:21]
    v_mov_b32 v17, 0
    v_permlane32_swap_b32 v11, v66
    v_max_f32 v11, v11, v66
    v_mul_f32 v11, s51, v11
    v_fma_f32 v64, v64, s51, -v11
    v_fma_f32 v65, v65, s51, -v11
    v_exp_f32 v64, v64
    v_fma_f32 v68, v68, s51, -v11
    v_exp_f32 v65, v65
    v_fma_f32 v69, v69, s51, -v11
    v_exp_f32 v68, v68
    v_cvt_pk_bf16_f32 v16, v64, v65
    v_fma_f32 v70, v70, s51, -v11
    v_exp_f32 v69, v69
    v_fma_f32 v71, v71, s51, -v11
    v_exp_f32 v70, v70
    v_cvt_pk_bf16_f32 v12, v68, v69
    v_mfma_f32_16x16x16_bf16 v[24:27], v[20:21], v[16:17], 0
    v_fma_f32 v28, v28, s51, -v11
    v_exp_f32 v71, v71
    v_mfma_f32_16x16x16_bf16 v[56:59], v[76:77], v[16:17], 0
    v_fma_f32 v29, v29, s51, -v11
    v_exp_f32 v28, v28
    v_cvt_pk_bf16_f32 v13, v70, v71
    v_mfma_f32_16x16x16_bf16 v[60:63], v[78:79], v[16:17], 0
    v_fma_f32 v30, v30, s51, -v11
    v_exp_f32 v29, v29
    v_fma_f32 v31, v31, s51, -v11
    v_exp_f32 v30, v30
    v_exp_f32 v31, v31
    v_cvt_pk_bf16_f32 v14, v28, v29
    v_cvt_pk_bf16_f32 v15, v30, v31
    s_nop 1
    v_mfma_f32_16x16x32_bf16 v[24:27], v[20:23], v[12:15], v[24:27]
    v_mfma_f32_16x16x32_bf16 v[56:59], v[32:35], v[12:15], v[56:59]
    v_mfma_f32_16x16x32_bf16 v[60:63], v[36:39], v[12:15], v[60:63]
    v_mov_b64 v[12:13], 0
    v_mov_b64 v[14:15], 0
    v_mov_b64 v[16:17], 0
    v_mov_b64 v[18:19], 0
    v_mov_b64 v[20:21], 0
    v_mov_b64 v[22:23], 0
    v_rcp_f32 v11, v24
    s_mov_b32 exec_lo, 0xcccccccc
    s_mov_b32 exec_hi, 0xcccccccc
    v_mul_f32 v56, v56, v11
    v_mul_f32 v57, v57, v11
    v_mul_f32 v58, v58, v11
    v_mul_f32 v59, v59, v11
    v_cvt_pk_bf16_f32 v56, v56, v57
    v_cvt_pk_bf16_f32 v57, v58, v59
    ds_write_b64 v7, v[56:57] offset:0
    v_mul_f32 v60, v60, v11
    v_mul_f32 v61, v61, v11
    v_mul_f32 v62, v62, v11
    v_mul_f32 v63, v63, v11
    v_cvt_pk_bf16_f32 v60, v60, v61
    v_cvt_pk_bf16_f32 v61, v62, v63
    ds_write_b64 v7, v[60:61] offset:32
    s_mov_b64 exec, -1
    ds_read_b128 v[32:35], v3 offset:24576
    ds_read_b128 v[36:39], v3 offset:25600
    ds_read_b128 v[64:67], v3 offset:26624
    ds_read_b128 v[68:71], v3 offset:27648
    v_mov_b64 v[24:25], 0
    v_mov_b64 v[26:27], 0
    v_mov_b64 v[28:29], 0
    v_mov_b64 v[30:31], 0
    buffer_load_dwordx4 v1, s[4:7], s46 offen offset:0 sc1 lds
    buffer_load_dwordx4 v1, s[4:7], s46 offen offset:1024 sc1 lds
    s_waitcnt lgkmcnt(4)
    s_barrier
    ds_read_b128 v[56:59], v8 offset:0
    ds_read_b128 v[60:63], v8 offset:128
    s_waitcnt lgkmcnt(1)
    v_smfmac_f32_16x16x64_bf16 v[28:31], v[56:59], v[40:47], v2
    s_waitcnt lgkmcnt(0)
    v_smfmac_f32_16x16x64_bf16 v[28:31], v[60:63], v[48:55], v2
    v_smfmac_f32_16x16x64_bf16 v[12:15], v[56:59], a[208:215], v2
    v_smfmac_f32_16x16x64_bf16 v[12:15], v[60:63], a[216:223], v2
    v_smfmac_f32_16x16x64_bf16 v[16:19], v[56:59], a[224:231], v2
    v_smfmac_f32_16x16x64_bf16 v[16:19], v[60:63], a[232:239], v2
    v_smfmac_f32_16x16x64_bf16 v[20:23], v[56:59], a[240:247], v2
    v_smfmac_f32_16x16x64_bf16 v[20:23], v[60:63], a[248:255], v2
    s_nop 1
    v_add_f32 v28, v28, v29
    v_add_f32 v30, v30, v31
    v_smfmac_f32_16x16x64_bf16 v[24:27], v[56:59], v[32:39], v2
    v_cvt_pk_bf16_f32 v44, v28, v30
    v_or_b32 v44, 1, v44
    v_smfmac_f32_16x16x64_bf16 v[24:27], v[60:63], v[64:71], v2
    buffer_store_dword v44, v9, s[4:7], s44 offen
    v_add_f32 v12, v12, v13
    v_add_f32 v14, v14, v15
    v_cvt_pk_bf16_f32 v40, v12, v14
    v_or_b32 v40, 1, v40
    v_add_f32 v16, v16, v17
    v_add_f32 v18, v18, v19
    v_cvt_pk_bf16_f32 v41, v16, v18
    v_or_b32 v41, 1, v41
    v_add_f32 v20, v20, v21
    v_add_f32 v22, v22, v23
    v_cvt_pk_bf16_f32 v42, v20, v22
    v_or_b32 v42, 1, v42
    v_add_f32 v24, v24, v25
    v_add_f32 v26, v26, v27
    v_cvt_pk_bf16_f32 v43, v24, v26
    v_or_b32 v43, 1, v43
    buffer_store_dwordx4 v[40:43], v9, s[4:7], s43 offen
    v_add_u32 v11, s56, v0
    ds_write_b32 v11, v76 offset:26624
    ds_write_b32 v11, v78 offset:26880
    s_add_u32 s53, s32, 1
    s_and_b32 s53, s53, 3
    s_lshl_b32 s53, s53, 13
    s_add_u32 s38, s36, s53
    s_xor_b32 s53, s53, 0x4000
    s_add_u32 s55, s36, s53
    s_add_u32 s39, s39, 16384
    s_add_u32 s40, s40, 16384
    ds_read_b128 v[28:31], v1 offset:30720
    v_mov_b64 v[40:41], 0
    v_mov_b64 v[42:43], 0
    v_mov_b64 v[44:45], 0
    v_mov_b64 v[46:47], 0
    v_mov_b64 v[48:49], 0
    v_mov_b64 v[50:51], 0
    v_mov_b64 v[52:53], 0
    v_mov_b64 v[54:55], 0
    v_mov_b64 v[56:57], 0
    v_mov_b64 v[58:59], 0
    v_mov_b64 v[60:61], 0
    v_mov_b64 v[62:63], 0
    s_cmp_ge_u32 s42, 40
    s_cbranch_scc1 Lnored_53
    s_sleep 4
    buffer_load_dwordx4 v[64:67], v1, s[4:7], s45 offen offset:0 sc1
    buffer_load_dwordx4 v[68:71], v1, s[4:7], s45 offen offset:1024 sc1
    buffer_load_dwordx4 v[72:75], v1, s[4:7], s45 offen offset:2048 sc1
    buffer_load_dwordx4 v[76:79], v1, s[4:7], s45 offen offset:3072 sc1
    s_sleep 2
    buffer_load_dwordx4 v[12:15], v1, s[4:7], s45 offen offset:0 sc1
    buffer_load_dwordx4 v[16:19], v1, s[4:7], s45 offen offset:1024 sc1
    buffer_load_dwordx4 v[20:23], v1, s[4:7], s45 offen offset:2048 sc1
    buffer_load_dwordx4 v[24:27], v1, s[4:7], s45 offen offset:3072 sc1
    s_waitcnt lgkmcnt(0)
Lrd_55:
    v_mov_b32 v11, 1
    s_waitcnt vmcnt(7)
    v_mfma_f32_16x16x32_bf16 v[32:35], v[28:31], v[64:67], 0
    v_bitop3_b32 v11, v11, v64, v65 bitop3:0x80
    v_bitop3_b32 v11, v11, v66, v67 bitop3:0x80
    s_waitcnt vmcnt(6)
    v_mfma_f32_16x16x32_bf16 v[32:35], v[28:31], v[68:71], v[32:35]
    v_bitop3_b32 v11, v11, v68, v69 bitop3:0x80
    v_bitop3_b32 v11, v11, v70, v71 bitop3:0x80
    s_waitcnt vmcnt(5)
    v_mfma_f32_16x16x32_bf16 v[32:35], v[28:31], v[72:75], v[32:35]
    v_bitop3_b32 v11, v11, v72, v73 bitop3:0x80
    v_bitop3_b32 v11, v11, v74, v75 bitop3:0x80
    s_waitcnt vmcnt(4)
    v_mfma_f32_16x16x32_bf16 v[32:35], v[28:31], v[76:79], v[32:35]
    v_bitop3_b32 v11, v11, v76, v77 bitop3:0x80
    v_bitop3_b32 v11, v11, v78, v79 bitop3:0x80
    v_and_b32 v11, 1, v11
    v_cmp_ne_u32 vcc, 1, v11
    s_cbranch_vccnz Lrd2_57
Lrdok_56:
    s_nop 2
    v_add_f32_dpp v36, v32, v32 row_ror:8 row_mask:0xf bank_mask:0xf
    v_add_f32_dpp v37, v33, v33 row_ror:8 row_mask:0xf bank_mask:0xf
    v_add_f32_dpp v38, v34, v34 row_ror:8 row_mask:0xf bank_mask:0xf
    v_add_f32_dpp v39, v35, v35 row_ror:8 row_mask:0xf bank_mask:0xf
    s_mov_b32 exec_lo, 0x00ff00ff
    s_mov_b32 exec_hi, 0
    v_cvt_pk_bf16_f32 v32, v36, v37
    v_cvt_pk_bf16_f32 v33, v38, v39
    v_min_u32 v32, -2, v32
    v_min_u32 v33, -2, v33
    buffer_store_dwordx2 v[32:33], v10, s[4:7], s38 offen
    buffer_store_dwordx2 v[32:33], v10, s[4:7], s40 offen sc1
    v_mov_b64 v[34:35], -1
    buffer_store_dwordx2 v[34:35], v10, s[4:7], s55 offen
    s_mov_b64 exec, -1
Ljoin_54:
    s_barrier
    s_add_u32 s32, s32, 1
    v_add_u32 v37, s33, v1
    v_add_u32 v38, s34, v0
    s_sleep 3
    buffer_load_dwordx4 v[12:15], v37, s[4:7], s38 offen sc1
    buffer_load_dword v16, v38, s[4:7], s38 offen sc1
    s_sleep 2
    s_mov_b32 m0, s50
    buffer_load_dwordx4 v[20:23], v37, s[4:7], s38 offen sc1
    buffer_load_dword v24, v38, s[4:7], s38 offen sc1
    s_waitcnt vmcnt(2)
Lgl_58:
    v_max3_u32 v11, v12, v13, v14
    v_max3_u32 v11, v11, v15, v16
    v_cmp_eq_u32 vcc, -1, v11
    s_cbranch_vccnz Lglre_62
    ds_write_b128 v37, v[12:15] offset:16384
    ds_write_b32 v38, v16 offset:16384
Lglok_61:
    ds_read_b128 v[64:67], v3 offset:0
    ds_read_b128 v[68:71], v3 offset:1024
    ds_read_b128 v[72:75], v3 offset:2048
    ds_read_b128 v[76:79], v3 offset:3072
    s_waitcnt lgkmcnt(4)
    s_barrier
    s_waitcnt vmcnt(0)
    ds_read_b128 v[12:15], v1 offset:16384
    ds_read_b128 v[16:19], v1 offset:17408
    ds_read_b128 v[20:23], v1 offset:18432
    ds_read_b128 v[24:27], v1 offset:19456
    ds_read_b128 v[28:31], v1 offset:20480
    buffer_load_dwordx4 v[32:35], v37, s[4:7], s39 offen sc1
    buffer_load_dword v36, v38, s[4:7], s39 offen sc1
    s_waitcnt lgkmcnt(4)
    v_smfmac_f32_16x16x64_bf16 v[48:51], v[12:15], v[64:71], v2
    ds_read_b128 v[64:67], v3 offset:4096
    ds_read_b128 v[68:71], v3 offset:5120
    v_smfmac_f32_16x16x64_bf16 v[40:43], v[12:15], v[80:87], v2
    v_smfmac_f32_16x16x64_bf16 v[44:47], v[12:15], v[88:95], v2
    v_smfmac_f32_16x16x64_bf16 v[52:55], v[12:15], v[72:79], v2
    ds_read_b128 v[72:75], v3 offset:6144
    ds_read_b128 v[76:79], v3 offset:7168
    s_waitcnt lgkmcnt(7)
    v_smfmac_f32_16x16x64_bf16 v[40:43], v[16:19], v[96:103], v2
    v_smfmac_f32_16x16x64_bf16 v[48:51], v[16:19], v[224:231], v2
    v_smfmac_f32_16x16x64_bf16 v[44:47], v[16:19], v[104:111], v2
    v_smfmac_f32_16x16x64_bf16 v[52:55], v[16:19], v[232:239], v2
    s_waitcnt lgkmcnt(6)
    s_waitcnt lgkmcnt(2)
    v_smfmac_f32_16x16x64_bf16 v[48:51], v[20:23], v[64:71], v2
    ds_read_b128 v[64:67], v3 offset:8192
    ds_read_b128 v[68:71], v3 offset:9216
    v_smfmac_f32_16x16x64_bf16 v[40:43], v[20:23], v[112:119], v2
    v_smfmac_f32_16x16x64_bf16 v[44:47], v[20:23], v[120:127], v2
    s_waitcnt lgkmcnt(2)
    v_smfmac_f32_16x16x64_bf16 v[52:55], v[20:23], v[72:79], v2
    ds_read_b128 v[72:75], v3 offset:10240
    ds_read_b128 v[76:79], v3 offset:11264
    v_smfmac_f32_16x16x64_bf16 v[40:43], v[24:27], v[128:135], v2
    v_smfmac_f32_16x16x64_bf16 v[48:51], v[24:27], v[240:247], v2
    v_smfmac_f32_16x16x64_bf16 v[44:47], v[24:27], v[136:143], v2
    v_smfmac_f32_16x16x64_bf16 v[52:55], v[24:27], v[248:255], v2
    s_waitcnt lgkmcnt(2)
    v_smfmac_f32_16x16x64_bf16 v[48:51], v[28:31], v[64:71], v2
    ds_read_b128 v[64:67], v3 offset:12288
    ds_read_b128 v[68:71], v3 offset:13312
    v_smfmac_f32_16x16x64_bf16 v[40:43], v[28:31], v[144:151], v2
    v_smfmac_f32_16x16x64_bf16 v[44:47], v[28:31], v[152:159], v2
    s_waitcnt lgkmcnt(2)
    v_smfmac_f32_16x16x64_bf16 v[52:55], v[28:31], v[72:79], v2
    ds_read_b128 v[72:75], v3 offset:14336
    ds_read_b128 v[76:79], v3 offset:15360
    s_waitcnt vmcnt(0)
Lgr_63:
    v_max3_u32 v11, v32, v33, v34
    v_max3_u32 v11, v11, v35, v36
    v_cmp_eq_u32 vcc, -1, v11
    s_cbranch_vccnz Lgrre_64
    ds_write_b128 v37, v[32:35] offset:21504
    ds_write_b32 v38, v36 offset:21504
    v_smfmac_f32_16x16x64_bf16 v[56:59], v[12:15], a[80:87], v2
    s_cmp_ge_i32 s32, s58
    s_cbranch_scc1 Lkvo_69
Lkvok_66:
    s_mov_b32 m0, s35
    s_add_u32 s46, s46, 0x4000
    s_add_u32 s53, s46, 0x4000
    buffer_load_dword v4, s[4:7], s53 offen sc1 lds
    s_waitcnt lgkmcnt(4)
    v_smfmac_f32_16x16x64_bf16 v[56:59], v[16:19], v[64:71], v2
    ds_read_b128 v[64:67], v3 offset:16384
    ds_read_b128 v[68:71], v3 offset:17408
    v_smfmac_f32_16x16x64_bf16 v[60:63], v[12:15], a[88:95], v2
    s_waitcnt lgkmcnt(4)
    v_smfmac_f32_16x16x64_bf16 v[60:63], v[16:19], v[72:79], v2
    ds_read_b128 v[72:75], v3 offset:18432
    ds_read_b128 v[76:79], v3 offset:19456
    s_waitcnt lgkmcnt(4)
    s_barrier
    ds_read_b128 v[12:15], v1 offset:21504
    ds_read_b128 v[16:19], v1 offset:22528
    s_cmp_ge_u32 s32, s59
    s_cbranch_scc1 Lxt_70
Lxr_71:
    v_smfmac_f32_16x16x64_bf16 v[56:59], v[20:23], a[96:103], v2
    v_smfmac_f32_16x16x64_bf16 v[60:63], v[20:23], a[104:111], v2
    ds_read_b128 v[20:23], v1 offset:23552
    v_smfmac_f32_16x16x64_bf16 v[56:59], v[28:31], a[112:119], v2
    v_smfmac_f32_16x16x64_bf16 v[60:63], v[28:31], a[120:127], v2
    ds_read_b128 v[28:31], v1 offset:25600
    s_waitcnt lgkmcnt(6)
    v_smfmac_f32_16x16x64_bf16 v[56:59], v[24:27], v[64:71], v2
    ds_read_b128 v[64:67], v3 offset:20480
    ds_read_b128 v[68:71], v3 offset:21504
    s_waitcnt lgkmcnt(6)
    v_smfmac_f32_16x16x64_bf16 v[60:63], v[24:27], v[72:79], v2
    ds_read_b128 v[72:75], v3 offset:22528
    ds_read_b128 v[76:79], v3 offset:23552
    ds_read_b128 v[24:27], v1 offset:24576
    v_add_u32 v36, s56, v6
    ds_read_b64 v[38:39], v36 offset:26624
    s_waitcnt lgkmcnt(8)
    v_smfmac_f32_16x16x64_bf16 v[40:43], v[16:19], v[160:167], v2
    v_smfmac_f32_16x16x64_bf16 v[44:47], v[16:19], v[168:175], v2
    s_waitcnt lgkmcnt(7)
    v_smfmac_f32_16x16x64_bf16 v[40:43], v[20:23], v[176:183], v2
    v_smfmac_f32_16x16x64_bf16 v[44:47], v[20:23], v[184:191], v2
    s_waitcnt lgkmcnt(6)
    v_smfmac_f32_16x16x64_bf16 v[40:43], v[28:31], v[208:215], v2
    v_smfmac_f32_16x16x64_bf16 v[44:47], v[28:31], v[216:223], v2
    s_waitcnt lgkmcnt(0)
    buffer_store_dwordx2 v[38:39], v6, s[4:7], s48 offen sc1
    s_add_u32 s48, s48, s62
    s_mov_b32 s62, 0x2000
    v_smfmac_f32_16x16x64_bf16 v[40:43], v[12:15], v[64:71], v2
    v_smfmac_f32_16x16x64_bf16 v[44:47], v[12:15], v[72:79], v2
    v_smfmac_f32_16x16x64_bf16 v[40:43], v[24:27], v[192:199], v2
    v_smfmac_f32_16x16x64_bf16 v[44:47], v[24:27], v[200:207], v2
    v_smfmac_f32_16x16x64_bf16 v[48:51], v[12:15], a[0:7], v2
    ds_read_b128 v[64:67], v1 offset:4096
    v_smfmac_f32_16x16x64_bf16 v[52:55], v[12:15], a[8:15], v2
    ds_read_b128 v[68:71], v1 offset:5120
    v_smfmac_f32_16x16x64_bf16 v[48:51], v[16:19], a[16:23], v2
    ds_read_b128 v[72:75], v1 offset:6144
    v_smfmac_f32_16x16x64_bf16 v[52:55], v[16:19], a[24:31], v2
    ds_read_b128 v[76:79], v1 offset:7168
    v_smfmac_f32_16x16x64_bf16 v[48:51], v[20:23], a[32:39], v2
    v_smfmac_f32_16x16x64_bf16 v[52:55], v[20:23], a[40:47], v2
    v_smfmac_f32_16x16x64_bf16 v[48:51], v[24:27], a[48:55], v2
    v_add_f32 v40, v40, v41
    v_add_f32 v42, v42, v43
    v_smfmac_f32_16x16x64_bf16 v[52:55], v[24:27], a[56:63], v2
    v_add_f32 v44, v44, v45
    v_add_f32 v46, v46, v47
    v_smfmac_f32_16x16x64_bf16 v[48:51], v[28:31], a[64:71], v2
    v_cvt_pk_bf16_f32 v41, v40, v42
    v_smfmac_f32_16x16x64_bf16 v[52:55], v[28:31], a[72:79], v2
    v_cvt_pk_bf16_f32 v45, v44, v46
    v_smfmac_f32_16x16x64_bf16 v[56:59], v[12:15], a[128:135], v2
    v_smfmac_f32_16x16x64_bf16 v[60:63], v[12:15], a[136:143], v2
    v_smfmac_f32_16x16x64_bf16 v[56:59], v[16:19], a[144:151], v2
    v_smfmac_f32_16x16x64_bf16 v[60:63], v[16:19], a[152:159], v2
    s_nop 1
    v_add_f32 v48, v48, v49
    v_add_f32 v50, v50, v51
    v_cvt_pk_bf16_f32 v40, v48, v50
    ds_write_b64 v5, v[40:41] offset:0
    v_add_f32 v52, v52, v53
    v_add_f32 v54, v54, v55
    v_cvt_pk_bf16_f32 v44, v52, v54
    ds_write_b64 v5, v[44:45] offset:512
    v_smfmac_f32_16x16x64_bf16 v[56:59], v[20:23], a[160:167], v2
    v_smfmac_f32_16x16x64_bf16 v[60:63], v[20:23], a[168:175], v2
    v_smfmac_f32_16x16x64_bf16 v[56:59], v[24:27], a[176:183], v2
    v_smfmac_f32_16x16x64_bf16 v[60:63], v[24:27], a[184:191], v2
    s_waitcnt lgkmcnt(0)
    s_barrier
    ds_read_b64_tr_b16 v[12:13], v6 offset:26624
    ds_read_b64_tr_b16 v[14:15], v6 offset:27136
    ds_read_b64_tr_b16 v[16:17], v6 offset:27648
    ds_read_b64_tr_b16 v[18:19], v6 offset:28160
    v_smfmac_f32_16x16x64_bf16 v[56:59], v[28:31], a[192:199], v2
    ds_read_b64_tr_b16 v[20:21], v6 offset:28672
    ds_read_b64_tr_b16 v[22:23], v6 offset:29184
    ds_read_b64_tr_b16 v[24:25], v6 offset:29696
    ds_read_b64_tr_b16 v[26:27], v6 offset:30208
    v_smfmac_f32_16x16x64_bf16 v[60:63], v[28:31], a[200:207], v2
    ds_read_b128 v[40:43], v1 offset:0
    ds_read_b128 v[44:47], v1 offset:1024
    ds_read_b128 v[48:51], v1 offset:2048
    ds_read_b128 v[52:55], v1 offset:3072
    v_add_u32 v11, s47, v1
    ds_read_b128 v[32:35], v11
    ds_read_b128 v[36:39], v11 offset:1024
    s_waitcnt lgkmcnt(12)
    v_mfma_f32_16x16x32_bf16 v[28:31], v[64:67], v[12:15], 0
    s_waitcnt lgkmcnt(10)
    v_mfma_f32_16x16x32_bf16 v[28:31], v[68:71], v[16:19], v[28:31]
    s_waitcnt lgkmcnt(8)
    v_mfma_f32_16x16x32_bf16 v[28:31], v[72:75], v[20:23], v[28:31]
    s_waitcnt lgkmcnt(6)
    v_mfma_f32_16x16x32_bf16 v[28:31], v[76:79], v[24:27], v[28:31]
    v_mfma_f32_16x16x32_bf16 v[64:67], v[12:15], v[12:15], 0
    v_mfma_f32_16x16x32_bf16 v[64:67], v[16:19], v[16:19], v[64:67]
    v_mfma_f32_16x16x32_bf16 v[64:67], v[20:23], v[20:23], v[64:67]
    v_mfma_f32_16x16x32_bf16 v[64:67], v[24:27], v[24:27], v[64:67]
    s_waitcnt lgkmcnt(0)
    s_mov_b32 m0, s50
    s_barrier
    v_mfma_f32_16x16x32_bf16 v[68:71], v[40:43], v[12:15], 0
    v_add_f32 v56, v56, v57
    v_add_f32 v58, v58, v59
    v_mfma_f32_16x16x32_bf16 v[68:71], v[44:47], v[16:19], v[68:71]
    v_add_f32 v60, v60, v61
    v_add_f32 v62, v62, v63
    v_mfma_f32_16x16x32_bf16 v[68:71], v[48:51], v[20:23], v[68:71]
    buffer_load_dwordx4 v1, s[4:7], s46 offen offset:2048 sc1 lds
    v_cvt_pk_bf16_f32 v76, v56, v58
    v_mov_b32 v77, 0
    v_mfma_f32_16x16x32_bf16 v[68:71], v[52:55], v[24:27], v[68:71]
    buffer_load_dwordx4 v1, s[4:7], s46 offen offset:3072 sc1 lds
    v_cvt_pk_bf16_f32 v78, v60, v62
    v_mov_b32 v79, 0
    s_cmp_eq_u32 s32, 63
    s_cbranch_scc1 L_rec_last
    ds_read_b128 v[40:43], v3 offset:28672
    ds_read_b128 v[44:47], v3 offset:29696
    ds_read_b128 v[48:51], v3 offset:30720
    ds_read_b128 v[52:55], v3 offset:31744
    v_max3_f32 v11, v28, v29, v30
    v_max3_f32 v11, v11, v31, v64
    v_max3_f32 v11, v11, v65, v68
    v_max3_f32 v11, v11, v69, v70
    v_max_f32 v11, v11, v71
    v_mov_b32 v66, v11
    v_mov_b32 v20, 0x3f803f80
    v_mov_b32 v21, 0x3f803f80
    v_permlane16_swap_b32 v11, v66
    v_max_f32 v11, v11, v66
    v_mov_b32 v66, v11
    v_mov_b64 v[22:23], v[20:21]
    v_mov_b32 v17, 0
    v_permlane32_swap_b32 v11, v66
    v_max_f32 v11, v11, v66
    v_mul_f32 v11, s51, v11
    v_fma_f32 v64, v64, s51, -v11
    v_fma_f32 v65, v65, s51, -v11
    v_exp_f32 v64, v64
    v_fma_f32 v68, v68, s51, -v11
    v_exp_f32 v65, v65
    v_fma_f32 v69, v69, s51, -v11
    v_exp_f32 v68, v68
    v_cvt_pk_bf16_f32 v16, v64, v65
    v_fma_f32 v70, v70, s51, -v11
    v_exp_f32 v69, v69
    v_fma_f32 v71, v71, s51, -v11
    v_exp_f32 v70, v70
    v_cvt_pk_bf16_f32 v12, v68, v69
    v_mfma_f32_16x16x16_bf16 v[24:27], v[20:21], v[16:17], 0
    v_fma_f32 v28, v28, s51, -v11
    v_exp_f32 v71, v71
    v_mfma_f32_16x16x16_bf16 v[56:59], v[76:77], v[16:17], 0
    v_fma_f32 v29, v29, s51, -v11
    v_exp_f32 v28, v28
    v_cvt_pk_bf16_f32 v13, v70, v71
    v_mfma_f32_16x16x16_bf16 v[60:63], v[78:79], v[16:17], 0
    v_fma_f32 v30, v30, s51, -v11
    v_exp_f32 v29, v29
    v_fma_f32 v31, v31, s51, -v11
    v_exp_f32 v30, v30
    v_exp_f32 v31, v31
    v_cvt_pk_bf16_f32 v14, v28, v29
    v_cvt_pk_bf16_f32 v15, v30, v31
    s_nop 1
    v_mfma_f32_16x16x32_bf16 v[24:27], v[20:23], v[12:15], v[24:27]
    v_mfma_f32_16x16x32_bf16 v[56:59], v[32:35], v[12:15], v[56:59]
    v_mfma_f32_16x16x32_bf16 v[60:63], v[36:39], v[12:15], v[60:63]
    v_mov_b64 v[12:13], 0
    v_mov_b64 v[14:15], 0
    v_mov_b64 v[16:17], 0
    v_mov_b64 v[18:19], 0
    v_mov_b64 v[20:21], 0
    v_mov_b64 v[22:23], 0
    v_rcp_f32 v11, v24
    s_mov_b32 exec_lo, 0xcccccccc
    s_mov_b32 exec_hi, 0xcccccccc
    v_mul_f32 v56, v56, v11
    v_mul_f32 v57, v57, v11
    v_mul_f32 v58, v58, v11
    v_mul_f32 v59, v59, v11
    v_cvt_pk_bf16_f32 v56, v56, v57
    v_cvt_pk_bf16_f32 v57, v58, v59
    ds_write_b64 v7, v[56:57] offset:0
    v_mul_f32 v60, v60, v11
    v_mul_f32 v61, v61, v11
    v_mul_f32 v62, v62, v11
    v_mul_f32 v63, v63, v11
    v_cvt_pk_bf16_f32 v60, v60, v61
    v_cvt_pk_bf16_f32 v61, v62, v63
    ds_write_b64 v7, v[60:61] offset:32
    s_mov_b64 exec, -1
    ds_read_b128 v[32:35], v3 offset:24576
    ds_read_b128 v[36:39], v3 offset:25600
    ds_read_b128 v[64:67], v3 offset:26624
    ds_read_b128 v[68:71], v3 offset:27648
    v_mov_b64 v[24:25], 0
    v_mov_b64 v[26:27], 0
    v_mov_b64 v[28:29], 0
    v_mov_b64 v[30:31], 0
    buffer_load_dwordx4 v1, s[4:7], s46 offen offset:0 sc1 lds
    buffer_load_dwordx4 v1, s[4:7], s46 offen offset:1024 sc1 lds
    s_waitcnt lgkmcnt(4)
    s_barrier
    ds_read_b128 v[56:59], v8 offset:0
    ds_read_b128 v[60:63], v8 offset:128
    s_waitcnt lgkmcnt(1)
    v_smfmac_f32_16x16x64_bf16 v[28:31], v[56:59], v[40:47], v2
    s_waitcnt lgkmcnt(0)
    v_smfmac_f32_16x16x64_bf16 v[28:31], v[60:63], v[48:55], v2
    v_smfmac_f32_16x16x64_bf16 v[12:15], v[56:59], a[208:215], v2
    v_smfmac_f32_16x16x64_bf16 v[12:15], v[60:63], a[216:223], v2
    v_smfmac_f32_16x16x64_bf16 v[16:19], v[56:59], a[224:231], v2
    v_smfmac_f32_16x16x64_bf16 v[16:19], v[60:63], a[232:239], v2
    v_smfmac_f32_16x16x64_bf16 v[20:23], v[56:59], a[240:247], v2
    v_smfmac_f32_16x16x64_bf16 v[20:23], v[60:63], a[248:255], v2
    s_nop 1
    v_add_f32 v28, v28, v29
    v_add_f32 v30, v30, v31
    v_smfmac_f32_16x16x64_bf16 v[24:27], v[56:59], v[32:39], v2
    v_cvt_pk_bf16_f32 v44, v28, v30
    v_and_b32 v44, -2, v44
    v_smfmac_f32_16x16x64_bf16 v[24:27], v[60:63], v[64:71], v2
    buffer_store_dword v44, v9, s[4:7], s44 offen
    v_add_f32 v12, v12, v13
    v_add_f32 v14, v14, v15
    v_cvt_pk_bf16_f32 v40, v12, v14
    v_and_b32 v40, -2, v40
    v_add_f32 v16, v16, v17
    v_add_f32 v18, v18, v19
    v_cvt_pk_bf16_f32 v41, v16, v18
    v_and_b32 v41, -2, v41
    v_add_f32 v20, v20, v21
    v_add_f32 v22, v22, v23
    v_cvt_pk_bf16_f32 v42, v20, v22
    v_and_b32 v42, -2, v42
    v_add_f32 v24, v24, v25
    v_add_f32 v26, v26, v27
    v_cvt_pk_bf16_f32 v43, v24, v26
    v_and_b32 v43, -2, v43
    buffer_store_dwordx4 v[40:43], v9, s[4:7], s43 offen
    v_add_u32 v11, s56, v0
    ds_write_b32 v11, v76 offset:26624
    ds_write_b32 v11, v78 offset:26880
    s_add_u32 s53, s32, 1
    s_and_b32 s53, s53, 3
    s_lshl_b32 s53, s53, 13
    s_add_u32 s38, s36, s53
    s_xor_b32 s53, s53, 0x4000
    s_add_u32 s55, s36, s53
    s_add_u32 s39, s39, 16384
    s_add_u32 s40, s40, 16384
    ds_read_b128 v[28:31], v1 offset:30720
    v_mov_b64 v[40:41], 0
    v_mov_b64 v[42:43], 0
    v_mov_b64 v[44:45], 0
    v_mov_b64 v[46:47], 0
    v_mov_b64 v[48:49], 0
    v_mov_b64 v[50:51], 0
    v_mov_b64 v[52:53], 0
    v_mov_b64 v[54:55], 0
    v_mov_b64 v[56:57], 0
    v_mov_b64 v[58:59], 0
    v_mov_b64 v[60:61], 0
    v_mov_b64 v[62:63], 0
    s_cmp_ge_u32 s42, 40
    s_cbranch_scc1 Lnored_74
    s_sleep 4
    buffer_load_dwordx4 v[64:67], v1, s[4:7], s45 offen offset:0 sc1
    buffer_load_dwordx4 v[68:71], v1, s[4:7], s45 offen offset:1024 sc1
    buffer_load_dwordx4 v[72:75], v1, s[4:7], s45 offen offset:2048 sc1
    buffer_load_dwordx4 v[76:79], v1, s[4:7], s45 offen offset:3072 sc1
    s_sleep 2
    buffer_load_dwordx4 v[12:15], v1, s[4:7], s45 offen offset:0 sc1
    buffer_load_dwordx4 v[16:19], v1, s[4:7], s45 offen offset:1024 sc1
    buffer_load_dwordx4 v[20:23], v1, s[4:7], s45 offen offset:2048 sc1
    buffer_load_dwordx4 v[24:27], v1, s[4:7], s45 offen offset:3072 sc1
    s_waitcnt lgkmcnt(0)
Lrd_76:
    v_mov_b32 v11, 0
    s_waitcnt vmcnt(7)
    v_mfma_f32_16x16x32_bf16 v[32:35], v[28:31], v[64:67], 0
    v_or3_b32 v11, v11, v64, v65
    v_or3_b32 v11, v11, v66, v67
    s_waitcnt vmcnt(6)
    v_mfma_f32_16x16x32_bf16 v[32:35], v[28:31], v[68:71], v[32:35]
    v_or3_b32 v11, v11, v68, v69
    v_or3_b32 v11, v11, v70, v71
    s_waitcnt vmcnt(5)
    v_mfma_f32_16x16x32_bf16 v[32:35], v[28:31], v[72:75], v[32:35]
    v_or3_b32 v11, v11, v72, v73
    v_or3_b32 v11, v11, v74, v75
    s_waitcnt vmcnt(4)
    v_mfma_f32_16x16x32_bf16 v[32:35], v[28:31], v[76:79], v[32:35]
    v_or3_b32 v11, v11, v76, v77
    v_or3_b32 v11, v11, v78, v79
    v_and_b32 v11, 1, v11
    v_cmp_ne_u32 vcc, 0, v11
    s_cbranch_vccnz Lrd2_78
Lrdok_77:
    s_nop 2
    v_add_f32_dpp v36, v32, v32 row_ror:8 row_mask:0xf bank_mask:0xf
    v_add_f32_dpp v37, v33, v33 row_ror:8 row_mask:0xf bank_mask:0xf
    v_add_f32_dpp v38, v34, v34 row_ror:8 row_mask:0xf bank_mask:0xf
    v_add_f32_dpp v39, v35, v35 row_ror:8 row_mask:0xf bank_mask:0xf
    s_mov_b32 exec_lo, 0x00ff00ff
    s_mov_b32 exec_hi, 0
    v_cvt_pk_bf16_f32 v32, v36, v37
    v_cvt_pk_bf16_f32 v33, v38, v39
    v_min_u32 v32, -2, v32
    v_min_u32 v33, -2, v33
    buffer_store_dwordx2 v[32:33], v10, s[4:7], s38 offen
    buffer_store_dwordx2 v[32:33], v10, s[4:7], s40 offen sc1
    v_mov_b64 v[34:35], -1
    buffer_store_dwordx2 v[34:35], v10, s[4:7], s55 offen
    s_mov_b64 exec, -1
Ljoin_75:
    s_barrier
    s_add_u32 s32, s32, 1
    s_branch L_loop_fast1
L_ool_fast1:
Lrd2_57:
    buffer_load_dwordx4 v[64:67], v1, s[4:7], s45 offen offset:0 sc1
    buffer_load_dwordx4 v[68:71], v1, s[4:7], s45 offen offset:1024 sc1
    buffer_load_dwordx4 v[72:75], v1, s[4:7], s45 offen offset:2048 sc1
    buffer_load_dwordx4 v[76:79], v1, s[4:7], s45 offen offset:3072 sc1
    v_mov_b32 v11, 1
    s_waitcnt vmcnt(7)
    v_mfma_f32_16x16x32_bf16 v[32:35], v[28:31], v[12:15], 0
    v_bitop3_b32 v11, v11, v12, v13 bitop3:0x80
    v_bitop3_b32 v11, v11, v14, v15 bitop3:0x80
    s_waitcnt vmcnt(6)
    v_mfma_f32_16x16x32_bf16 v[32:35], v[28:31], v[16:19], v[32:35]
    v_bitop3_b32 v11, v11, v16, v17 bitop3:0x80
    v_bitop3_b32 v11, v11, v18, v19 bitop3:0x80
    s_waitcnt vmcnt(5)
    v_mfma_f32_16x16x32_bf16 v[32:35], v[28:31], v[20:23], v[32:35]
    v_bitop3_b32 v11, v11, v20, v21 bitop3:0x80
    v_bitop3_b32 v11, v11, v22, v23 bitop3:0x80
    s_waitcnt vmcnt(4)
    v_mfma_f32_16x16x32_bf16 v[32:35], v[28:31], v[24:27], v[32:35]
    v_bitop3_b32 v11, v11, v24, v25 bitop3:0x80
    v_bitop3_b32 v11, v11, v26, v27 bitop3:0x80
    v_and_b32 v11, 1, v11
    v_cmp_ne_u32 vcc, 1, v11
    s_cbranch_vccz Lrdok_56
    buffer_load_dwordx4 v[12:15], v1, s[4:7], s45 offen offset:0 sc1
    buffer_load_dwordx4 v[16:19], v1, s[4:7], s45 offen offset:1024 sc1
    buffer_load_dwordx4 v[20:23], v1, s[4:7], s45 offen offset:2048 sc1
    buffer_load_dwordx4 v[24:27], v1, s[4:7], s45 offen offset:3072 sc1
    s_add_u32 s74, s74, 1
    s_cmp_gt_u32 s74, 60000
    s_cbranch_scc1 L_abort
    s_branch Lrd_55
Lglre_46:
    buffer_load_dwordx4 v[12:15], v37, s[4:7], s38 offen sc1
    buffer_load_dword v16, v38, s[4:7], s38 offen sc1
    s_waitcnt vmcnt(2)
    v_max3_u32 v11, v20, v21, v22
    v_max3_u32 v11, v11, v23, v24
    v_cmp_eq_u32 vcc, -1, v11
    s_cbranch_vccz LglB_44
    buffer_load_dwordx4 v[20:23], v37, s[4:7], s38 offen sc1
    buffer_load_dword v24, v38, s[4:7], s38 offen sc1
    s_add_u32 s74, s74, 1
    s_cmp_gt_u32 s74, 60000
    s_cbranch_scc1 L_abort
    s_waitcnt vmcnt(2)
    s_branch Lgl_42
LglB_44:
    ds_write_b128 v37, v[20:23] offset:16384
    ds_write_b32 v38, v24 offset:16384
    s_branch Lglok_45
Lgrre_48:
    buffer_load_dwordx4 v[32:35], v37, s[4:7], s39 offen sc1
    buffer_load_dword v36, v38, s[4:7], s39 offen sc1
    s_add_u32 s74, s74, 1
    s_cmp_gt_u32 s74, 60000
    s_cbranch_scc1 L_abort
    s_waitcnt vmcnt(0)
    s_branch Lgr_47
Lnored_53:
    s_waitcnt lgkmcnt(0)
    s_branch Ljoin_54
Lxt_49:
    s_cmp_lg_u32 s63, 0
    s_cbranch_scc1 Lsg_79
    s_max_u32 s53, s32, 2
    s_sub_u32 s53, s53, 2
    s_mov_b64 exec, 1
    v_mov_b32 v11, s53
    s_mov_b32 s53, 0x5c00000
    buffer_store_dword v11, v0, s[4:7], s53 offen sc1
    s_mov_b64 exec, -1
Lsg_79:
    s_add_u32 s59, s32, 4
    s_min_u32 s59, s59, 59
    s_cmp_lt_u32 s32, 59
    s_cbranch_scc1 Lxr_50
    s_cmp_lg_u32 s28, 2
    s_cbranch_scc1 Lsg_80
    s_lshl_b32 s53, s30, 7
    s_lshl_b32 s54, s29, 2
    s_add_u32 s53, s53, s54
    s_add_u32 s53, s53, 0x5c00080
    s_sub_u32 s54, s32, 1
    s_mov_b64 exec, 1
    v_mov_b32 v11, s54
    buffer_store_dword v11, v0, s[4:7], s53 offen sc1
    s_mov_b64 exec, -1
Lsg_80:
    s_branch Lxr_50
Lrd2_78:
    buffer_load_dwordx4 v[64:67], v1, s[4:7], s45 offen offset:0 sc1
    buffer_load_dwordx4 v[68:71], v1, s[4:7], s45 offen offset:1024 sc1
    buffer_load_dwordx4 v[72:75], v1, s[4:7], s45 offen offset:2048 sc1
    buffer_load_dwordx4 v[76:79], v1, s[4:7], s45 offen offset:3072 sc1
    v_mov_b32 v11, 0
    s_waitcnt vmcnt(7)
    v_mfma_f32_16x16x32_bf16 v[32:35], v[28:31], v[12:15], 0
    v_or3_b32 v11, v11, v12, v13
    v_or3_b32 v11, v11, v14, v15
    s_waitcnt vmcnt(6)
    v_mfma_f32_16x16x32_bf16 v[32:35], v[28:31], v[16:19], v[32:35]
    v_or3_b32 v11, v11, v16, v17
    v_or3_b32 v11, v11, v18, v19
    s_waitcnt vmcnt(5)
    v_mfma_f32_16x16x32_bf16 v[32:35], v[28:31], v[20:23], v[32:35]
    v_or3_b32 v11, v11, v20, v21
    v_or3_b32 v11, v11, v22, v23
    s_waitcnt vmcnt(4)
    v_mfma_f32_16x16x32_bf16 v[32:35], v[28:31], v[24:27], v[32:35]
    v_or3_b32 v11, v11, v24, v25
    v_or3_b32 v11, v11, v26, v27
    v_and_b32 v11, 1, v11
    v_cmp_ne_u32 vcc, 0, v11
    s_cbranch_vccz Lrdok_77
    buffer_load_dwordx4 v[12:15], v1, s[4:7], s45 offen offset:0 sc1
    buffer_load_dwordx4 v[16:19], v1, s[4:7], s45 offen offset:1024 sc1
    buffer_load_dwordx4 v[20:23], v1, s[4:7], s45 offen offset:2048 sc1
    buffer_load_dwordx4 v[24:27], v1, s[4:7], s45 offen offset:3072 sc1
    s_add_u32 s74, s74, 1
    s_cmp_gt_u32 s74, 60000
    s_cbranch_scc1 L_abort
    s_branch Lrd_76
Lglre_62:
    buffer_load_dwordx4 v[12:15], v37, s[4:7], s38 offen sc1
    buffer_load_dword v16, v38, s[4:7], s38 offen sc1
    s_waitcnt vmcnt(2)
    v_max3_u32 v11, v20, v21, v22
    v_max3_u32 v11, v11, v23, v24
    v_cmp_eq_u32 vcc, -1, v11
    s_cbranch_vccz LglB_60
    buffer_load_dwordx4 v[20:23], v37, s[4:7], s38 offen sc1
    buffer_load_dword v24, v38, s[4:7], s38 offen sc1
    s_add_u32 s74, s74, 1
    s_cmp_gt_u32 s74, 60000
    s_cbranch_scc1 L_abort
    s_waitcnt vmcnt(2)
    s_branch Lgl_58
LglB_60:
    ds_write_b128 v37, v[20:23] offset:16384
    ds_write_b32 v38, v24 offset:16384
    s_branch Lglok_61
Lgrre_64:
    buffer_load_dwordx4 v[32:35], v37, s[4:7], s39 offen sc1
    buffer_load_dword v36, v38, s[4:7], s39 offen sc1
    s_add_u32 s74, s74, 1
    s_cmp_gt_u32 s74, 60000
    s_cbranch_scc1 L_abort
    s_waitcnt vmcnt(0)
    s_branch Lgr_63
Lnored_74:
    s_waitcnt lgkmcnt(0)
    s_branch Ljoin_75
Lkvo_69:
    s_add_u32 s54, s32, 3
    s_lshr_b32 s54, s54, 2
    s_cmp_ge_u32 s54, s49
    s_cbranch_scc1 Lkvn_68
    s_mov_b32 m0, s37
    s_mov_b32 exec_hi, 0
    buffer_load_dword v0, s[24:27], 0 offen sc1 lds
    s_mov_b32 exec_hi, -1
    s_branch Lkvok_66
Lkvn_68:
    v_add_u32 v11, s37, v0
    ds_read_b32 v11, v11
    s_waitcnt lgkmcnt(0)
    s_branch Lkvu_67
Lkv_65:
    buffer_load_dword v11, v0, s[24:27], 0 offen sc1
    s_waitcnt vmcnt(0)
Lkvu_67:
    v_and_b32 v11, 0x3ff, v11
    v_cmp_le_u32 vcc, 128, v11
    s_nop 3
    s_lshr_b32 s49, vcc_lo, 16
    s_ff0_i32_b32 s49, s49
    s_cmp_eq_u32 s49, 16
    s_cmov_b32 s49, 18
    s_lshl_b32 s58, s49, 2
    s_sub_u32 s58, s58, 5
    s_cmp_lt_u32 s54, s49
    s_cbranch_scc1 Lkvok_66
    s_add_u32 s74, s74, 1
    s_cmp_gt_u32 s74, 60000
    s_cbranch_scc1 L_abort
    s_sleep 2
    s_branch Lkv_65
Lxt_70:
    s_cmp_lg_u32 s63, 0
    s_cbranch_scc1 Lsg_81
    s_max_u32 s53, s32, 2
    s_sub_u32 s53, s53, 2
    s_mov_b64 exec, 1
    v_mov_b32 v11, s53
    s_mov_b32 s53, 0x5c00000
    buffer_store_dword v11, v0, s[4:7], s53 offen sc1
    s_mov_b64 exec, -1
Lsg_81:
    s_add_u32 s59, s32, 4
    s_min_u32 s59, s59, 59
    s_cmp_lt_u32 s32, 59
    s_cbranch_scc1 Lxr_71
    s_cmp_lg_u32 s28, 2
    s_cbranch_scc1 Lsg_82
    s_lshl_b32 s53, s30, 7
    s_lshl_b32 s54, s29, 2
    s_add_u32 s53, s53, s54
    s_add_u32 s53, s53, 0x5c00080
    s_sub_u32 s54, s32, 1
    s_mov_b64 exec, 1
    v_mov_b32 v11, s54
    buffer_store_dword v11, v0, s[4:7], s53 offen sc1
    s_mov_b64 exec, -1
Lsg_82:
    s_branch Lxr_71
L_loop_slow0:
    v_add_u32 v37, s33, v1
    v_add_u32 v38, s34, v0
    s_sleep 3
    buffer_load_dwordx4 v[12:15], v37, s[4:7], s38 offen sc1
    buffer_load_dword v16, v38, s[4:7], s38 offen sc1
    s_sleep 2
    s_mov_b32 m0, s50
    buffer_load_dwordx4 v[20:23], v37, s[4:7], s38 offen sc1
    buffer_load_dword v24, v38, s[4:7], s38 offen sc1
    s_waitcnt vmcnt(2)
Lgl_83:
    v_max3_u32 v11, v12, v13, v14
    v_max3_u32 v11, v11, v15, v16
    v_cmp_eq_u32 vcc, -1, v11
    s_cbranch_vccnz Lglre_87
    ds_write_b128 v37, v[12:15] offset:16384
    ds_write_b32 v38, v16 offset:16384
Lglok_86:
    ds_read_b128 v[64:67], v3 offset:0
    ds_read_b128 v[68:71], v3 offset:1024
    ds_read_b128 v[72:75], v3 offset:2048
    ds_read_b128 v[76:79], v3 offset:3072
    s_waitcnt lgkmcnt(4)
    s_barrier
    s_waitcnt vmcnt(0)
    ds_read_b128 v[12:15], v1 offset:16384
    ds_read_b128 v[16:19], v1 offset:17408
    ds_read_b128 v[20:23], v1 offset:18432
    ds_read_b128 v[24:27], v1 offset:19456
    ds_read_b128 v[28:31], v1 offset:20480
    buffer_load_dwordx4 v[32:35], v37, s[4:7], s39 offen sc1
    buffer_load_dword v36, v38, s[4:7], s39 offen sc1
    s_waitcnt lgkmcnt(4)
    v_smfmac_f32_16x16x64_bf16 v[48:51], v[12:15], v[64:71], v2
    ds_read_b128 v[64:67], v3 offset:4096
    ds_read_b128 v[68:71], v3 offset:5120
    v_smfmac_f32_16x16x64_bf16 v[40:43], v[12:15], v[80:87], v2
    v_smfmac_f32_16x16x64_bf16 v[44:47], v[12:15], v[88:95], v2
    v_smfmac_f32_16x16x64_bf16 v[52:55], v[12:15], v[72:79], v2
    ds_read_b128 v[72:75], v3 offset:6144
    ds_read_b128 v[76:79], v3 offset:7168
    s_waitcnt lgkmcnt(7)
    v_smfmac_f32_16x16x64_bf16 v[40:43], v[16:19], v[96:103], v2
    v_smfmac_f32_16x16x64_bf16 v[48:51], v[16:19], v[224:231], v2
    v_smfmac_f32_16x16x64_bf16 v[44:47], v[16:19], v[104:111], v2
    v_smfmac_f32_16x16x64_bf16 v[52:55], v[16:19], v[232:239], v2
    s_waitcnt lgkmcnt(6)
    s_waitcnt lgkmcnt(2)
    v_smfmac_f32_16x16x64_bf16 v[48:51], v[20:23], v[64:71], v2
    ds_read_b128 v[64:67], v3 offset:8192
    ds_read_b128 v[68:71], v3 offset:9216
    v_smfmac_f32_16x16x64_bf16 v[40:43], v[20:23], v[112:119], v2
    v_smfmac_f32_16x16x64_bf16 v[44:47], v[20:23], v[120:127], v2
    s_waitcnt lgkmcnt(2)
    v_smfmac_f32_16x16x64_bf16 v[52:55], v[20:23], v[72:79], v2
    ds_read_b128 v[72:75], v3 offset:10240
    ds_read_b128 v[76:79], v3 offset:11264
    v_smfmac_f32_16x16x64_bf16 v[40:43], v[24:27], v[128:135], v2
    v_smfmac_f32_16x16x64_bf16 v[48:51], v[24:27], v[240:247], v2
    v_smfmac_f32_16x16x64_bf16 v[44:47], v[24:27], v[136:143], v2
    v_smfmac_f32_16x16x64_bf16 v[52:55], v[24:27], v[248:255], v2
    s_waitcnt lgkmcnt(2)
    v_smfmac_f32_16x16x64_bf16 v[48:51], v[28:31], v[64:71], v2
    ds_read_b128 v[64:67], v3 offset:12288
    ds_read_b128 v[68:71], v3 offset:13312
    v_smfmac_f32_16x16x64_bf16 v[40:43], v[28:31], v[144:151], v2
    v_smfmac_f32_16x16x64_bf16 v[44:47], v[28:31], v[152:159], v2
    s_waitcnt lgkmcnt(2)
    v_smfmac_f32_16x16x64_bf16 v[52:55], v[28:31], v[72:79], v2
    ds_read_b128 v[72:75], v3 offset:14336
    ds_read_b128 v[76:79], v3 offset:15360
    s_waitcnt vmcnt(0)
Lgr_88:
    v_max3_u32 v11, v32, v33, v34
    v_max3_u32 v11, v11, v35, v36
    v_cmp_eq_u32 vcc, -1, v11
    s_cbranch_vccnz Lgrre_89
    ds_write_b128 v37, v[32:35] offset:21504
    ds_write_b32 v38, v36 offset:21504
    v_smfmac_f32_16x16x64_bf16 v[56:59], v[12:15], a[80:87], v2
    s_mov_b32 m0, s35
    s_add_u32 s46, s46, 0x4000
    s_add_u32 s53, s46, 0x4000
    buffer_load_dword v4, s[4:7], s53 offen sc1 lds
    s_waitcnt lgkmcnt(4)
    v_smfmac_f32_16x16x64_bf16 v[56:59], v[16:19], v[64:71], v2
    ds_read_b128 v[64:67], v3 offset:16384
    ds_read_b128 v[68:71], v3 offset:17408
    v_smfmac_f32_16x16x64_bf16 v[60:63], v[12:15], a[88:95], v2
    s_waitcnt lgkmcnt(4)
    v_smfmac_f32_16x16x64_bf16 v[60:63], v[16:19], v[72:79], v2
    ds_read_b128 v[72:75], v3 offset:18432
    ds_read_b128 v[76:79], v3 offset:19456
    s_waitcnt lgkmcnt(4)
    s_barrier
    ds_read_b128 v[12:15], v1 offset:21504
    ds_read_b128 v[16:19], v1 offset:22528
    s_cmp_ge_u32 s32, s59
    s_cbranch_scc1 Lxt_90
Lxr_91:
    v_smfmac_f32_16x16x64_bf16 v[56:59], v[20:23], a[96:103], v2
    v_smfmac_f32_16x16x64_bf16 v[60:63], v[20:23], a[104:111], v2
    ds_read_b128 v[20:23], v1 offset:23552
    v_smfmac_f32_16x16x64_bf16 v[56:59], v[28:31], a[112:119], v2
    v_smfmac_f32_16x16x64_bf16 v[60:63], v[28:31], a[120:127], v2
    ds_read_b128 v[28:31], v1 offset:25600
    s_waitcnt lgkmcnt(6)
    v_smfmac_f32_16x16x64_bf16 v[56:59], v[24:27], v[64:71], v2
    ds_read_b128 v[64:67], v3 offset:20480
    ds_read_b128 v[68:71], v3 offset:21504
    s_waitcnt lgkmcnt(6)
    v_smfmac_f32_16x16x64_bf16 v[60:63], v[24:27], v[72:79], v2
    ds_read_b128 v[72:75], v3 offset:22528
    ds_read_b128 v[76:79], v3 offset:23552
    ds_read_b128 v[24:27], v1 offset:24576
    v_add_u32 v36, s56, v6
    ds_read_b64_tr_b16 v[32:33], v36 offset:26624
    ds_read_b64_tr_b16 v[34:35], v36 offset:27136
    s_waitcnt lgkmcnt(9)
    v_smfmac_f32_16x16x64_bf16 v[40:43], v[16:19], v[160:167], v2
    v_smfmac_f32_16x16x64_bf16 v[44:47], v[16:19], v[168:175], v2
    s_waitcnt lgkmcnt(8)
    v_smfmac_f32_16x16x64_bf16 v[40:43], v[20:23], v[176:183], v2
    v_smfmac_f32_16x16x64_bf16 v[44:47], v[20:23], v[184:191], v2
    s_waitcnt lgkmcnt(7)
    v_smfmac_f32_16x16x64_bf16 v[40:43], v[28:31], v[208:215], v2
    v_smfmac_f32_16x16x64_bf16 v[44:47], v[28:31], v[216:223], v2
    s_waitcnt lgkmcnt(0)
    buffer_store_dwordx4 v[32:35], v1, s[4:7], s48 offen sc1
    s_add_u32 s48, s48, s62
    s_mov_b32 s62, 0x2000
    v_smfmac_f32_16x16x64_bf16 v[40:43], v[12:15], v[64:71], v2
    v_smfmac_f32_16x16x64_bf16 v[44:47], v[12:15], v[72:79], v2
    v_smfmac_f32_16x16x64_bf16 v[40:43], v[24:27], v[192:199], v2
    v_smfmac_f32_16x16x64_bf16 v[44:47], v[24:27], v[200:207], v2
    v_smfmac_f32_16x16x64_bf16 v[48:51], v[12:15], a[0:7], v2
    ds_read_b128 v[64:67], v1 offset:4096
    v_smfmac_f32_16x16x64_bf16 v[52:55], v[12:15], a[8:15], v2
    ds_read_b128 v[68:71], v1 offset:5120
    v_smfmac_f32_16x16x64_bf16 v[48:51], v[16:19], a[16:23], v2
    ds_read_b128 v[72:75], v1 offset:6144
    v_smfmac_f32_16x16x64_bf16 v[52:55], v[16:19], a[24:31], v2
    ds_read_b128 v[76:79], v1 offset:7168
    v_smfmac_f32_16x16x64_bf16 v[48:51], v[20:23], a[32:39], v2
    v_smfmac_f32_16x16x64_bf16 v[52:55], v[20:23], a[40:47], v2
    v_smfmac_f32_16x16x64_bf16 v[48:51], v[24:27], a[48:55], v2
    v_add_f32 v40, v40, v41
    v_add_f32 v42, v42, v43
    v_smfmac_f32_16x16x64_bf16 v[52:55], v[24:27], a[56:63], v2
    v_add_f32 v44, v44, v45
    v_add_f32 v46, v46, v47
    v_smfmac_f32_16x16x64_bf16 v[48:51], v[28:31], a[64:71], v2
    v_cvt_pk_bf16_f32 v41, v40, v42
    v_smfmac_f32_16x16x64_bf16 v[52:55], v[28:31], a[72:79], v2
    v_cvt_pk_bf16_f32 v45, v44, v46
    v_smfmac_f32_16x16x64_bf16 v[56:59], v[12:15], a[128:135], v2
    v_smfmac_f32_16x16x64_bf16 v[60:63], v[12:15], a[136:143], v2
    v_smfmac_f32_16x16x64_bf16 v[56:59], v[16:19], a[144:151], v2
    v_smfmac_f32_16x16x64_bf16 v[60:63], v[16:19], a[152:159], v2
    s_nop 1
    v_add_f32 v48, v48, v49
    v_add_f32 v50, v50, v51
    v_cvt_pk_bf16_f32 v40, v48, v50
    ds_write_b64 v5, v[40:41] offset:0
    v_add_f32 v52, v52, v53
    v_add_f32 v54, v54, v55
    v_cvt_pk_bf16_f32 v44, v52, v54
    ds_write_b64 v5, v[44:45] offset:512
    v_smfmac_f32_16x16x64_bf16 v[56:59], v[20:23], a[160:167], v2
    v_smfmac_f32_16x16x64_bf16 v[60:63], v[20:23], a[168:175], v2
    v_smfmac_f32_16x16x64_bf16 v[56:59], v[24:27], a[176:183], v2
    v_smfmac_f32_16x16x64_bf16 v[60:63], v[24:27], a[184:191], v2
    s_waitcnt lgkmcnt(0)
    s_barrier
    ds_read_b64_tr_b16 v[12:13], v6 offset:26624
    ds_read_b64_tr_b16 v[14:15], v6 offset:27136
    ds_read_b64_tr_b16 v[16:17], v6 offset:27648
    ds_read_b64_tr_b16 v[18:19], v6 offset:28160
    v_smfmac_f32_16x16x64_bf16 v[56:59], v[28:31], a[192:199], v2
    ds_read_b64_tr_b16 v[20:21], v6 offset:28672
    ds_read_b64_tr_b16 v[22:23], v6 offset:29184
    ds_read_b64_tr_b16 v[24:25], v6 offset:29696
    ds_read_b64_tr_b16 v[26:27], v6 offset:30208
    v_smfmac_f32_16x16x64_bf16 v[60:63], v[28:31], a[200:207], v2
    ds_read_b128 v[40:43], v1 offset:0
    ds_read_b128 v[44:47], v1 offset:1024
    ds_read_b128 v[48:51], v1 offset:2048
    ds_read_b128 v[52:55], v1 offset:3072
    v_add_u32 v11, s47, v1
    ds_read_b128 v[32:35], v11
    ds_read_b128 v[36:39], v11 offset:1024
    s_waitcnt lgkmcnt(12)
    v_mfma_f32_16x16x32_bf16 v[28:31], v[64:67], v[12:15], 0
    s_waitcnt lgkmcnt(10)
    v_mfma_f32_16x16x32_bf16 v[28:31], v[68:71], v[16:19], v[28:31]
    s_waitcnt lgkmcnt(8)
    v_mfma_f32_16x16x32_bf16 v[28:31], v[72:75], v[20:23], v[28:31]
    s_waitcnt lgkmcnt(6)
    v_mfma_f32_16x16x32_bf16 v[28:31], v[76:79], v[24:27], v[28:31]
    v_mfma_f32_16x16x32_bf16 v[64:67], v[12:15], v[12:15], 0
    v_mfma_f32_16x16x32_bf16 v[64:67], v[16:19], v[16:19], v[64:67]
    v_mfma_f32_16x16x32_bf16 v[64:67], v[20:23], v[20:23], v[64:67]
    v_mfma_f32_16x16x32_bf16 v[64:67], v[24:27], v[24:27], v[64:67]
    s_waitcnt lgkmcnt(0)
    s_mov_b32 m0, s50
    s_barrier
    v_mfma_f32_16x16x32_bf16 v[68:71], v[40:43], v[12:15], 0
    v_add_f32 v56, v56, v57
    v_add_f32 v58, v58, v59
    v_mfma_f32_16x16x32_bf16 v[68:71], v[44:47], v[16:19], v[68:71]
    v_add_f32 v60, v60, v61
    v_add_f32 v62, v62, v63
    v_mfma_f32_16x16x32_bf16 v[68:71], v[48:51], v[20:23], v[68:71]
    buffer_load_dwordx4 v1, s[4:7], s46 offen offset:2048 sc1 lds
    v_cvt_pk_bf16_f32 v76, v56, v58
    v_mov_b32 v77, 0
    v_mfma_f32_16x16x32_bf16 v[68:71], v[52:55], v[24:27], v[68:71]
    buffer_load_dwordx4 v1, s[4:7], s46 offen offset:3072 sc1 lds
    v_cvt_pk_bf16_f32 v78, v60, v62
    v_mov_b32 v79, 0
    ds_read_b128 v[40:43], v3 offset:28672
    ds_read_b128 v[44:47], v3 offset:29696
    ds_read_b128 v[48:51], v3 offset:30720
    ds_read_b128 v[52:55], v3 offset:31744
    v_max3_f32 v11, v28, v29, v30
    v_max3_f32 v11, v11, v31, v64
    v_max3_f32 v11, v11, v65, v68
    v_max3_f32 v11, v11, v69, v70
    v_max_f32 v11, v11, v71
    v_mov_b32 v66, v11
    v_mov_b32 v20, 0x3f803f80
    v_mov_b32 v21, 0x3f803f80
    v_permlane16_swap_b32 v11, v66
    v_max_f32 v11, v11, v66
    v_mov_b32 v66, v11
    v_mov_b64 v[22:23], v[20:21]
    v_mov_b32 v17, 0
    v_permlane32_swap_b32 v11, v66
    v_max_f32 v11, v11, v66
    v_mul_f32 v11, s51, v11
    v_fma_f32 v64, v64, s51, -v11
    v_fma_f32 v65, v65, s51, -v11
    v_exp_f32 v64, v64
    v_fma_f32 v68, v68, s51, -v11
    v_exp_f32 v65, v65
    v_fma_f32 v69, v69, s51, -v11
    v_exp_f32 v68, v68
    v_cvt_pk_bf16_f32 v16, v64, v65
    v_fma_f32 v70, v70, s51, -v11
    v_exp_f32 v69, v69
    v_fma_f32 v71, v71, s51, -v11
    v_exp_f32 v70, v70
    v_cvt_pk_bf16_f32 v12, v68, v69
    v_mfma_f32_16x16x16_bf16 v[24:27], v[20:21], v[16:17], 0
    v_fma_f32 v28, v28, s51, -v11
    v_exp_f32 v71, v71
    v_mfma_f32_16x16x16_bf16 v[56:59], v[76:77], v[16:17], 0
    v_fma_f32 v29, v29, s51, -v11
    v_exp_f32 v28, v28
    v_cvt_pk_bf16_f32 v13, v70, v71
    v_mfma_f32_16x16x16_bf16 v[60:63], v[78:79], v[16:17], 0
    v_fma_f32 v30, v30, s51, -v11
    v_exp_f32 v29, v29
    v_fma_f32 v31, v31, s51, -v11
    v_exp_f32 v30, v30
    v_exp_f32 v31, v31
    v_cvt_pk_bf16_f32 v14, v28, v29
    v_cvt_pk_bf16_f32 v15, v30, v31
    s_nop 1
    v_mfma_f32_16x16x32_bf16 v[24:27], v[20:23], v[12:15], v[24:27]
    v_mfma_f32_16x16x32_bf16 v[56:59], v[32:35], v[12:15], v[56:59]
    v_mfma_f32_16x16x32_bf16 v[60:63], v[36:39], v[12:15], v[60:63]
    v_mov_b64 v[12:13], 0
    v_mov_b64 v[14:15], 0
    v_mov_b64 v[16:17], 0
    v_mov_b64 v[18:19], 0
    v_mov_b64 v[20:21], 0
    v_mov_b64 v[22:23], 0
    v_rcp_f32 v11, v24
    s_mov_b32 exec_lo, 0xcccccccc
    s_mov_b32 exec_hi, 0xcccccccc
    v_mul_f32 v56, v56, v11
    v_mul_f32 v57, v57, v11
    v_mul_f32 v58, v58, v11
    v_mul_f32 v59, v59, v11
    v_cvt_pk_bf16_f32 v56, v56, v57
    v_cvt_pk_bf16_f32 v57, v58, v59
    ds_write_b64 v7, v[56:57] offset:0
    v_mul_f32 v60, v60, v11
    v_mul_f32 v61, v61, v11
    v_mul_f32 v62, v62, v11
    v_mul_f32 v63, v63, v11
    v_cvt_pk_bf16_f32 v60, v60, v61
    v_cvt_pk_bf16_f32 v61, v62, v63
    ds_write_b64 v7, v[60:61] offset:32
    s_mov_b64 exec, -1
    ds_read_b128 v[32:35], v3 offset:24576
    ds_read_b128 v[36:39], v3 offset:25600
    ds_read_b128 v[64:67], v3 offset:26624
    ds_read_b128 v[68:71], v3 offset:27648
    v_mov_b64 v[24:25], 0
    v_mov_b64 v[26:27], 0
    v_mov_b64 v[28:29], 0
    v_mov_b64 v[30:31], 0
    buffer_load_dwordx4 v1, s[4:7], s46 offen offset:0 sc1 lds
    buffer_load_dwordx4 v1, s[4:7], s46 offen offset:1024 sc1 lds
    s_waitcnt lgkmcnt(4)
    s_barrier
    ds_read_b128 v[56:59], v8 offset:0
    ds_read_b128 v[60:63], v8 offset:128
    s_waitcnt lgkmcnt(1)
    v_smfmac_f32_16x16x64_bf16 v[28:31], v[56:59], v[40:47], v2
    s_waitcnt lgkmcnt(0)
    v_smfmac_f32_16x16x64_bf16 v[28:31], v[60:63], v[48:55], v2
    v_smfmac_f32_16x16x64_bf16 v[12:15], v[56:59], a[208:215], v2
    v_smfmac_f32_16x16x64_bf16 v[12:15], v[60:63], a[216:223], v2
    v_smfmac_f32_16x16x64_bf16 v[16:19], v[56:59], a[224:231], v2
    v_smfmac_f32_16x16x64_bf16 v[16:19], v[60:63], a[232:239], v2
    v_smfmac_f32_16x16x64_bf16 v[20:23], v[56:59], a[240:247], v2
    v_smfmac_f32_16x16x64_bf16 v[20:23], v[60:63], a[248:255], v2
    s_nop 1
    v_add_f32 v28, v28, v29
    v_add_f32 v30, v30, v31
    v_smfmac_f32_16x16x64_bf16 v[24:27], v[56:59], v[32:39], v2
    v_cvt_pk_bf16_f32 v44, v28, v30
    v_or_b32 v44, 1, v44
    v_smfmac_f32_16x16x64_bf16 v[24:27], v[60:63], v[64:71], v2
    buffer_store_dword v44, v9, s[4:7], s44 offen sc1
    v_add_f32 v12, v12, v13
    v_add_f32 v14, v14, v15
    v_cvt_pk_bf16_f32 v40, v12, v14
    v_or_b32 v40, 1, v40
    v_add_f32 v16, v16, v17
    v_add_f32 v18, v18, v19
    v_cvt_pk_bf16_f32 v41, v16, v18
    v_or_b32 v41, 1, v41
    v_add_f32 v20, v20, v21
    v_add_f32 v22, v22, v23
    v_cvt_pk_bf16_f32 v42, v20, v22
    v_or_b32 v42, 1, v42
    v_add_f32 v24, v24, v25
    v_add_f32 v26, v26, v27
    v_cvt_pk_bf16_f32 v43, v24, v26
    v_or_b32 v43, 1, v43
    buffer_store_dwordx4 v[40:43], v9, s[4:7], s43 offen sc1
    s_add_u32 s53, s32, 1
    s_and_b32 s53, s53, 3
    s_lshl_b32 s53, s53, 13
    s_add_u32 s38, s36, s53
    s_xor_b32 s53, s53, 0x4000
    s_add_u32 s55, s36, s53
    s_add_u32 s39, s39, 16384
    s_add_u32 s40, s40, 16384
    ds_read_b128 v[28:31], v1 offset:30720
    v_mov_b64 v[40:41], 0
    v_mov_b64 v[42:43], 0
    v_mov_b64 v[44:45], 0
    v_mov_b64 v[46:47], 0
    v_mov_b64 v[48:49], 0
    v_mov_b64 v[50:51], 0
    v_mov_b64 v[52:53], 0
    v_mov_b64 v[54:55], 0
    v_mov_b64 v[56:57], 0
    v_mov_b64 v[58:59], 0
    v_mov_b64 v[60:61], 0
    v_mov_b64 v[62:63], 0
    s_cmp_ge_u32 s42, 40
    s_cbranch_scc1 Lnored_94
    s_sleep 4
    buffer_load_dwordx4 v[64:67], v1, s[4:7], s45 offen offset:0 sc1
    buffer_load_dwordx4 v[68:71], v1, s[4:7], s45 offen offset:1024 sc1
    buffer_load_dwordx4 v[72:75], v1, s[4:7], s45 offen offset:2048 sc1
    buffer_load_dwordx4 v[76:79], v1, s[4:7], s45 offen offset:3072 sc1
    s_sleep 2
    buffer_load_dwordx4 v[12:15], v1, s[4:7], s45 offen offset:0 sc1
    buffer_load_dwordx4 v[16:19], v1, s[4:7], s45 offen offset:1024 sc1
    buffer_load_dwordx4 v[20:23], v1, s[4:7], s45 offen offset:2048 sc1
    buffer_load_dwordx4 v[24:27], v1, s[4:7], s45 offen offset:3072 sc1
    s_waitcnt lgkmcnt(0)
Lrd_96:
    v_mov_b32 v11, 1
    s_waitcnt vmcnt(7)
    v_mfma_f32_16x16x32_bf16 v[32:35], v[28:31], v[64:67], 0
    v_bitop3_b32 v11, v11, v64, v65 bitop3:0x80
    v_bitop3_b32 v11, v11, v66, v67 bitop3:0x80
    s_waitcnt vmcnt(6)
    v_mfma_f32_16x16x32_bf16 v[32:35], v[28:31], v[68:71], v[32:35]
    v_bitop3_b32 v11, v11, v68, v69 bitop3:0x80
    v_bitop3_b32 v11, v11, v70, v71 bitop3:0x80
    s_waitcnt vmcnt(5)
    v_mfma_f32_16x16x32_bf16 v[32:35], v[28:31], v[72:75], v[32:35]
    v_bitop3_b32 v11, v11, v72, v73 bitop3:0x80
    v_bitop3_b32 v11, v11, v74, v75 bitop3:0x80
    s_waitcnt vmcnt(4)
    v_mfma_f32_16x16x32_bf16 v[32:35], v[28:31], v[76:79], v[32:35]
    v_bitop3_b32 v11, v11, v76, v77 bitop3:0x80
    v_bitop3_b32 v11, v11, v78, v79 bitop3:0x80
    v_and_b32 v11, 1, v11
    v_cmp_ne_u32 vcc, 1, v11
    s_cbranch_vccnz Lrd2_98
Lrdok_97:
    s_nop 2
    v_add_f32_dpp v36, v32, v32 row_ror:8 row_mask:0xf bank_mask:0xf
    v_add_f32_dpp v37, v33, v33 row_ror:8 row_mask:0xf bank_mask:0xf
    v_add_f32_dpp v38, v34, v34 row_ror:8 row_mask:0xf bank_mask:0xf
    v_add_f32_dpp v39, v35, v35 row_ror:8 row_mask:0xf bank_mask:0xf
    s_mov_b32 exec_lo, 0x00ff00ff
    s_mov_b32 exec_hi, 0
    v_cvt_pk_bf16_f32 v32, v36, v37
    v_cvt_pk_bf16_f32 v33, v38, v39
    v_min_u32 v32, -2, v32
    v_min_u32 v33, -2, v33
    buffer_store_dwordx2 v[32:33], v10, s[4:7], s38 offen sc1
    buffer_store_dwordx2 v[32:33], v10, s[4:7], s40 offen sc1
    v_mov_b64 v[34:35], -1
    buffer_store_dwordx2 v[34:35], v10, s[4:7], s55 offen sc1
    s_mov_b64 exec, -1
Ljoin_95:
    s_barrier
    s_add_u32 s32, s32, 1
    v_add_u32 v37, s33, v1
    v_add_u32 v38, s34, v0
    s_sleep 3
    buffer_load_dwordx4 v[12:15], v37, s[4:7], s38 offen sc1
    buffer_load_dword v16, v38, s[4:7], s38 offen sc1
    s_sleep 2
    s_mov_b32 m0, s50
    buffer_load_dwordx4 v[20:23], v37, s[4:7], s38 offen sc1
    buffer_load_dword v24, v38, s[4:7], s38 offen sc1
    s_waitcnt vmcnt(2)
Lgl_99:
    v_max3_u32 v11, v12, v13, v14
    v_max3_u32 v11, v11, v15, v16
    v_cmp_eq_u32 vcc, -1, v11
    s_cbranch_vccnz Lglre_103
    ds_write_b128 v37, v[12:15] offset:16384
    ds_write_b32 v38, v16 offset:16384
Lglok_102:
    ds_read_b128 v[64:67], v3 offset:0
    ds_read_b128 v[68:71], v3 offset:1024
    ds_read_b128 v[72:75], v3 offset:2048
    ds_read_b128 v[76:79], v3 offset:3072
    s_waitcnt lgkmcnt(4)
    s_barrier
    s_waitcnt vmcnt(0)
    ds_read_b128 v[12:15], v1 offset:16384
    ds_read_b128 v[16:19], v1 offset:17408
    ds_read_b128 v[20:23], v1 offset:18432
    ds_read_b128 v[24:27], v1 offset:19456
    ds_read_b128 v[28:31], v1 offset:20480
    buffer_load_dwordx4 v[32:35], v37, s[4:7], s39 offen sc1
    buffer_load_dword v36, v38, s[4:7], s39 offen sc1
    s_waitcnt lgkmcnt(4)
    v_smfmac_f32_16x16x64_bf16 v[48:51], v[12:15], v[64:71], v2
    ds_read_b128 v[64:67], v3 offset:4096
    ds_read_b128 v[68:71], v3 offset:5120
    v_smfmac_f32_16x16x64_bf16 v[40:43], v[12:15], v[80:87], v2
    v_smfmac_f32_16x16x64_bf16 v[44:47], v[12:15], v[88:95], v2
    v_smfmac_f32_16x16x64_bf16 v[52:55], v[12:15], v[72:79], v2
    ds_read_b128 v[72:75], v3 offset:6144
    ds_read_b128 v[76:79], v3 offset:7168
    s_waitcnt lgkmcnt(7)
    v_smfmac_f32_16x16x64_bf16 v[40:43], v[16:19], v[96:103], v2
    v_smfmac_f32_16x16x64_bf16 v[48:51], v[16:19], v[224:231], v2
    v_smfmac_f32_16x16x64_bf16 v[44:47], v[16:19], v[104:111], v2
    v_smfmac_f32_16x16x64_bf16 v[52:55], v[16:19], v[232:239], v2
    s_waitcnt lgkmcnt(6)
    s_waitcnt lgkmcnt(2)
    v_smfmac_f32_16x16x64_bf16 v[48:51], v[20:23], v[64:71], v2
    ds_read_b128 v[64:67], v3 offset:8192
    ds_read_b128 v[68:71], v3 offset:9216
    v_smfmac_f32_16x16x64_bf16 v[40:43], v[20:23], v[112:119], v2
    v_smfmac_f32_16x16x64_bf16 v[44:47], v[20:23], v[120:127], v2
    s_waitcnt lgkmcnt(2)
    v_smfmac_f32_16x16x64_bf16 v[52:55], v[20:23], v[72:79], v2
    ds_read_b128 v[72:75], v3 offset:10240
    ds_read_b128 v[76:79], v3 offset:11264
    v_smfmac_f32_16x16x64_bf16 v[40:43], v[24:27], v[128:135], v2
    v_smfmac_f32_16x16x64_bf16 v[48:51], v[24:27], v[240:247], v2
    v_smfmac_f32_16x16x64_bf16 v[44:47], v[24:27], v[136:143], v2
    v_smfmac_f32_16x16x64_bf16 v[52:55], v[24:27], v[248:255], v2
    s_waitcnt lgkmcnt(2)
    v_smfmac_f32_16x16x64_bf16 v[48:51], v[28:31], v[64:71], v2
    ds_read_b128 v[64:67], v3 offset:12288
    ds_read_b128 v[68:71], v3 offset:13312
    v_smfmac_f32_16x16x64_bf16 v[40:43], v[28:31], v[144:151], v2
    v_smfmac_f32_16x16x64_bf16 v[44:47], v[28:31], v[152:159], v2
    s_waitcnt lgkmcnt(2)
    v_smfmac_f32_16x16x64_bf16 v[52:55], v[28:31], v[72:79], v2
    ds_read_b128 v[72:75], v3 offset:14336
    ds_read_b128 v[76:79], v3 offset:15360
    s_waitcnt vmcnt(0)
Lgr_104:
    v_max3_u32 v11, v32, v33, v34
    v_max3_u32 v11, v11, v35, v36
    v_cmp_eq_u32 vcc, -1, v11
    s_cbranch_vccnz Lgrre_105
    ds_write_b128 v37, v[32:35] offset:21504
    ds_write_b32 v38, v36 offset:21504
    v_smfmac_f32_16x16x64_bf16 v[56:59], v[12:15], a[80:87], v2
    s_cmp_ge_i32 s32, s58
    s_cbranch_scc1 Lkvo_110
Lkvok_107:
    s_mov_b32 m0, s35
    s_add_u32 s46, s46, 0x4000
    s_add_u32 s53, s46, 0x4000
    buffer_load_dword v4, s[4:7], s53 offen sc1 lds
    s_waitcnt lgkmcnt(4)
    v_smfmac_f32_16x16x64_bf16 v[56:59], v[16:19], v[64:71], v2
    ds_read_b128 v[64:67], v3 offset:16384
    ds_read_b128 v[68:71], v3 offset:17408
    v_smfmac_f32_16x16x64_bf16 v[60:63], v[12:15], a[88:95], v2
    s_waitcnt lgkmcnt(4)
    v_smfmac_f32_16x16x64_bf16 v[60:63], v[16:19], v[72:79], v2
    ds_read_b128 v[72:75], v3 offset:18432
    ds_read_b128 v[76:79], v3 offset:19456
    s_waitcnt lgkmcnt(4)
    s_barrier
    ds_read_b128 v[12:15], v1 offset:21504
    ds_read_b128 v[16:19], v1 offset:22528
    s_cmp_ge_u32 s32, s59
    s_cbranch_scc1 Lxt_111
Lxr_112:
    v_smfmac_f32_16x16x64_bf16 v[56:59], v[20:23], a[96:103], v2
    v_smfmac_f32_16x16x64_bf16 v[60:63], v[20:23], a[104:111], v2
    ds_read_b128 v[20:23], v1 offset:23552
    v_smfmac_f32_16x16x64_bf16 v[56:59], v[28:31], a[112:119], v2
    v_smfmac_f32_16x16x64_bf16 v[60:63], v[28:31], a[120:127], v2
    ds_read_b128 v[28:31], v1 offset:25600
    s_waitcnt lgkmcnt(6)
    v_smfmac_f32_16x16x64_bf16 v[56:59], v[24:27], v[64:71], v2
    ds_read_b128 v[64:67], v3 offset:20480
    ds_read_b128 v[68:71], v3 offset:21504
    s_waitcnt lgkmcnt(6)
    v_smfmac_f32_16x16x64_bf16 v[60:63], v[24:27], v[72:79], v2
    ds_read_b128 v[72:75], v3 offset:22528
    ds_read_b128 v[76:79], v3 offset:23552
    ds_read_b128 v[24:27], v1 offset:24576
    v_add_u32 v36, s56, v6
    ds_read_b64_tr_b16 v[32:33], v36 offset:26624
    ds_read_b64_tr_b16 v[34:35], v36 offset:27136
    s_waitcnt lgkmcnt(9)
    v_smfmac_f32_16x16x64_bf16 v[40:43], v[16:19], v[160:167], v2
    v_smfmac_f32_16x16x64_bf16 v[44:47], v[16:19], v[168:175], v2
    s_waitcnt lgkmcnt(8)
    v_smfmac_f32_16x16x64_bf16 v[40:43], v[20:23], v[176:183], v2
    v_smfmac_f32_16x16x64_bf16 v[44:47], v[20:23], v[184:191], v2
    s_waitcnt lgkmcnt(7)
    v_smfmac_f32_16x16x64_bf16 v[40:43], v[28:31], v[208:215], v2
    v_smfmac_f32_16x16x64_bf16 v[44:47], v[28:31], v[216:223], v2
    s_waitcnt lgkmcnt(0)
    buffer_store_dwordx4 v[32:35], v1, s[4:7], s48 offen sc1
    s_add_u32 s48, s48, s62
    s_mov_b32 s62, 0x2000
    v_smfmac_f32_16x16x64_bf16 v[40:43], v[12:15], v[64:71], v2
    v_smfmac_f32_16x16x64_bf16 v[44:47], v[12:15], v[72:79], v2
    v_smfmac_f32_16x16x64_bf16 v[40:43], v[24:27], v[192:199], v2
    v_smfmac_f32_16x16x64_bf16 v[44:47], v[24:27], v[200:207], v2
    v_smfmac_f32_16x16x64_bf16 v[48:51], v[12:15], a[0:7], v2
    ds_read_b128 v[64:67], v1 offset:4096
    v_smfmac_f32_16x16x64_bf16 v[52:55], v[12:15], a[8:15], v2
    ds_read_b128 v[68:71], v1 offset:5120
    v_smfmac_f32_16x16x64_bf16 v[48:51], v[16:19], a[16:23], v2
    ds_read_b128 v[72:75], v1 offset:6144
    v_smfmac_f32_16x16x64_bf16 v[52:55], v[16:19], a[24:31], v2
    ds_read_b128 v[76:79], v1 offset:7168
    v_smfmac_f32_16x16x64_bf16 v[48:51], v[20:23], a[32:39], v2
    v_smfmac_f32_16x16x64_bf16 v[52:55], v[20:23], a[40:47], v2
    v_smfmac_f32_16x16x64_bf16 v[48:51], v[24:27], a[48:55], v2
    v_add_f32 v40, v40, v41
    v_add_f32 v42, v42, v43
    v_smfmac_f32_16x16x64_bf16 v[52:55], v[24:27], a[56:63], v2
    v_add_f32 v44, v44, v45
    v_add_f32 v46, v46, v47
    v_smfmac_f32_16x16x64_bf16 v[48:51], v[28:31], a[64:71], v2
    v_cvt_pk_bf16_f32 v41, v40, v42
    v_smfmac_f32_16x16x64_bf16 v[52:55], v[28:31], a[72:79], v2
    v_cvt_pk_bf16_f32 v45, v44, v46
    v_smfmac_f32_16x16x64_bf16 v[56:59], v[12:15], a[128:135], v2
    v_smfmac_f32_16x16x64_bf16 v[60:63], v[12:15], a[136:143], v2
    v_smfmac_f32_16x16x64_bf16 v[56:59], v[16:19], a[144:151], v2
    v_smfmac_f32_16x16x64_bf16 v[60:63], v[16:19], a[152:159], v2
    s_nop 1
    v_add_f32 v48, v48, v49
    v_add_f32 v50, v50, v51
    v_cvt_pk_bf16_f32 v40, v48, v50
    ds_write_b64 v5, v[40:41] offset:0
    v_add_f32 v52, v52, v53
    v_add_f32 v54, v54, v55
    v_cvt_pk_bf16_f32 v44, v52, v54
    ds_write_b64 v5, v[44:45] offset:512
    v_smfmac_f32_16x16x64_bf16 v[56:59], v[20:23], a[160:167], v2
    v_smfmac_f32_16x16x64_bf16 v[60:63], v[20:23], a[168:175], v2
    v_smfmac_f32_16x16x64_bf16 v[56:59], v[24:27], a[176:183], v2
    v_smfmac_f32_16x16x64_bf16 v[60:63], v[24:27], a[184:191], v2
    s_waitcnt lgkmcnt(0)
    s_barrier
    ds_read_b64_tr_b16 v[12:13], v6 offset:26624
    ds_read_b64_tr_b16 v[14:15], v6 offset:27136
    ds_read_b64_tr_b16 v[16:17], v6 offset:27648
    ds_read_b64_tr_b16 v[18:19], v6 offset:28160
    v_smfmac_f32_16x16x64_bf16 v[56:59], v[28:31], a[192:199], v2
    ds_read_b64_tr_b16 v[20:21], v6 offset:28672
    ds_read_b64_tr_b16 v[22:23], v6 offset:29184
    ds_read_b64_tr_b16 v[24:25], v6 offset:29696
    ds_read_b64_tr_b16 v[26:27], v6 offset:30208
    v_smfmac_f32_16x16x64_bf16 v[60:63], v[28:31], a[200:207], v2
    ds_read_b128 v[40:43], v1 offset:0
    ds_read_b128 v[44:47], v1 offset:1024
    ds_read_b128 v[48:51], v1 offset:2048
    ds_read_b128 v[52:55], v1 offset:3072
    v_add_u32 v11, s47, v1
    ds_read_b128 v[32:35], v11
    ds_read_b128 v[36:39], v11 offset:1024
    s_waitcnt lgkmcnt(12)
    v_mfma_f32_16x16x32_bf16 v[28:31], v[64:67], v[12:15], 0
    s_waitcnt lgkmcnt(10)
    v_mfma_f32_16x16x32_bf16 v[28:31], v[68:71], v[16:19], v[28:31]
    s_waitcnt lgkmcnt(8)
    v_mfma_f32_16x16x32_bf16 v[28:31], v[72:75], v[20:23], v[28:31]
    s_waitcnt lgkmcnt(6)
    v_mfma_f32_16x16x32_bf16 v[28:31], v[76:79], v[24:27], v[28:31]
    v_mfma_f32_16x16x32_bf16 v[64:67], v[12:15], v[12:15], 0
    v_mfma_f32_16x16x32_bf16 v[64:67], v[16:19], v[16:19], v[64:67]
    v_mfma_f32_16x16x32_bf16 v[64:67], v[20:23], v[20:23], v[64:67]
    v_mfma_f32_16x16x32_bf16 v[64:67], v[24:27], v[24:27], v[64:67]
    s_waitcnt lgkmcnt(0)
    s_mov_b32 m0, s50
    s_barrier
    v_mfma_f32_16x16x32_bf16 v[68:71], v[40:43], v[12:15], 0
    v_add_f32 v56, v56, v57
    v_add_f32 v58, v58, v59
    v_mfma_f32_16x16x32_bf16 v[68:71], v[44:47], v[16:19], v[68:71]
    v_add_f32 v60, v60, v61
    v_add_f32 v62, v62, v63
    v_mfma_f32_16x16x32_bf16 v[68:71], v[48:51], v[20:23], v[68:71]
    buffer_load_dwordx4 v1, s[4:7], s46 offen offset:2048 sc1 lds
    v_cvt_pk_bf16_f32 v76, v56, v58
    v_mov_b32 v77, 0
    v_mfma_f32_16x16x32_bf16 v[68:71], v[52:55], v[24:27], v[68:71]
    buffer_load_dwordx4 v1, s[4:7], s46 offen offset:3072 sc1 lds
    v_cvt_pk_bf16_f32 v78, v60, v62
    v_mov_b32 v79, 0
    s_cmp_eq_u32 s32, 63
    s_cbranch_scc1 L_rec_last
    ds_read_b128 v[40:43], v3 offset:28672
    ds_read_b128 v[44:47], v3 offset:29696
    ds_read_b128 v[48:51], v3 offset:30720
    ds_read_b128 v[52:55], v3 offset:31744
    v_max3_f32 v11, v28, v29, v30
    v_max3_f32 v11, v11, v31, v64
    v_max3_f32 v11, v11, v65, v68
    v_max3_f32 v11, v11, v69, v70
    v_max_f32 v11, v11, v71
    v_mov_b32 v66, v11
    v_mov_b32 v20, 0x3f803f80
    v_mov_b32 v21, 0x3f803f80
    v_permlane16_swap_b32 v11, v66
    v_max_f32 v11, v11, v66
    v_mov_b32 v66, v11
    v_mov_b64 v[22:23], v[20:21]
    v_mov_b32 v17, 0
    v_permlane32_swap_b32 v11, v66
    v_max_f32 v11, v11, v66
    v_mul_f32 v11, s51, v11
    v_fma_f32 v64, v64, s51, -v11
    v_fma_f32 v65, v65, s51, -v11
    v_exp_f32 v64, v64
    v_fma_f32 v68, v68, s51, -v11
    v_exp_f32 v65, v65
    v_fma_f32 v69, v69, s51, -v11
    v_exp_f32 v68, v68
    v_cvt_pk_bf16_f32 v16, v64, v65
    v_fma_f32 v70, v70, s51, -v11
    v_exp_f32 v69, v69
    v_fma_f32 v71, v71, s51, -v11
    v_exp_f32 v70, v70
    v_cvt_pk_bf16_f32 v12, v68, v69
    v_mfma_f32_16x16x16_bf16 v[24:27], v[20:21], v[16:17], 0
    v_fma_f32 v28, v28, s51, -v11
    v_exp_f32 v71, v71
    v_mfma_f32_16x16x16_bf16 v[56:59], v[76:77], v[16:17], 0
    v_fma_f32 v29, v29, s51, -v11
    v_exp_f32 v28, v28
    v_cvt_pk_bf16_f32 v13, v70, v71
    v_mfma_f32_16x16x16_bf16 v[60:63], v[78:79], v[16:17], 0
    v_fma_f32 v30, v30, s51, -v11
    v_exp_f32 v29, v29
    v_fma_f32 v31, v31, s51, -v11
    v_exp_f32 v30, v30
    v_exp_f32 v31, v31
    v_cvt_pk_bf16_f32 v14, v28, v29
    v_cvt_pk_bf16_f32 v15, v30, v31
    s_nop 1
    v_mfma_f32_16x16x32_bf16 v[24:27], v[20:23], v[12:15], v[24:27]
    v_mfma_f32_16x16x32_bf16 v[56:59], v[32:35], v[12:15], v[56:59]
    v_mfma_f32_16x16x32_bf16 v[60:63], v[36:39], v[12:15], v[60:63]
    v_mov_b64 v[12:13], 0
    v_mov_b64 v[14:15], 0
    v_mov_b64 v[16:17], 0
    v_mov_b64 v[18:19], 0
    v_mov_b64 v[20:21], 0
    v_mov_b64 v[22:23], 0
    v_rcp_f32 v11, v24
    s_mov_b32 exec_lo, 0xcccccccc
    s_mov_b32 exec_hi, 0xcccccccc
    v_mul_f32 v56, v56, v11
    v_mul_f32 v57, v57, v11
    v_mul_f32 v58, v58, v11
    v_mul_f32 v59, v59, v11
    v_cvt_pk_bf16_f32 v56, v56, v57
    v_cvt_pk_bf16_f32 v57, v58, v59
    ds_write_b64 v7, v[56:57] offset:0
    v_mul_f32 v60, v60, v11
    v_mul_f32 v61, v61, v11
    v_mul_f32 v62, v62, v11
    v_mul_f32 v63, v63, v11
    v_cvt_pk_bf16_f32 v60, v60, v61
    v_cvt_pk_bf16_f32 v61, v62, v63
    ds_write_b64 v7, v[60:61] offset:32
    s_mov_b64 exec, -1
    ds_read_b128 v[32:35], v3 offset:24576
    ds_read_b128 v[36:39], v3 offset:25600
    ds_read_b128 v[64:67], v3 offset:26624
    ds_read_b128 v[68:71], v3 offset:27648
    v_mov_b64 v[24:25], 0
    v_mov_b64 v[26:27], 0
    v_mov_b64 v[28:29], 0
    v_mov_b64 v[30:31], 0
    buffer_load_dwordx4 v1, s[4:7], s46 offen offset:0 sc1 lds
    buffer_load_dwordx4 v1, s[4:7], s46 offen offset:1024 sc1 lds
    s_waitcnt lgkmcnt(4)
    s_barrier
    ds_read_b128 v[56:59], v8 offset:0
    ds_read_b128 v[60:63], v8 offset:128
    s_waitcnt lgkmcnt(1)
    v_smfmac_f32_16x16x64_bf16 v[28:31], v[56:59], v[40:47], v2
    s_waitcnt lgkmcnt(0)
    v_smfmac_f32_16x16x64_bf16 v[28:31], v[60:63], v[48:55], v2
    v_smfmac_f32_16x16x64_bf16 v[12:15], v[56:59], a[208:215], v2
    v_smfmac_f32_16x16x64_bf16 v[12:15], v[60:63], a[216:223], v2
    v_smfmac_f32_16x16x64_bf16 v[16:19], v[56:59], a[224:231], v2
    v_smfmac_f32_16x16x64_bf16 v[16:19], v[60:63], a[232:239], v2
    v_smfmac_f32_16x16x64_bf16 v[20:23], v[56:59], a[240:247], v2
    v_smfmac_f32_16x16x64_bf16 v[20:23], v[60:63], a[248:255], v2
    s_nop 1
    v_add_f32 v28, v28, v29
    v_add_f32 v30, v30, v31
    v_smfmac_f32_16x16x64_bf16 v[24:27], v[56:59], v[32:39], v2
    v_cvt_pk_bf16_f32 v44, v28, v30
    v_and_b32 v44, -2, v44
    v_smfmac_f32_16x16x64_bf16 v[24:27], v[60:63], v[64:71], v2
    buffer_store_dword v44, v9, s[4:7], s44 offen sc1
    v_add_f32 v12, v12, v13
    v_add_f32 v14, v14, v15
    v_cvt_pk_bf16_f32 v40, v12, v14
    v_and_b32 v40, -2, v40
    v_add_f32 v16, v16, v17
    v_add_f32 v18, v18, v19
    v_cvt_pk_bf16_f32 v41, v16, v18
    v_and_b32 v41, -2, v41
    v_add_f32 v20, v20, v21
    v_add_f32 v22, v22, v23
    v_cvt_pk_bf16_f32 v42, v20, v22
    v_and_b32 v42, -2, v42
    v_add_f32 v24, v24, v25
    v_add_f32 v26, v26, v27
    v_cvt_pk_bf16_f32 v43, v24, v26
    v_and_b32 v43, -2, v43
    buffer_store_dwordx4 v[40:43], v9, s[4:7], s43 offen sc1
    s_add_u32 s53, s32, 1
    s_and_b32 s53, s53, 3
    s_lshl_b32 s53, s53, 13
    s_add_u32 s38, s36, s53
    s_xor_b32 s53, s53, 0x4000
    s_add_u32 s55, s36, s53
    s_add_u32 s39, s39, 16384
    s_add_u32 s40, s40, 16384
    ds_read_b128 v[28:31], v1 offset:30720
    v_mov_b64 v[40:41], 0
    v_mov_b64 v[42:43], 0
    v_mov_b64 v[44:45], 0
    v_mov_b64 v[46:47], 0
    v_mov_b64 v[48:49], 0
    v_mov_b64 v[50:51], 0
    v_mov_b64 v[52:53], 0
    v_mov_b64 v[54:55], 0
    v_mov_b64 v[56:57], 0
    v_mov_b64 v[58:59], 0
    v_mov_b64 v[60:61], 0
    v_mov_b64 v[62:63], 0
    s_cmp_ge_u32 s42, 40
    s_cbranch_scc1 Lnored_115
    s_sleep 4
    buffer_load_dwordx4 v[64:67], v1, s[4:7], s45 offen offset:0 sc1
    buffer_load_dwordx4 v[68:71], v1, s[4:7], s45 offen offset:1024 sc1
    buffer_load_dwordx4 v[72:75], v1, s[4:7], s45 offen offset:2048 sc1
    buffer_load_dwordx4 v[76:79], v1, s[4:7], s45 offen offset:3072 sc1
    s_sleep 2
    buffer_load_dwordx4 v[12:15], v1, s[4:7], s45 offen offset:0 sc1
    buffer_load_dwordx4 v[16:19], v1, s[4:7], s45 offen offset:1024 sc1
    buffer_load_dwordx4 v[20:23], v1, s[4:7], s45 offen offset:2048 sc1
    buffer_load_dwordx4 v[24:27], v1, s[4:7], s45 offen offset:3072 sc1
    s_waitcnt lgkmcnt(0)
Lrd_117:
    v_mov_b32 v11, 0
    s_waitcnt vmcnt(7)
    v_mfma_f32_16x16x32_bf16 v[32:35], v[28:31], v[64:67], 0
    v_or3_b32 v11, v11, v64, v65
    v_or3_b32 v11, v11, v66, v67
    s_waitcnt vmcnt(6)
    v_mfma_f32_16x16x32_bf16 v[32:35], v[28:31], v[68:71], v[32:35]
    v_or3_b32 v11, v11, v68, v69
    v_or3_b32 v11, v11, v70, v71
    s_waitcnt vmcnt(5)
    v_mfma_f32_16x16x32_bf16 v[32:35], v[28:31], v[72:75], v[32:35]
    v_or3_b32 v11, v11, v72, v73
    v_or3_b32 v11, v11, v74, v75
    s_waitcnt vmcnt(4)
    v_mfma_f32_16x16x32_bf16 v[32:35], v[28:31], v[76:79], v[32:35]
    v_or3_b32 v11, v11, v76, v77
    v_or3_b32 v11, v11, v78, v79
    v_and_b32 v11, 1, v11
    v_cmp_ne_u32 vcc, 0, v11
    s_cbranch_vccnz Lrd2_119
Lrdok_118:
    s_nop 2
    v_add_f32_dpp v36, v32, v32 row_ror:8 row_mask:0xf bank_mask:0xf
    v_add_f32_dpp v37, v33, v33 row_ror:8 row_mask:0xf bank_mask:0xf
    v_add_f32_dpp v38, v34, v34 row_ror:8 row_mask:0xf bank_mask:0xf
    v_add_f32_dpp v39, v35, v35 row_ror:8 row_mask:0xf bank_mask:0xf
    s_mov_b32 exec_lo, 0x00ff00ff
    s_mov_b32 exec_hi, 0
    v_cvt_pk_bf16_f32 v32, v36, v37
    v_cvt_pk_bf16_f32 v33, v38, v39
    v_min_u32 v32, -2, v32
    v_min_u32 v33, -2, v33
    buffer_store_dwordx2 v[32:33], v10, s[4:7], s38 offen sc1
    buffer_store_dwordx2 v[32:33], v10, s[4:7], s40 offen sc1
    v_mov_b64 v[34:35], -1
    buffer_store_dwordx2 v[34:35], v10, s[4:7], s55 offen sc1
    s_mov_b64 exec, -1
Ljoin_116:
    s_barrier
    s_add_u32 s32, s32, 1
    s_branch L_loop_slow0
L_ool_slow0:
Lrd2_98:
    buffer_load_dwordx4 v[64:67], v1, s[4:7], s45 offen offset:0 sc1
    buffer_load_dwordx4 v[68:71], v1, s[4:7], s45 offen offset:1024 sc1
    buffer_load_dwordx4 v[72:75], v1, s[4:7], s45 offen offset:2048 sc1
    buffer_load_dwordx4 v[76:79], v1, s[4:7], s45 offen offset:3072 sc1
    v_mov_b32 v11, 1
    s_waitcnt vmcnt(7)
    v_mfma_f32_16x16x32_bf16 v[32:35], v[28:31], v[12:15], 0
    v_bitop3_b32 v11, v11, v12, v13 bitop3:0x80
    v_bitop3_b32 v11, v11, v14, v15 bitop3:0x80
    s_waitcnt vmcnt(6)
    v_mfma_f32_16x16x32_bf16 v[32:35], v[28:31], v[16:19], v[32:35]
    v_bitop3_b32 v11, v11, v16, v17 bitop3:0x80
    v_bitop3_b32 v11, v11, v18, v19 bitop3:0x80
    s_waitcnt vmcnt(5)
    v_mfma_f32_16x16x32_bf16 v[32:35], v[28:31], v[20:23], v[32:35]
    v_bitop3_b32 v11, v11, v20, v21 bitop3:0x80
    v_bitop3_b32 v11, v11, v22, v23 bitop3:0x80
    s_waitcnt vmcnt(4)
    v_mfma_f32_16x16x32_bf16 v[32:35], v[28:31], v[24:27], v[32:35]
    v_bitop3_b32 v11, v11, v24, v25 bitop3:0x80
    v_bitop3_b32 v11, v11, v26, v27 bitop3:0x80
    v_and_b32 v11, 1, v11
    v_cmp_ne_u32 vcc, 1, v11
    s_cbranch_vccz Lrdok_97
    buffer_load_dwordx4 v[12:15], v1, s[4:7], s45 offen offset:0 sc1
    buffer_load_dwordx4 v[16:19], v1, s[4:7], s45 offen offset:1024 sc1
    buffer_load_dwordx4 v[20:23], v1, s[4:7], s45 offen offset:2048 sc1
    buffer_load_dwordx4 v[24:27], v1, s[4:7], s45 offen offset:3072 sc1
    s_add_u32 s74, s74, 1
    s_cmp_gt_u32 s74, 60000
    s_cbranch_scc1 L_abort
    s_branch Lrd_96
Lglre_87:
    buffer_load_dwordx4 v[12:15], v37, s[4:7], s38 offen sc1
    buffer_load_dword v16, v38, s[4:7], s38 offen sc1
    s_waitcnt vmcnt(2)
    v_max3_u32 v11, v20, v21, v22
    v_max3_u32 v11, v11, v23, v24
    v_cmp_eq_u32 vcc, -1, v11
    s_cbranch_vccz LglB_85
    buffer_load_dwordx4 v[20:23], v37, s[4:7], s38 offen sc1
    buffer_load_dword v24, v38, s[4:7], s38 offen sc1
    s_add_u32 s74, s74, 1
    s_cmp_gt_u32 s74, 60000
    s_cbranch_scc1 L_abort
    s_waitcnt vmcnt(2)
    s_branch Lgl_83
LglB_85:
    ds_write_b128 v37, v[20:23] offset:16384
    ds_write_b32 v38, v24 offset:16384
    s_branch Lglok_86
Lgrre_89:
    buffer_load_dwordx4 v[32:35], v37, s[4:7], s39 offen sc1
    buffer_load_dword v36, v38, s[4:7], s39 offen sc1
    s_add_u32 s74, s74, 1
    s_cmp_gt_u32 s74, 60000
    s_cbranch_scc1 L_abort
    s_waitcnt vmcnt(0)
    s_branch Lgr_88
Lnored_94:
    s_waitcnt lgkmcnt(0)
    s_branch Ljoin_95
Lxt_90:
    s_cmp_lg_u32 s63, 0
    s_cbranch_scc1 Lsg_120
    s_max_u32 s53, s32, 2
    s_sub_u32 s53, s53, 2
    s_mov_b64 exec, 1
    v_mov_b32 v11, s53
    s_mov_b32 s53, 0x5c00000
    buffer_store_dword v11, v0, s[4:7], s53 offen sc1
    s_mov_b64 exec, -1
Lsg_120:
    s_add_u32 s59, s32, 4
    s_min_u32 s59, s59, 59
    s_cmp_lt_u32 s32, 59
    s_cbranch_scc1 Lxr_91
    s_cmp_lg_u32 s28, 2
    s_cbranch_scc1 Lsg_121
    s_lshl_b32 s53, s30, 7
    s_lshl_b32 s54, s29, 2
    s_add_u32 s53, s53, s54
    s_add_u32 s53, s53, 0x5c00080
    s_sub_u32 s54, s32, 1
    s_mov_b64 exec, 1
    v_mov_b32 v11, s54
    buffer_store_dword v11, v0, s[4:7], s53 offen sc1
    s_mov_b64 exec, -1
Lsg_121:
    s_branch Lxr_91
Lrd2_119:
    buffer_load_dwordx4 v[64:67], v1, s[4:7], s45 offen offset:0 sc1
    buffer_load_dwordx4 v[68:71], v1, s[4:7], s45 offen offset:1024 sc1
    buffer_load_dwordx4 v[72:75], v1, s[4:7], s45 offen offset:2048 sc1
    buffer_load_dwordx4 v[76:79], v1, s[4:7], s45 offen offset:3072 sc1
    v_mov_b32 v11, 0
    s_waitcnt vmcnt(7)
    v_mfma_f32_16x16x32_bf16 v[32:35], v[28:31], v[12:15], 0
    v_or3_b32 v11, v11, v12, v13
    v_or3_b32 v11, v11, v14, v15
    s_waitcnt vmcnt(6)
    v_mfma_f32_16x16x32_bf16 v[32:35], v[28:31], v[16:19], v[32:35]
    v_or3_b32 v11, v11, v16, v17
    v_or3_b32 v11, v11, v18, v19
    s_waitcnt vmcnt(5)
    v_mfma_f32_16x16x32_bf16 v[32:35], v[28:31], v[20:23], v[32:35]
    v_or3_b32 v11, v11, v20, v21
    v_or3_b32 v11, v11, v22, v23
    s_waitcnt vmcnt(4)
    v_mfma_f32_16x16x32_bf16 v[32:35], v[28:31], v[24:27], v[32:35]
    v_or3_b32 v11, v11, v24, v25
    v_or3_b32 v11, v11, v26, v27
    v_and_b32 v11, 1, v11
    v_cmp_ne_u32 vcc, 0, v11
    s_cbranch_vccz Lrdok_118
    buffer_load_dwordx4 v[12:15], v1, s[4:7], s45 offen offset:0 sc1
    buffer_load_dwordx4 v[16:19], v1, s[4:7], s45 offen offset:1024 sc1
    buffer_load_dwordx4 v[20:23], v1, s[4:7], s45 offen offset:2048 sc1
    buffer_load_dwordx4 v[24:27], v1, s[4:7], s45 offen offset:3072 sc1
    s_add_u32 s74, s74, 1
    s_cmp_gt_u32 s74, 60000
    s_cbranch_scc1 L_abort
    s_branch Lrd_117
Lglre_103:
    buffer_load_dwordx4 v[12:15], v37, s[4:7], s38 offen sc1
    buffer_load_dword v16, v38, s[4:7], s38 offen sc1
    s_waitcnt vmcnt(2)
    v_max3_u32 v11, v20, v21, v22
    v_max3_u32 v11, v11, v23, v24
    v_cmp_eq_u32 vcc, -1, v11
    s_cbranch_vccz LglB_101
    buffer_load_dwordx4 v[20:23], v37, s[4:7], s38 offen sc1
    buffer_load_dword v24, v38, s[4:7], s38 offen sc1
    s_add_u32 s74, s74, 1
    s_cmp_gt_u32 s74, 60000
    s_cbranch_scc1 L_abort
    s_waitcnt vmcnt(2)
    s_branch Lgl_99
LglB_101:
    ds_write_b128 v37, v[20:23] offset:16384
    ds_write_b32 v38, v24 offset:16384
    s_branch Lglok_102
Lgrre_105:
    buffer_load_dwordx4 v[32:35], v37, s[4:7], s39 offen sc1
    buffer_load_dword v36, v38, s[4:7], s39 offen sc1
    s_add_u32 s74, s74, 1
    s_cmp_gt_u32 s74, 60000
    s_cbranch_scc1 L_abort
    s_waitcnt vmcnt(0)
    s_branch Lgr_104
Lnored_115:
    s_waitcnt lgkmcnt(0)
    s_branch Ljoin_116
Lkvo_110:
    s_add_u32 s54, s32, 3
    s_lshr_b32 s54, s54, 2
    s_cmp_ge_u32 s54, s49
    s_cbranch_scc1 Lkvn_109
    s_mov_b32 m0, s37
    s_mov_b32 exec_hi, 0
    buffer_load_dword v0, s[24:27], 0 offen sc1 lds
    s_mov_b32 exec_hi, -1
    s_branch Lkvok_107
Lkvn_109:
    v_add_u32 v11, s37, v0
    ds_read_b32 v11, v11
    s_waitcnt lgkmcnt(0)
    s_branch Lkvu_108
Lkv_106:
    buffer_load_dword v11, v0, s[24:27], 0 offen sc1
    s_waitcnt vmcnt(0)
Lkvu_108:
    v_and_b32 v11, 0x3ff, v11
    v_cmp_le_u32 vcc, 128, v11
    s_nop 3
    s_lshr_b32 s49, vcc_lo, 16
    s_ff0_i32_b32 s49, s49
    s_cmp_eq_u32 s49, 16
    s_cmov_b32 s49, 18
    s_lshl_b32 s58, s49, 2
    s_sub_u32 s58, s58, 5
    s_cmp_lt_u32 s54, s49
    s_cbranch_scc1 Lkvok_107
    s_add_u32 s74, s74, 1
    s_cmp_gt_u32 s74, 60000
    s_cbranch_scc1 L_abort
    s_sleep 2
    s_branch Lkv_106
Lxt_111:
    s_cmp_lg_u32 s63, 0
    s_cbranch_scc1 Lsg_122
    s_max_u32 s53, s32, 2
    s_sub_u32 s53, s53, 2
    s_mov_b64 exec, 1
    v_mov_b32 v11, s53
    s_mov_b32 s53, 0x5c00000
    buffer_store_dword v11, v0, s[4:7], s53 offen sc1
    s_mov_b64 exec, -1
Lsg_122:
    s_add_u32 s59, s32, 4
    s_min_u32 s59, s59, 59
    s_cmp_lt_u32 s32, 59
    s_cbranch_scc1 Lxr_112
    s_cmp_lg_u32 s28, 2
    s_cbranch_scc1 Lsg_123
    s_lshl_b32 s53, s30, 7
    s_lshl_b32 s54, s29, 2
    s_add_u32 s53, s53, s54
    s_add_u32 s53, s53, 0x5c00080
    s_sub_u32 s54, s32, 1
    s_mov_b64 exec, 1
    v_mov_b32 v11, s54
    buffer_store_dword v11, v0, s[4:7], s53 offen sc1
    s_mov_b64 exec, -1
Lsg_123:
    s_branch Lxr_112
L_loop_slow1:
    v_add_u32 v37, s33, v1
    v_add_u32 v38, s34, v0
    s_sleep 3
    buffer_load_dwordx4 v[12:15], v37, s[4:7], s38 offen sc1
    buffer_load_dword v16, v38, s[4:7], s38 offen sc1
    s_sleep 2
    s_mov_b32 m0, s50
    buffer_load_dwordx4 v[20:23], v37, s[4:7], s38 offen sc1
    buffer_load_dword v24, v38, s[4:7], s38 offen sc1
    s_waitcnt vmcnt(2)
Lgl_124:
    v_max3_u32 v11, v12, v13, v14
    v_max3_u32 v11, v11, v15, v16
    v_cmp_eq_u32 vcc, -1, v11
    s_cbranch_vccnz Lglre_128
    ds_write_b128 v37, v[12:15] offset:16384
    ds_write_b32 v38, v16 offset:16384
Lglok_127:
    ds_read_b128 v[64:67], v3 offset:0
    ds_read_b128 v[68:71], v3 offset:1024
    ds_read_b128 v[72:75], v3 offset:2048
    ds_read_b128 v[76:79], v3 offset:3072
    s_waitcnt lgkmcnt(4)
    s_barrier
    s_waitcnt vmcnt(0)
    ds_read_b128 v[12:15], v1 offset:16384
    ds_read_b128 v[16:19], v1 offset:17408
    ds_read_b128 v[20:23], v1 offset:18432
    ds_read_b128 v[24:27], v1 offset:19456
    ds_read_b128 v[28:31], v1 offset:20480
    buffer_load_dwordx4 v[32:35], v37, s[4:7], s39 offen sc1
    buffer_load_dword v36, v38, s[4:7], s39 offen sc1
    s_waitcnt lgkmcnt(4)
    v_smfmac_f32_16x16x64_bf16 v[48:51], v[12:15], v[64:71], v2
    ds_read_b128 v[64:67], v3 offset:4096
    ds_read_b128 v[68:71], v3 offset:5120
    v_smfmac_f32_16x16x64_bf16 v[40:43], v[12:15], v[80:87], v2
    v_smfmac_f32_16x16x64_bf16 v[44:47], v[12:15], v[88:95], v2
    v_smfmac_f32_16x16x64_bf16 v[52:55], v[12:15], v[72:79], v2
    ds_read_b128 v[72:75], v3 offset:6144
    ds_read_b128 v[76:79], v3 offset:7168
    s_waitcnt lgkmcnt(7)
    v_smfmac_f32_16x16x64_bf16 v[40:43], v[16:19], v[96:103], v2
    v_smfmac_f32_16x16x64_bf16 v[48:51], v[16:19], v[224:231], v2
    v_smfmac_f32_16x16x64_bf16 v[44:47], v[16:19], v[104:111], v2
    v_smfmac_f32_16x16x64_bf16 v[52:55], v[16:19], v[232:239], v2
    s_waitcnt lgkmcnt(6)
    s_waitcnt lgkmcnt(2)
    v_smfmac_f32_16x16x64_bf16 v[48:51], v[20:23], v[64:71], v2
    ds_read_b128 v[64:67], v3 offset:8192
    ds_read_b128 v[68:71], v3 offset:9216
    v_smfmac_f32_16x16x64_bf16 v[40:43], v[20:23], v[112:119], v2
    v_smfmac_f32_16x16x64_bf16 v[44:47], v[20:23], v[120:127], v2
    s_waitcnt lgkmcnt(2)
    v_smfmac_f32_16x16x64_bf16 v[52:55], v[20:23], v[72:79], v2
    ds_read_b128 v[72:75], v3 offset:10240
    ds_read_b128 v[76:79], v3 offset:11264
    v_smfmac_f32_16x16x64_bf16 v[40:43], v[24:27], v[128:135], v2
    v_smfmac_f32_16x16x64_bf16 v[48:51], v[24:27], v[240:247], v2
    v_smfmac_f32_16x16x64_bf16 v[44:47], v[24:27], v[136:143], v2
    v_smfmac_f32_16x16x64_bf16 v[52:55], v[24:27], v[248:255], v2
    s_waitcnt lgkmcnt(2)
    v_smfmac_f32_16x16x64_bf16 v[48:51], v[28:31], v[64:71], v2
    ds_read_b128 v[64:67], v3 offset:12288
    ds_read_b128 v[68:71], v3 offset:13312
    v_smfmac_f32_16x16x64_bf16 v[40:43], v[28:31], v[144:151], v2
    v_smfmac_f32_16x16x64_bf16 v[44:47], v[28:31], v[152:159], v2
    s_waitcnt lgkmcnt(2)
    v_smfmac_f32_16x16x64_bf16 v[52:55], v[28:31], v[72:79], v2
    ds_read_b128 v[72:75], v3 offset:14336
    ds_read_b128 v[76:79], v3 offset:15360
    s_waitcnt vmcnt(0)
Lgr_129:
    v_max3_u32 v11, v32, v33, v34
    v_max3_u32 v11, v11, v35, v36
    v_cmp_eq_u32 vcc, -1, v11
    s_cbranch_vccnz Lgrre_130
    ds_write_b128 v37, v[32:35] offset:21504
    ds_write_b32 v38, v36 offset:21504
    v_smfmac_f32_16x16x64_bf16 v[56:59], v[12:15], a[80:87], v2
    s_mov_b32 m0, s35
    s_add_u32 s46, s46, 0x4000
    s_add_u32 s53, s46, 0x4000
    buffer_load_dword v4, s[4:7], s53 offen sc1 lds
    s_waitcnt lgkmcnt(4)
    v_smfmac_f32_16x16x64_bf16 v[56:59], v[16:19], v[64:71], v2
    ds_read_b128 v[64:67], v3 offset:16384
    ds_read_b128 v[68:71], v3 offset:17408
    v_smfmac_f32_16x16x64_bf16 v[60:63], v[12:15], a[88:95], v2
    s_waitcnt lgkmcnt(4)
    v_smfmac_f32_16x16x64_bf16 v[60:63], v[16:19], v[72:79], v2
    ds_read_b128 v[72:75], v3 offset:18432
    ds_read_b128 v[76:79], v3 offset:19456
    s_waitcnt lgkmcnt(4)
    s_barrier
    ds_read_b128 v[12:15], v1 offset:21504
    ds_read_b128 v[16:19], v1 offset:22528
    s_cmp_ge_u32 s32, s59
    s_cbranch_scc1 Lxt_131
Lxr_132:
    v_smfmac_f32_16x16x64_bf16 v[56:59], v[20:23], a[96:103], v2
    v_smfmac_f32_16x16x64_bf16 v[60:63], v[20:23], a[104:111], v2
    ds_read_b128 v[20:23], v1 offset:23552
    v_smfmac_f32_16x16x64_bf16 v[56:59], v[28:31], a[112:119], v2
    v_smfmac_f32_16x16x64_bf16 v[60:63], v[28:31], a[120:127], v2
    ds_read_b128 v[28:31], v1 offset:25600
    s_waitcnt lgkmcnt(6)
    v_smfmac_f32_16x16x64_bf16 v[56:59], v[24:27], v[64:71], v2
    ds_read_b128 v[64:67], v3 offset:20480
    ds_read_b128 v[68:71], v3 offset:21504
    s_waitcnt lgkmcnt(6)
    v_smfmac_f32_16x16x64_bf16 v[60:63], v[24:27], v[72:79], v2
    ds_read_b128 v[72:75], v3 offset:22528
    ds_read_b128 v[76:79], v3 offset:23552
    ds_read_b128 v[24:27], v1 offset:24576
    v_add_u32 v36, s56, v6
    ds_read_b64 v[38:39], v36 offset:26624
    s_waitcnt lgkmcnt(8)
    v_smfmac_f32_16x16x64_bf16 v[40:43], v[16:19], v[160:167], v2
    v_smfmac_f32_16x16x64_bf16 v[44:47], v[16:19], v[168:175], v2
    s_waitcnt lgkmcnt(7)
    v_smfmac_f32_16x16x64_bf16 v[40:43], v[20:23], v[176:183], v2
    v_smfmac_f32_16x16x64_bf16 v[44:47], v[20:23], v[184:191], v2
    s_waitcnt lgkmcnt(6)
    v_smfmac_f32_16x16x64_bf16 v[40:43], v[28:31], v[208:215], v2
    v_smfmac_f32_16x16x64_bf16 v[44:47], v[28:31], v[216:223], v2
    s_waitcnt lgkmcnt(0)
    buffer_store_dwordx2 v[38:39], v6, s[4:7], s48 offen sc1
    s_add_u32 s48, s48, s62
    s_mov_b32 s62, 0x2000
    v_smfmac_f32_16x16x64_bf16 v[40:43], v[12:15], v[64:71], v2
    v_smfmac_f32_16x16x64_bf16 v[44:47], v[12:15], v[72:79], v2
    v_smfmac_f32_16x16x64_bf16 v[40:43], v[24:27], v[192:199], v2
    v_smfmac_f32_16x16x64_bf16 v[44:47], v[24:27], v[200:207], v2
    v_smfmac_f32_16x16x64_bf16 v[48:51], v[12:15], a[0:7], v2
    ds_read_b128 v[64:67], v1 offset:4096
    v_smfmac_f32_16x16x64_bf16 v[52:55], v[12:15], a[8:15], v2
    ds_read_b128 v[68:71], v1 offset:5120
    v_smfmac_f32_16x16x64_bf16 v[48:51], v[16:19], a[16:23], v2
    ds_read_b128 v[72:75], v1 offset:6144
    v_smfmac_f32_16x16x64_bf16 v[52:55], v[16:19], a[24:31], v2
    ds_read_b128 v[76:79], v1 offset:7168
    v_smfmac_f32_16x16x64_bf16 v[48:51], v[20:23], a[32:39], v2
    v_smfmac_f32_16x16x64_bf16 v[52:55], v[20:23], a[40:47], v2
    v_smfmac_f32_16x16x64_bf16 v[48:51], v[24:27], a[48:55], v2
    v_add_f32 v40, v40, v41
    v_add_f32 v42, v42, v43
    v_smfmac_f32_16x16x64_bf16 v[52:55], v[24:27], a[56:63], v2
    v_add_f32 v44, v44, v45
    v_add_f32 v46, v46, v47
    v_smfmac_f32_16x16x64_bf16 v[48:51], v[28:31], a[64:71], v2
    v_cvt_pk_bf16_f32 v41, v40, v42
    v_smfmac_f32_16x16x64_bf16 v[52:55], v[28:31], a[72:79], v2
    v_cvt_pk_bf16_f32 v45, v44, v46
    v_smfmac_f32_16x16x64_bf16 v[56:59], v[12:15], a[128:135], v2
    v_smfmac_f32_16x16x64_bf16 v[60:63], v[12:15], a[136:143], v2
    v_smfmac_f32_16x16x64_bf16 v[56:59], v[16:19], a[144:151], v2
    v_smfmac_f32_16x16x64_bf16 v[60:63], v[16:19], a[152:159], v2
    s_nop 1
    v_add_f32 v48, v48, v49
    v_add_f32 v50, v50, v51
    v_cvt_pk_bf16_f32 v40, v48, v50
    ds_write_b64 v5, v[40:41] offset:0
    v_add_f32 v52, v52, v53
    v_add_f32 v54, v54, v55
    v_cvt_pk_bf16_f32 v44, v52, v54
    ds_write_b64 v5, v[44:45] offset:512
    v_smfmac_f32_16x16x64_bf16 v[56:59], v[20:23], a[160:167], v2
    v_smfmac_f32_16x16x64_bf16 v[60:63], v[20:23], a[168:175], v2
    v_smfmac_f32_16x16x64_bf16 v[56:59], v[24:27], a[176:183], v2
    v_smfmac_f32_16x16x64_bf16 v[60:63], v[24:27], a[184:191], v2
    s_waitcnt lgkmcnt(0)
    s_barrier
    ds_read_b64_tr_b16 v[12:13], v6 offset:26624
    ds_read_b64_tr_b16 v[14:15], v6 offset:27136
    ds_read_b64_tr_b16 v[16:17], v6 offset:27648
    ds_read_b64_tr_b16 v[18:19], v6 offset:28160
    v_smfmac_f32_16x16x64_bf16 v[56:59], v[28:31], a[192:199], v2
    ds_read_b64_tr_b16 v[20:21], v6 offset:28672
    ds_read_b64_tr_b16 v[22:23], v6 offset:29184
    ds_read_b64_tr_b16 v[24:25], v6 offset:29696
    ds_read_b64_tr_b16 v[26:27], v6 offset:30208
    v_smfmac_f32_16x16x64_bf16 v[60:63], v[28:31], a[200:207], v2
    ds_read_b128 v[40:43], v1 offset:0
    ds_read_b128 v[44:47], v1 offset:1024
    ds_read_b128 v[48:51], v1 offset:2048
    ds_read_b128 v[52:55], v1 offset:3072
    v_add_u32 v11, s47, v1
    ds_read_b128 v[32:35], v11
    ds_read_b128 v[36:39], v11 offset:1024
    s_waitcnt lgkmcnt(12)
    v_mfma_f32_16x16x32_bf16 v[28:31], v[64:67], v[12:15], 0
    s_waitcnt lgkmcnt(10)
    v_mfma_f32_16x16x32_bf16 v[28:31], v[68:71], v[16:19], v[28:31]
    s_waitcnt lgkmcnt(8)
    v_mfma_f32_16x16x32_bf16 v[28:31], v[72:75], v[20:23], v[28:31]
    s_waitcnt lgkmcnt(6)
    v_mfma_f32_16x16x32_bf16 v[28:31], v[76:79], v[24:27], v[28:31]
    v_mfma_f32_16x16x32_bf16 v[64:67], v[12:15], v[12:15], 0
    v_mfma_f32_16x16x32_bf16 v[64:67], v[16:19], v[16:19], v[64:67]
    v_mfma_f32_16x16x32_bf16 v[64:67], v[20:23], v[20:23], v[64:67]
    v_mfma_f32_16x16x32_bf16 v[64:67], v[24:27], v[24:27], v[64:67]
    s_waitcnt lgkmcnt(0)
    s_mov_b32 m0, s50
    s_barrier
    v_mfma_f32_16x16x32_bf16 v[68:71], v[40:43], v[12:15], 0
    v_add_f32 v56, v56, v57
    v_add_f32 v58, v58, v59
    v_mfma_f32_16x16x32_bf16 v[68:71], v[44:47], v[16:19], v[68:71]
    v_add_f32 v60, v60, v61
    v_add_f32 v62, v62, v63
    v_mfma_f32_16x16x32_bf16 v[68:71], v[48:51], v[20:23], v[68:71]
    buffer_load_dwordx4 v1, s[4:7], s46 offen offset:2048 sc1 lds
    v_cvt_pk_bf16_f32 v76, v56, v58
    v_mov_b32 v77, 0
    v_mfma_f32_16x16x32_bf16 v[68:71], v[52:55], v[24:27], v[68:71]
    buffer_load_dwordx4 v1, s[4:7], s46 offen offset:3072 sc1 lds
    v_cvt_pk_bf16_f32 v78, v60, v62
    v_mov_b32 v79, 0
    ds_read_b128 v[40:43], v3 offset:28672
    ds_read_b128 v[44:47], v3 offset:29696
    ds_read_b128 v[48:51], v3 offset:30720
    ds_read_b128 v[52:55], v3 offset:31744
    v_max3_f32 v11, v28, v29, v30
    v_max3_f32 v11, v11, v31, v64
    v_max3_f32 v11, v11, v65, v68
    v_max3_f32 v11, v11, v69, v70
    v_max_f32 v11, v11, v71
    v_mov_b32 v66, v11
    v_mov_b32 v20, 0x3f803f80
    v_mov_b32 v21, 0x3f803f80
    v_permlane16_swap_b32 v11, v66
    v_max_f32 v11, v11, v66
    v_mov_b32 v66, v11
    v_mov_b64 v[22:23], v[20:21]
    v_mov_b32 v17, 0
    v_permlane32_swap_b32 v11, v66
    v_max_f32 v11, v11, v66
    v_mul_f32 v11, s51, v11
    v_fma_f32 v64, v64, s51, -v11
    v_fma_f32 v65, v65, s51, -v11
    v_exp_f32 v64, v64
    v_fma_f32 v68, v68, s51, -v11
    v_exp_f32 v65, v65
    v_fma_f32 v69, v69, s51, -v11
    v_exp_f32 v68, v68
    v_cvt_pk_bf16_f32 v16, v64, v65
    v_fma_f32 v70, v70, s51, -v11
    v_exp_f32 v69, v69
    v_fma_f32 v71, v71, s51, -v11
    v_exp_f32 v70, v70
    v_cvt_pk_bf16_f32 v12, v68, v69
    v_mfma_f32_16x16x16_bf16 v[24:27], v[20:21], v[16:17], 0
    v_fma_f32 v28, v28, s51, -v11
    v_exp_f32 v71, v71
    v_mfma_f32_16x16x16_bf16 v[56:59], v[76:77], v[16:17], 0
    v_fma_f32 v29, v29, s51, -v11
    v_exp_f32 v28, v28
    v_cvt_pk_bf16_f32 v13, v70, v71
    v_mfma_f32_16x16x16_bf16 v[60:63], v[78:79], v[16:17], 0
    v_fma_f32 v30, v30, s51, -v11
    v_exp_f32 v29, v29
    v_fma_f32 v31, v31, s51, -v11
    v_exp_f32 v30, v30
    v_exp_f32 v31, v31
    v_cvt_pk_bf16_f32 v14, v28, v29
    v_cvt_pk_bf16_f32 v15, v30, v31
    s_nop 1
    v_mfma_f32_16x16x32_bf16 v[24:27], v[20:23], v[12:15], v[24:27]
    v_mfma_f32_16x16x32_bf16 v[56:59], v[32:35], v[12:15], v[56:59]
    v_mfma_f32_16x16x32_bf16 v[60:63], v[36:39], v[12:15], v[60:63]
    v_mov_b64 v[12:13], 0
    v_mov_b64 v[14:15], 0
    v_mov_b64 v[16:17], 0
    v_mov_b64 v[18:19], 0
    v_mov_b64 v[20:21], 0
    v_mov_b64 v[22:23], 0
    v_rcp_f32 v11, v24
    s_mov_b32 exec_lo, 0xcccccccc
    s_mov_b32 exec_hi, 0xcccccccc
    v_mul_f32 v56, v56, v11
    v_mul_f32 v57, v57, v11
    v_mul_f32 v58, v58, v11
    v_mul_f32 v59, v59, v11
    v_cvt_pk_bf16_f32 v56, v56, v57
    v_cvt_pk_bf16_f32 v57, v58, v59
    ds_write_b64 v7, v[56:57] offset:0
    v_mul_f32 v60, v60, v11
    v_mul_f32 v61, v61, v11
    v_mul_f32 v62, v62, v11
    v_mul_f32 v63, v63, v11
    v_cvt_pk_bf16_f32 v60, v60, v61
    v_cvt_pk_bf16_f32 v61, v62, v63
    ds_write_b64 v7, v[60:61] offset:32
    s_mov_b64 exec, -1
    ds_read_b128 v[32:35], v3 offset:24576
    ds_read_b128 v[36:39], v3 offset:25600
    ds_read_b128 v[64:67], v3 offset:26624
    ds_read_b128 v[68:71], v3 offset:27648
    v_mov_b64 v[24:25], 0
    v_mov_b64 v[26:27], 0
    v_mov_b64 v[28:29], 0
    v_mov_b64 v[30:31], 0
    buffer_load_dwordx4 v1, s[4:7], s46 offen offset:0 sc1 lds
    buffer_load_dwordx4 v1, s[4:7], s46 offen offset:1024 sc1 lds
    s_waitcnt lgkmcnt(4)
    s_barrier
    ds_read_b128 v[56:59], v8 offset:0
    ds_read_b128 v[60:63], v8 offset:128
    s_waitcnt lgkmcnt(1)
    v_smfmac_f32_16x16x64_bf16 v[28:31], v[56:59], v[40:47], v2
    s_waitcnt lgkmcnt(0)
    v_smfmac_f32_16x16x64_bf16 v[28:31], v[60:63], v[48:55], v2
    v_smfmac_f32_16x16x64_bf16 v[12:15], v[56:59], a[208:215], v2
    v_smfmac_f32_16x16x64_bf16 v[12:15], v[60:63], a[216:223], v2
    v_smfmac_f32_16x16x64_bf16 v[16:19], v[56:59], a[224:231], v2
    v_smfmac_f32_16x16x64_bf16 v[16:19], v[60:63], a[232:239], v2
    v_smfmac_f32_16x16x64_bf16 v[20:23], v[56:59], a[240:247], v2
    v_smfmac_f32_16x16x64_bf16 v[20:23], v[60:63], a[248:255], v2
    s_nop 1
    v_add_f32 v28, v28, v29
    v_add_f32 v30, v30, v31
    v_smfmac_f32_16x16x64_bf16 v[24:27], v[56:59], v[32:39], v2
    v_cvt_pk_bf16_f32 v44, v28, v30
    v_or_b32 v44, 1, v44
    v_smfmac_f32_16x16x64_bf16 v[24:27], v[60:63], v[64:71], v2
    buffer_store_dword v44, v9, s[4:7], s44 offen sc1
    v_add_f32 v12, v12, v13
    v_add_f32 v14, v14, v15
    v_cvt_pk_bf16_f32 v40, v12, v14
    v_or_b32 v40, 1, v40
    v_add_f32 v16, v16, v17
    v_add_f32 v18, v18, v19
    v_cvt_pk_bf16_f32 v41, v16, v18
    v_or_b32 v41, 1, v41
    v_add_f32 v20, v20, v21
    v_add_f32 v22, v22, v23
    v_cvt_pk_bf16_f32 v42, v20, v22
    v_or_b32 v42, 1, v42
    v_add_f32 v24, v24, v25
    v_add_f32 v26, v26, v27
    v_cvt_pk_bf16_f32 v43, v24, v26
    v_or_b32 v43, 1, v43
    buffer_store_dwordx4 v[40:43], v9, s[4:7], s43 offen sc1
    v_add_u32 v11, s56, v0
    ds_write_b32 v11, v76 offset:26624
    ds_write_b32 v11, v78 offset:26880
    s_add_u32 s53, s32, 1
    s_and_b32 s53, s53, 3
    s_lshl_b32 s53, s53, 13
    s_add_u32 s38, s36, s53
    s_xor_b32 s53, s53, 0x4000
    s_add_u32 s55, s36, s53
    s_add_u32 s39, s39, 16384
    s_add_u32 s40, s40, 16384
    ds_read_b128 v[28:31], v1 offset:30720
    v_mov_b64 v[40:41], 0
    v_mov_b64 v[42:43], 0
    v_mov_b64 v[44:45], 0
    v_mov_b64 v[46:47], 0
    v_mov_b64 v[48:49], 0
    v_mov_b64 v[50:51], 0
    v_mov_b64 v[52:53], 0
    v_mov_b64 v[54:55], 0
    v_mov_b64 v[56:57], 0
    v_mov_b64 v[58:59], 0
    v_mov_b64 v[60:61], 0
    v_mov_b64 v[62:63], 0
    s_cmp_ge_u32 s42, 40
    s_cbranch_scc1 Lnored_135
    s_sleep 4
    buffer_load_dwordx4 v[64:67], v1, s[4:7], s45 offen offset:0 sc1
    buffer_load_dwordx4 v[68:71], v1, s[4:7], s45 offen offset:1024 sc1
    buffer_load_dwordx4 v[72:75], v1, s[4:7], s45 offen offset:2048 sc1
    buffer_load_dwordx4 v[76:79], v1, s[4:7], s45 offen offset:3072 sc1
    s_sleep 2
    buffer_load_dwordx4 v[12:15], v1, s[4:7], s45 offen offset:0 sc1
    buffer_load_dwordx4 v[16:19], v1, s[4:7], s45 offen offset:1024 sc1
    buffer_load_dwordx4 v[20:23], v1, s[4:7], s45 offen offset:2048 sc1
    buffer_load_dwordx4 v[24:27], v1, s[4:7], s45 offen offset:3072 sc1
    s_waitcnt lgkmcnt(0)
Lrd_137:
    v_mov_b32 v11, 1
    s_waitcnt vmcnt(7)
    v_mfma_f32_16x16x32_bf16 v[32:35], v[28:31], v[64:67], 0
    v_bitop3_b32 v11, v11, v64, v65 bitop3:0x80
    v_bitop3_b32 v11, v11, v66, v67 bitop3:0x80
    s_waitcnt vmcnt(6)
    v_mfma_f32_16x16x32_bf16 v[32:35], v[28:31], v[68:71], v[32:35]
    v_bitop3_b32 v11, v11, v68, v69 bitop3:0x80
    v_bitop3_b32 v11, v11, v70, v71 bitop3:0x80
    s_waitcnt vmcnt(5)
    v_mfma_f32_16x16x32_bf16 v[32:35], v[28:31], v[72:75], v[32:35]
    v_bitop3_b32 v11, v11, v72, v73 bitop3:0x80
    v_bitop3_b32 v11, v11, v74, v75 bitop3:0x80
    s_waitcnt vmcnt(4)
    v_mfma_f32_16x16x32_bf16 v[32:35], v[28:31], v[76:79], v[32:35]
    v_bitop3_b32 v11, v11, v76, v77 bitop3:0x80
    v_bitop3_b32 v11, v11, v78, v79 bitop3:0x80
    v_and_b32 v11, 1, v11
    v_cmp_ne_u32 vcc, 1, v11
    s_cbranch_vccnz Lrd2_139
Lrdok_138:
    s_nop 2
    v_add_f32_dpp v36, v32, v32 row_ror:8 row_mask:0xf bank_mask:0xf
    v_add_f32_dpp v37, v33, v33 row_ror:8 row_mask:0xf bank_mask:0xf
    v_add_f32_dpp v38, v34, v34 row_ror:8 row_mask:0xf bank_mask:0xf
    v_add_f32_dpp v39, v35, v35 row_ror:8 row_mask:0xf bank_mask:0xf
    s_mov_b32 exec_lo, 0x00ff00ff
    s_mov_b32 exec_hi, 0
    v_cvt_pk_bf16_f32 v32, v36, v37
    v_cvt_pk_bf16_f32 v33, v38, v39
    v_min_u32 v32, -2, v32
    v_min_u32 v33, -2, v33
    buffer_store_dwordx2 v[32:33], v10, s[4:7], s38 offen sc1
    buffer_store_dwordx2 v[32:33], v10, s[4:7], s40 offen sc1
    v_mov_b64 v[34:35], -1
    buffer_store_dwordx2 v[34:35], v10, s[4:7], s55 offen sc1
    s_mov_b64 exec, -1
Ljoin_136:
    s_barrier
    s_add_u32 s32, s32, 1
    v_add_u32 v37, s33, v1
    v_add_u32 v38, s34, v0
    s_sleep 3
    buffer_load_dwordx4 v[12:15], v37, s[4:7], s38 offen sc1
    buffer_load_dword v16, v38, s[4:7], s38 offen sc1
    s_sleep 2
    s_mov_b32 m0, s50
    buffer_load_dwordx4 v[20:23], v37, s[4:7], s38 offen sc1
    buffer_load_dword v24, v38, s[4:7], s38 offen sc1
    s_waitcnt vmcnt(2)
Lgl_140:
    v_max3_u32 v11, v12, v13, v14
    v_max3_u32 v11, v11, v15, v16
    v_cmp_eq_u32 vcc, -1, v11
    s_cbranch_vccnz Lglre_144
    ds_write_b128 v37, v[12:15] offset:16384
    ds_write_b32 v38, v16 offset:16384
Lglok_143:
    ds_read_b128 v[64:67], v3 offset:0
    ds_read_b128 v[68:71], v3 offset:1024
    ds_read_b128 v[72:75], v3 offset:2048
    ds_read_b128 v[76:79], v3 offset:3072
    s_waitcnt lgkmcnt(4)
    s_barrier
    s_waitcnt vmcnt(0)
    ds_read_b128 v[12:15], v1 offset:16384
    ds_read_b128 v[16:19], v1 offset:17408
    ds_read_b128 v[20:23], v1 offset:18432
    ds_read_b128 v[24:27], v1 offset:19456
    ds_read_b128 v[28:31], v1 offset:20480
    buffer_load_dwordx4 v[32:35], v37, s[4:7], s39 offen sc1
    buffer_load_dword v36, v38, s[4:7], s39 offen sc1
    s_waitcnt lgkmcnt(4)
    v_smfmac_f32_16x16x64_bf16 v[48:51], v[12:15], v[64:71], v2
    ds_read_b128 v[64:67], v3 offset:4096
    ds_read_b128 v[68:71], v3 offset:5120
    v_smfmac_f32_16x16x64_bf16 v[40:43], v[12:15], v[80:87], v2
    v_smfmac_f32_16x16x64_bf16 v[44:47], v[12:15], v[88:95], v2
    v_smfmac_f32_16x16x64_bf16 v[52:55], v[12:15], v[72:79], v2
    ds_read_b128 v[72:75], v3 offset:6144
    ds_read_b128 v[76:79], v3 offset:7168
    s_waitcnt lgkmcnt(7)
    v_smfmac_f32_16x16x64_bf16 v[40:43], v[16:19], v[96:103], v2
    v_smfmac_f32_16x16x64_bf16 v[48:51], v[16:19], v[224:231], v2
    v_smfmac_f32_16x16x64_bf16 v[44:47], v[16:19], v[104:111], v2
    v_smfmac_f32_16x16x64_bf16 v[52:55], v[16:19], v[232:239], v2
    s_waitcnt lgkmcnt(6)
    s_waitcnt lgkmcnt(2)
    v_smfmac_f32_16x16x64_bf16 v[48:51], v[20:23], v[64:71], v2
    ds_read_b128 v[64:67], v3 offset:8192
    ds_read_b128 v[68:71], v3 offset:9216
    v_smfmac_f32_16x16x64_bf16 v[40:43], v[20:23], v[112:119], v2
    v_smfmac_f32_16x16x64_bf16 v[44:47], v[20:23], v[120:127], v2
    s_waitcnt lgkmcnt(2)
    v_smfmac_f32_16x16x64_bf16 v[52:55], v[20:23], v[72:79], v2
    ds_read_b128 v[72:75], v3 offset:10240
    ds_read_b128 v[76:79], v3 offset:11264
    v_smfmac_f32_16x16x64_bf16 v[40:43], v[24:27], v[128:135], v2
    v_smfmac_f32_16x16x64_bf16 v[48:51], v[24:27], v[240:247], v2
    v_smfmac_f32_16x16x64_bf16 v[44:47], v[24:27], v[136:143], v2
    v_smfmac_f32_16x16x64_bf16 v[52:55], v[24:27], v[248:255], v2
    s_waitcnt lgkmcnt(2)
    v_smfmac_f32_16x16x64_bf16 v[48:51], v[28:31], v[64:71], v2
    ds_read_b128 v[64:67], v3 offset:12288
    ds_read_b128 v[68:71], v3 offset:13312
    v_smfmac_f32_16x16x64_bf16 v[40:43], v[28:31], v[144:151], v2
    v_smfmac_f32_16x16x64_bf16 v[44:47], v[28:31], v[152:159], v2
    s_waitcnt lgkmcnt(2)
    v_smfmac_f32_16x16x64_bf16 v[52:55], v[28:31], v[72:79], v2
    ds_read_b128 v[72:75], v3 offset:14336
    ds_read_b128 v[76:79], v3 offset:15360
    s_waitcnt vmcnt(0)
Lgr_145:
    v_max3_u32 v11, v32, v33, v34
    v_max3_u32 v11, v11, v35, v36
    v_cmp_eq_u32 vcc, -1, v11
    s_cbranch_vccnz Lgrre_146
    ds_write_b128 v37, v[32:35] offset:21504
    ds_write_b32 v38, v36 offset:21504
    v_smfmac_f32_16x16x64_bf16 v[56:59], v[12:15], a[80:87], v2
    s_cmp_ge_i32 s32, s58
    s_cbranch_scc1 Lkvo_151
Lkvok_148:
    s_mov_b32 m0, s35
    s_add_u32 s46, s46, 0x4000
    s_add_u32 s53, s46, 0x4000
    buffer_load_dword v4, s[4:7], s53 offen sc1 lds
    s_waitcnt lgkmcnt(4)
    v_smfmac_f32_16x16x64_bf16 v[56:59], v[16:19], v[64:71], v2
    ds_read_b128 v[64:67], v3 offset:16384
    ds_read_b128 v[68:71], v3 offset:17408
    v_smfmac_f32_16x16x64_bf16 v[60:63], v[12:15], a[88:95], v2
    s_waitcnt lgkmcnt(4)
    v_smfmac_f32_16x16x64_bf16 v[60:63], v[16:19], v[72:79], v2
    ds_read_b128 v[72:75], v3 offset:18432
    ds_read_b128 v[76:79], v3 offset:19456
    s_waitcnt lgkmcnt(4)
    s_barrier
    ds_read_b128 v[12:15], v1 offset:21504
    ds_read_b128 v[16:19], v1 offset:22528
    s_cmp_ge_u32 s32, s59
    s_cbranch_scc1 Lxt_152
Lxr_153:
    v_smfmac_f32_16x16x64_bf16 v[56:59], v[20:23], a[96:103], v2
    v_smfmac_f32_16x16x64_bf16 v[60:63], v[20:23], a[104:111], v2
    ds_read_b128 v[20:23], v1 offset:23552
    v_smfmac_f32_16x16x64_bf16 v[56:59], v[28:31], a[112:119], v2
    v_smfmac_f32_16x16x64_bf16 v[60:63], v[28:31], a[120:127], v2
    ds_read_b128 v[28:31], v1 offset:25600
    s_waitcnt lgkmcnt(6)
    v_smfmac_f32_16x16x64_bf16 v[56:59], v[24:27], v[64:71], v2
    ds_read_b128 v[64:67], v3 offset:20480
    ds_read_b128 v[68:71], v3 offset:21504
    s_waitcnt lgkmcnt(6)
    v_smfmac_f32_16x16x64_bf16 v[60:63], v[24:27], v[72:79], v2
    ds_read_b128 v[72:75], v3 offset:22528
    ds_read_b128 v[76:79], v3 offset:23552
    ds_read_b128 v[24:27], v1 offset:24576
    v_add_u32 v36, s56, v6
    ds_read_b64 v[38:39], v36 offset:26624
    s_waitcnt lgkmcnt(8)
    v_smfmac_f32_16x16x64_bf16 v[40:43], v[16:19], v[160:167], v2
    v_smfmac_f32_16x16x64_bf16 v[44:47], v[16:19], v[168:175], v2
    s_waitcnt lgkmcnt(7)
    v_smfmac_f32_16x16x64_bf16 v[40:43], v[20:23], v[176:183], v2
    v_smfmac_f32_16x16x64_bf16 v[44:47], v[20:23], v[184:191], v2
    s_waitcnt lgkmcnt(6)
    v_smfmac_f32_16x16x64_bf16 v[40:43], v[28:31], v[208:215], v2
    v_smfmac_f32_16x16x64_bf16 v[44:47], v[28:31], v[216:223], v2
    s_waitcnt lgkmcnt(0)
    buffer_store_dwordx2 v[38:39], v6, s[4:7], s48 offen sc1
    s_add_u32 s48, s48, s62
    s_mov_b32 s62, 0x2000
    v_smfmac_f32_16x16x64_bf16 v[40:43], v[12:15], v[64:71], v2
    v_smfmac_f32_16x16x64_bf16 v[44:47], v[12:15], v[72:79], v2
    v_smfmac_f32_16x16x64_bf16 v[40:43], v[24:27], v[192:199], v2
    v_smfmac_f32_16x16x64_bf16 v[44:47], v[24:27], v[200:207], v2
    v_smfmac_f32_16x16x64_bf16 v[48:51], v[12:15], a[0:7], v2
    ds_read_b128 v[64:67], v1 offset:4096
    v_smfmac_f32_16x16x64_bf16 v[52:55], v[12:15], a[8:15], v2
    ds_read_b128 v[68:71], v1 offset:5120
    v_smfmac_f32_16x16x64_bf16 v[48:51], v[16:19], a[16:23], v2
    ds_read_b128 v[72:75], v1 offset:6144
    v_smfmac_f32_16x16x64_bf16 v[52:55], v[16:19], a[24:31], v2
    ds_read_b128 v[76:79], v1 offset:7168
    v_smfmac_f32_16x16x64_bf16 v[48:51], v[20:23], a[32:39], v2
    v_smfmac_f32_16x16x64_bf16 v[52:55], v[20:23], a[40:47], v2
    v_smfmac_f32_16x16x64_bf16 v[48:51], v[24:27], a[48:55], v2
    v_add_f32 v40, v40, v41
    v_add_f32 v42, v42, v43
    v_smfmac_f32_16x16x64_bf16 v[52:55], v[24:27], a[56:63], v2
    v_add_f32 v44, v44, v45
    v_add_f32 v46, v46, v47
    v_smfmac_f32_16x16x64_bf16 v[48:51], v[28:31], a[64:71], v2
    v_cvt_pk_bf16_f32 v41, v40, v42
    v_smfmac_f32_16x16x64_bf16 v[52:55], v[28:31], a[72:79], v2
    v_cvt_pk_bf16_f32 v45, v44, v46
    v_smfmac_f32_16x16x64_bf16 v[56:59], v[12:15], a[128:135], v2
    v_smfmac_f32_16x16x64_bf16 v[60:63], v[12:15], a[136:143], v2
    v_smfmac_f32_16x16x64_bf16 v[56:59], v[16:19], a[144:151], v2
    v_smfmac_f32_16x16x64_bf16 v[60:63], v[16:19], a[152:159], v2
    s_nop 1
    v_add_f32 v48, v48, v49
    v_add_f32 v50, v50, v51
    v_cvt_pk_bf16_f32 v40, v48, v50
    ds_write_b64 v5, v[40:41] offset:0
    v_add_f32 v52, v52, v53
    v_add_f32 v54, v54, v55
    v_cvt_pk_bf16_f32 v44, v52, v54
    ds_write_b64 v5, v[44:45] offset:512
    v_smfmac_f32_16x16x64_bf16 v[56:59], v[20:23], a[160:167], v2
    v_smfmac_f32_16x16x64_bf16 v[60:63], v[20:23], a[168:175], v2
    v_smfmac_f32_16x16x64_bf16 v[56:59], v[24:27], a[176:183], v2
    v_smfmac_f32_16x16x64_bf16 v[60:63], v[24:27], a[184:191], v2
    s_waitcnt lgkmcnt(0)
    s_barrier
    ds_read_b64_tr_b16 v[12:13], v6 offset:26624
    ds_read_b64_tr_b16 v[14:15], v6 offset:27136
    ds_read_b64_tr_b16 v[16:17], v6 offset:27648
    ds_read_b64_tr_b16 v[18:19], v6 offset:28160
    v_smfmac_f32_16x16x64_bf16 v[56:59], v[28:31], a[192:199], v2
    ds_read_b64_tr_b16 v[20:21], v6 offset:28672
    ds_read_b64_tr_b16 v[22:23], v6 offset:29184
    ds_read_b64_tr_b16 v[24:25], v6 offset:29696
    ds_read_b64_tr_b16 v[26:27], v6 offset:30208
    v_smfmac_f32_16x16x64_bf16 v[60:63], v[28:31], a[200:207], v2
    ds_read_b128 v[40:43], v1 offset:0
    ds_read_b128 v[44:47], v1 offset:1024
    ds_read_b128 v[48:51], v1 offset:2048
    ds_read_b128 v[52:55], v1 offset:3072
    v_add_u32 v11, s47, v1
    ds_read_b128 v[32:35], v11
    ds_read_b128 v[36:39], v11 offset:1024
    s_waitcnt lgkmcnt(12)
    v_mfma_f32_16x16x32_bf16 v[28:31], v[64:67], v[12:15], 0
    s_waitcnt lgkmcnt(10)
    v_mfma_f32_16x16x32_bf16 v[28:31], v[68:71], v[16:19], v[28:31]
    s_waitcnt lgkmcnt(8)
    v_mfma_f32_16x16x32_bf16 v[28:31], v[72:75], v[20:23], v[28:31]
    s_waitcnt lgkmcnt(6)
    v_mfma_f32_16x16x32_bf16 v[28:31], v[76:79], v[24:27], v[28:31]
    v_mfma_f32_16x16x32_bf16 v[64:67], v[12:15], v[12:15], 0
    v_mfma_f32_16x16x32_bf16 v[64:67], v[16:19], v[16:19], v[64:67]
    v_mfma_f32_16x16x32_bf16 v[64:67], v[20:23], v[20:23], v[64:67]
    v_mfma_f32_16x16x32_bf16 v[64:67], v[24:27], v[24:27], v[64:67]
    s_waitcnt lgkmcnt(0)
    s_mov_b32 m0, s50
    s_barrier
    v_mfma_f32_16x16x32_bf16 v[68:71], v[40:43], v[12:15], 0
    v_add_f32 v56, v56, v57
    v_add_f32 v58, v58, v59
    v_mfma_f32_16x16x32_bf16 v[68:71], v[44:47], v[16:19], v[68:71]
    v_add_f32 v60, v60, v61
    v_add_f32 v62, v62, v63
    v_mfma_f32_16x16x32_bf16 v[68:71], v[48:51], v[20:23], v[68:71]
    buffer_load_dwordx4 v1, s[4:7], s46 offen offset:2048 sc1 lds
    v_cvt_pk_bf16_f32 v76, v56, v58
    v_mov_b32 v77, 0
    v_mfma_f32_16x16x32_bf16 v[68:71], v[52:55], v[24:27], v[68:71]
    buffer_load_dwordx4 v1, s[4:7], s46 offen offset:3072 sc1 lds
    v_cvt_pk_bf16_f32 v78, v60, v62
    v_mov_b32 v79, 0
    s_cmp_eq_u32 s32, 63
    s_cbranch_scc1 L_rec_last
    ds_read_b128 v[40:43], v3 offset:28672
    ds_read_b128 v[44:47], v3 offset:29696
    ds_read_b128 v[48:51], v3 offset:30720
    ds_read_b128 v[52:55], v3 offset:31744
    v_max3_f32 v11, v28, v29, v30
    v_max3_f32 v11, v11, v31, v64
    v_max3_f32 v11, v11, v65, v68
    v_max3_f32 v11, v11, v69, v70
    v_max_f32 v11, v11, v71
    v_mov_b32 v66, v11
    v_mov_b32 v20, 0x3f803f80
    v_mov_b32 v21, 0x3f803f80
    v_permlane16_swap_b32 v11, v66
    v_max_f32 v11, v11, v66
    v_mov_b32 v66, v11
    v_mov_b64 v[22:23], v[20:21]
    v_mov_b32 v17, 0
    v_permlane32_swap_b32 v11, v66
    v_max_f32 v11, v11, v66
    v_mul_f32 v11, s51, v11
    v_fma_f32 v64, v64, s51, -v11
    v_fma_f32 v65, v65, s51, -v11
    v_exp_f32 v64, v64
    v_fma_f32 v68, v68, s51, -v11
    v_exp_f32 v65, v65
    v_fma_f32 v69, v69, s51, -v11
    v_exp_f32 v68, v68
    v_cvt_pk_bf16_f32 v16, v64, v65
    v_fma_f32 v70, v70, s51, -v11
    v_exp_f32 v69, v69
    v_fma_f32 v71, v71, s51, -v11
    v_exp_f32 v70, v70
    v_cvt_pk_bf16_f32 v12, v68, v69
    v_mfma_f32_16x16x16_bf16 v[24:27], v[20:21], v[16:17], 0
    v_fma_f32 v28, v28, s51, -v11
    v_exp_f32 v71, v71
    v_mfma_f32_16x16x16_bf16 v[56:59], v[76:77], v[16:17], 0
    v_fma_f32 v29, v29, s51, -v11
    v_exp_f32 v28, v28
    v_cvt_pk_bf16_f32 v13, v70, v71
    v_mfma_f32_16x16x16_bf16 v[60:63], v[78:79], v[16:17], 0
    v_fma_f32 v30, v30, s51, -v11
    v_exp_f32 v29, v29
    v_fma_f32 v31, v31, s51, -v11
    v_exp_f32 v30, v30
    v_exp_f32 v31, v31
    v_cvt_pk_bf16_f32 v14, v28, v29
    v_cvt_pk_bf16_f32 v15, v30, v31
    s_nop 1
    v_mfma_f32_16x16x32_bf16 v[24:27], v[20:23], v[12:15], v[24:27]
    v_mfma_f32_16x16x32_bf16 v[56:59], v[32:35], v[12:15], v[56:59]
    v_mfma_f32_16x16x32_bf16 v[60:63], v[36:39], v[12:15], v[60:63]
    v_mov_b64 v[12:13], 0
    v_mov_b64 v[14:15], 0
    v_mov_b64 v[16:17], 0
    v_mov_b64 v[18:19], 0
    v_mov_b64 v[20:21], 0
    v_mov_b64 v[22:23], 0
    v_rcp_f32 v11, v24
    s_mov_b32 exec_lo, 0xcccccccc
    s_mov_b32 exec_hi, 0xcccccccc
    v_mul_f32 v56, v56, v11
    v_mul_f32 v57, v57, v11
    v_mul_f32 v58, v58, v11
    v_mul_f32 v59, v59, v11
    v_cvt_pk_bf16_f32 v56, v56, v57
    v_cvt_pk_bf16_f32 v57, v58, v59
    ds_write_b64 v7, v[56:57] offset:0
    v_mul_f32 v60, v60, v11
    v_mul_f32 v61, v61, v11
    v_mul_f32 v62, v62, v11
    v_mul_f32 v63, v63, v11
    v_cvt_pk_bf16_f32 v60, v60, v61
    v_cvt_pk_bf16_f32 v61, v62, v63
    ds_write_b64 v7, v[60:61] offset:32
    s_mov_b64 exec, -1
    ds_read_b128 v[32:35], v3 offset:24576
    ds_read_b128 v[36:39], v3 offset:25600
    ds_read_b128 v[64:67], v3 offset:26624
    ds_read_b128 v[68:71], v3 offset:27648
    v_mov_b64 v[24:25], 0
    v_mov_b64 v[26:27], 0
    v_mov_b64 v[28:29], 0
    v_mov_b64 v[30:31], 0
    buffer_load_dwordx4 v1, s[4:7], s46 offen offset:0 sc1 lds
    buffer_load_dwordx4 v1, s[4:7], s46 offen offset:1024 sc1 lds
    s_waitcnt lgkmcnt(4)
    s_barrier
    ds_read_b128 v[56:59], v8 offset:0
    ds_read_b128 v[60:63], v8 offset:128
    s_waitcnt lgkmcnt(1)
    v_smfmac_f32_16x16x64_bf16 v[28:31], v[56:59], v[40:47], v2
    s_waitcnt lgkmcnt(0)
    v_smfmac_f32_16x16x64_bf16 v[28:31], v[60:63], v[48:55], v2
    v_smfmac_f32_16x16x64_bf16 v[12:15], v[56:59], a[208:215], v2
    v_smfmac_f32_16x16x64_bf16 v[12:15], v[60:63], a[216:223], v2
    v_smfmac_f32_16x16x64_bf16 v[16:19], v[56:59], a[224:231], v2
    v_smfmac_f32_16x16x64_bf16 v[16:19], v[60:63], a[232:239], v2
    v_smfmac_f32_16x16x64_bf16 v[20:23], v[56:59], a[240:247], v2
    v_smfmac_f32_16x16x64_bf16 v[20:23], v[60:63], a[248:255], v2
    s_nop 1
    v_add_f32 v28, v28, v29
    v_add_f32 v30, v30, v31
    v_smfmac_f32_16x16x64_bf16 v[24:27], v[56:59], v[32:39], v2
    v_cvt_pk_bf16_f32 v44, v28, v30
    v_and_b32 v44, -2, v44
    v_smfmac_f32_16x16x64_bf16 v[24:27], v[60:63], v[64:71], v2
    buffer_store_dword v44, v9, s[4:7], s44 offen sc1
    v_add_f32 v12, v12, v13
    v_add_f32 v14, v14, v15
    v_cvt_pk_bf16_f32 v40, v12, v14
    v_and_b32 v40, -2, v40
    v_add_f32 v16, v16, v17
    v_add_f32 v18, v18, v19
    v_cvt_pk_bf16_f32 v41, v16, v18
    v_and_b32 v41, -2, v41
    v_add_f32 v20, v20, v21
    v_add_f32 v22, v22, v23
    v_cvt_pk_bf16_f32 v42, v20, v22
    v_and_b32 v42, -2, v42
    v_add_f32 v24, v24, v25
    v_add_f32 v26, v26, v27
    v_cvt_pk_bf16_f32 v43, v24, v26
    v_and_b32 v43, -2, v43
    buffer_store_dwordx4 v[40:43], v9, s[4:7], s43 offen sc1
    v_add_u32 v11, s56, v0
    ds_write_b32 v11, v76 offset:26624
    ds_write_b32 v11, v78 offset:26880
    s_add_u32 s53, s32, 1
    s_and_b32 s53, s53, 3
    s_lshl_b32 s53, s53, 13
    s_add_u32 s38, s36, s53
    s_xor_b32 s53, s53, 0x4000
    s_add_u32 s55, s36, s53
    s_add_u32 s39, s39, 16384
    s_add_u32 s40, s40, 16384
    ds_read_b128 v[28:31], v1 offset:30720
    v_mov_b64 v[40:41], 0
    v_mov_b64 v[42:43], 0
    v_mov_b64 v[44:45], 0
    v_mov_b64 v[46:47], 0
    v_mov_b64 v[48:49], 0
    v_mov_b64 v[50:51], 0
    v_mov_b64 v[52:53], 0
    v_mov_b64 v[54:55], 0
    v_mov_b64 v[56:57], 0
    v_mov_b64 v[58:59], 0
    v_mov_b64 v[60:61], 0
    v_mov_b64 v[62:63], 0
    s_cmp_ge_u32 s42, 40
    s_cbranch_scc1 Lnored_156
    s_sleep 4
    buffer_load_dwordx4 v[64:67], v1, s[4:7], s45 offen offset:0 sc1
    buffer_load_dwordx4 v[68:71], v1, s[4:7], s45 offen offset:1024 sc1
    buffer_load_dwordx4 v[72:75], v1, s[4:7], s45 offen offset:2048 sc1
    buffer_load_dwordx4 v[76:79], v1, s[4:7], s45 offen offset:3072 sc1
    s_sleep 2
    buffer_load_dwordx4 v[12:15], v1, s[4:7], s45 offen offset:0 sc1
    buffer_load_dwordx4 v[16:19], v1, s[4:7], s45 offen offset:1024 sc1
    buffer_load_dwordx4 v[20:23], v1, s[4:7], s45 offen offset:2048 sc1
    buffer_load_dwordx4 v[24:27], v1, s[4:7], s45 offen offset:3072 sc1
    s_waitcnt lgkmcnt(0)
Lrd_158:
    v_mov_b32 v11, 0
    s_waitcnt vmcnt(7)
    v_mfma_f32_16x16x32_bf16 v[32:35], v[28:31], v[64:67], 0
    v_or3_b32 v11, v11, v64, v65
    v_or3_b32 v11, v11, v66, v67
    s_waitcnt vmcnt(6)
    v_mfma_f32_16x16x32_bf16 v[32:35], v[28:31], v[68:71], v[32:35]
    v_or3_b32 v11, v11, v68, v69
    v_or3_b32 v11, v11, v70, v71
    s_waitcnt vmcnt(5)
    v_mfma_f32_16x16x32_bf16 v[32:35], v[28:31], v[72:75], v[32:35]
    v_or3_b32 v11, v11, v72, v73
    v_or3_b32 v11, v11, v74, v75
    s_waitcnt vmcnt(4)
    v_mfma_f32_16x16x32_bf16 v[32:35], v[28:31], v[76:79], v[32:35]
    v_or3_b32 v11, v11, v76, v77
    v_or3_b32 v11, v11, v78, v79
    v_and_b32 v11, 1, v11
    v_cmp_ne_u32 vcc, 0, v11
    s_cbranch_vccnz Lrd2_160
Lrdok_159:
    s_nop 2
    v_add_f32_dpp v36, v32, v32 row_ror:8 row_mask:0xf bank_mask:0xf
    v_add_f32_dpp v37, v33, v33 row_ror:8 row_mask:0xf bank_mask:0xf
    v_add_f32_dpp v38, v34, v34 row_ror:8 row_mask:0xf bank_mask:0xf
    v_add_f32_dpp v39, v35, v35 row_ror:8 row_mask:0xf bank_mask:0xf
    s_mov_b32 exec_lo, 0x00ff00ff
    s_mov_b32 exec_hi, 0
    v_cvt_pk_bf16_f32 v32, v36, v37
    v_cvt_pk_bf16_f32 v33, v38, v39
    v_min_u32 v32, -2, v32
    v_min_u32 v33, -2, v33
    buffer_store_dwordx2 v[32:33], v10, s[4:7], s38 offen sc1
    buffer_store_dwordx2 v[32:33], v10, s[4:7], s40 offen sc1
    v_mov_b64 v[34:35], -1
    buffer_store_dwordx2 v[34:35], v10, s[4:7], s55 offen sc1
    s_mov_b64 exec, -1
Ljoin_157:
    s_barrier
    s_add_u32 s32, s32, 1
    s_branch L_loop_slow1
L_ool_slow1:
Lrd2_139:
    buffer_load_dwordx4 v[64:67], v1, s[4:7], s45 offen offset:0 sc1
    buffer_load_dwordx4 v[68:71], v1, s[4:7], s45 offen offset:1024 sc1
    buffer_load_dwordx4 v[72:75], v1, s[4:7], s45 offen offset:2048 sc1
    buffer_load_dwordx4 v[76:79], v1, s[4:7], s45 offen offset:3072 sc1
    v_mov_b32 v11, 1
    s_waitcnt vmcnt(7)
    v_mfma_f32_16x16x32_bf16 v[32:35], v[28:31], v[12:15], 0
    v_bitop3_b32 v11, v11, v12, v13 bitop3:0x80
    v_bitop3_b32 v11, v11, v14, v15 bitop3:0x80
    s_waitcnt vmcnt(6)
    v_mfma_f32_16x16x32_bf16 v[32:35], v[28:31], v[16:19], v[32:35]
    v_bitop3_b32 v11, v11, v16, v17 bitop3:0x80
    v_bitop3_b32 v11, v11, v18, v19 bitop3:0x80
    s_waitcnt vmcnt(5)
    v_mfma_f32_16x16x32_bf16 v[32:35], v[28:31], v[20:23], v[32:35]
    v_bitop3_b32 v11, v11, v20, v21 bitop3:0x80
    v_bitop3_b32 v11, v11, v22, v23 bitop3:0x80
    s_waitcnt vmcnt(4)
    v_mfma_f32_16x16x32_bf16 v[32:35], v[28:31], v[24:27], v[32:35]
    v_bitop3_b32 v11, v11, v24, v25 bitop3:0x80
    v_bitop3_b32 v11, v11, v26, v27 bitop3:0x80
    v_and_b32 v11, 1, v11
    v_cmp_ne_u32 vcc, 1, v11
    s_cbranch_vccz Lrdok_138
    buffer_load_dwordx4 v[12:15], v1, s[4:7], s45 offen offset:0 sc1
    buffer_load_dwordx4 v[16:19], v1, s[4:7], s45 offen offset:1024 sc1
    buffer_load_dwordx4 v[20:23], v1, s[4:7], s45 offen offset:2048 sc1
    buffer_load_dwordx4 v[24:27], v1, s[4:7], s45 offen offset:3072 sc1
    s_add_u32 s74, s74, 1
    s_cmp_gt_u32 s74, 60000
    s_cbranch_scc1 L_abort
    s_branch Lrd_137
Lglre_128:
    buffer_load_dwordx4 v[12:15], v37, s[4:7], s38 offen sc1
    buffer_load_dword v16, v38, s[4:7], s38 offen sc1
    s_waitcnt vmcnt(2)
    v_max3_u32 v11, v20, v21, v22
    v_max3_u32 v11, v11, v23, v24
    v_cmp_eq_u32 vcc, -1, v11
    s_cbranch_vccz LglB_126
    buffer_load_dwordx4 v[20:23], v37, s[4:7], s38 offen sc1
    buffer_load_dword v24, v38, s[4:7], s38 offen sc1
    s_add_u32 s74, s74, 1
    s_cmp_gt_u32 s74, 60000
    s_cbranch_scc1 L_abort
    s_waitcnt vmcnt(2)
    s_branch Lgl_124
LglB_126:
    ds_write_b128 v37, v[20:23] offset:16384
    ds_write_b32 v38, v24 offset:16384
    s_branch Lglok_127
Lgrre_130:
    buffer_load_dwordx4 v[32:35], v37, s[4:7], s39 offen sc1
    buffer_load_dword v36, v38, s[4:7], s39 offen sc1
    s_add_u32 s74, s74, 1
    s_cmp_gt_u32 s74, 60000
    s_cbranch_scc1 L_abort
    s_waitcnt vmcnt(0)
    s_branch Lgr_129
Lnored_135:
    s_waitcnt lgkmcnt(0)
    s_branch Ljoin_136
Lxt_131:
    s_cmp_lg_u32 s63, 0
    s_cbranch_scc1 Lsg_161
    s_max_u32 s53, s32, 2
    s_sub_u32 s53, s53, 2
    s_mov_b64 exec, 1
    v_mov_b32 v11, s53
    s_mov_b32 s53, 0x5c00000
    buffer_store_dword v11, v0, s[4:7], s53 offen sc1
    s_mov_b64 exec, -1
Lsg_161:
    s_add_u32 s59, s32, 4
    s_min_u32 s59, s59, 59
    s_cmp_lt_u32 s32, 59
    s_cbranch_scc1 Lxr_132
    s_cmp_lg_u32 s28, 2
    s_cbranch_scc1 Lsg_162
    s_lshl_b32 s53, s30, 7
    s_lshl_b32 s54, s29, 2
    s_add_u32 s53, s53, s54
    s_add_u32 s53, s53, 0x5c00080
    s_sub_u32 s54, s32, 1
    s_mov_b64 exec, 1
    v_mov_b32 v11, s54
    buffer_store_dword v11, v0, s[4:7], s53 offen sc1
    s_mov_b64 exec, -1
Lsg_162:
    s_branch Lxr_132
Lrd2_160:
    buffer_load_dwordx4 v[64:67], v1, s[4:7], s45 offen offset:0 sc1
    buffer_load_dwordx4 v[68:71], v1, s[4:7], s45 offen offset:1024 sc1
    buffer_load_dwordx4 v[72:75], v1, s[4:7], s45 offen offset:2048 sc1
    buffer_load_dwordx4 v[76:79], v1, s[4:7], s45 offen offset:3072 sc1
    v_mov_b32 v11, 0
    s_waitcnt vmcnt(7)
    v_mfma_f32_16x16x32_bf16 v[32:35], v[28:31], v[12:15], 0
    v_or3_b32 v11, v11, v12, v13
    v_or3_b32 v11, v11, v14, v15
    s_waitcnt vmcnt(6)
    v_mfma_f32_16x16x32_bf16 v[32:35], v[28:31], v[16:19], v[32:35]
    v_or3_b32 v11, v11, v16, v17
    v_or3_b32 v11, v11, v18, v19
    s_waitcnt vmcnt(5)
    v_mfma_f32_16x16x32_bf16 v[32:35], v[28:31], v[20:23], v[32:35]
    v_or3_b32 v11, v11, v20, v21
    v_or3_b32 v11, v11, v22, v23
    s_waitcnt vmcnt(4)
    v_mfma_f32_16x16x32_bf16 v[32:35], v[28:31], v[24:27], v[32:35]
    v_or3_b32 v11, v11, v24, v25
    v_or3_b32 v11, v11, v26, v27
    v_and_b32 v11, 1, v11
    v_cmp_ne_u32 vcc, 0, v11
    s_cbranch_vccz Lrdok_159
    buffer_load_dwordx4 v[12:15], v1, s[4:7], s45 offen offset:0 sc1
    buffer_load_dwordx4 v[16:19], v1, s[4:7], s45 offen offset:1024 sc1
    buffer_load_dwordx4 v[20:23], v1, s[4:7], s45 offen offset:2048 sc1
    buffer_load_dwordx4 v[24:27], v1, s[4:7], s45 offen offset:3072 sc1
    s_add_u32 s74, s74, 1
    s_cmp_gt_u32 s74, 60000
    s_cbranch_scc1 L_abort
    s_branch Lrd_158
Lglre_144:
    buffer_load_dwordx4 v[12:15], v37, s[4:7], s38 offen sc1
    buffer_load_dword v16, v38, s[4:7], s38 offen sc1
    s_waitcnt vmcnt(2)
    v_max3_u32 v11, v20, v21, v22
    v_max3_u32 v11, v11, v23, v24
    v_cmp_eq_u32 vcc, -1, v11
    s_cbranch_vccz LglB_142
    buffer_load_dwordx4 v[20:23], v37, s[4:7], s38 offen sc1
    buffer_load_dword v24, v38, s[4:7], s38 offen sc1
    s_add_u32 s74, s74, 1
    s_cmp_gt_u32 s74, 60000
    s_cbranch_scc1 L_abort
    s_waitcnt vmcnt(2)
    s_branch Lgl_140
LglB_142:
    ds_write_b128 v37, v[20:23] offset:16384
    ds_write_b32 v38, v24 offset:16384
    s_branch Lglok_143
Lgrre_146:
    buffer_load_dwordx4 v[32:35], v37, s[4:7], s39 offen sc1
    buffer_load_dword v36, v38, s[4:7], s39 offen sc1
    s_add_u32 s74, s74, 1
    s_cmp_gt_u32 s74, 60000
    s_cbranch_scc1 L_abort
    s_waitcnt vmcnt(0)
    s_branch Lgr_145
Lnored_156:
    s_waitcnt lgkmcnt(0)
    s_branch Ljoin_157
Lkvo_151:
    s_add_u32 s54, s32, 3
    s_lshr_b32 s54, s54, 2
    s_cmp_ge_u32 s54, s49
    s_cbranch_scc1 Lkvn_150
    s_mov_b32 m0, s37
    s_mov_b32 exec_hi, 0
    buffer_load_dword v0, s[24:27], 0 offen sc1 lds
    s_mov_b32 exec_hi, -1
    s_branch Lkvok_148
Lkvn_150:
    v_add_u32 v11, s37, v0
    ds_read_b32 v11, v11
    s_waitcnt lgkmcnt(0)
    s_branch Lkvu_149
Lkv_147:
    buffer_load_dword v11, v0, s[24:27], 0 offen sc1
    s_waitcnt vmcnt(0)
Lkvu_149:
    v_and_b32 v11, 0x3ff, v11
    v_cmp_le_u32 vcc, 128, v11
    s_nop 3
    s_lshr_b32 s49, vcc_lo, 16
    s_ff0_i32_b32 s49, s49
    s_cmp_eq_u32 s49, 16
    s_cmov_b32 s49, 18
    s_lshl_b32 s58, s49, 2
    s_sub_u32 s58, s58, 5
    s_cmp_lt_u32 s54, s49
    s_cbranch_scc1 Lkvok_148
    s_add_u32 s74, s74, 1
    s_cmp_gt_u32 s74, 60000
    s_cbranch_scc1 L_abort
    s_sleep 2
    s_branch Lkv_147
Lxt_152:
    s_cmp_lg_u32 s63, 0
    s_cbranch_scc1 Lsg_163
    s_max_u32 s53, s32, 2
    s_sub_u32 s53, s53, 2
    s_mov_b64 exec, 1
    v_mov_b32 v11, s53
    s_mov_b32 s53, 0x5c00000
    buffer_store_dword v11, v0, s[4:7], s53 offen sc1
    s_mov_b64 exec, -1
Lsg_163:
    s_add_u32 s59, s32, 4
    s_min_u32 s59, s59, 59
    s_cmp_lt_u32 s32, 59
    s_cbranch_scc1 Lxr_153
    s_cmp_lg_u32 s28, 2
    s_cbranch_scc1 Lsg_164
    s_lshl_b32 s53, s30, 7
    s_lshl_b32 s54, s29, 2
    s_add_u32 s53, s53, s54
    s_add_u32 s53, s53, 0x5c00080
    s_sub_u32 s54, s32, 1
    s_mov_b64 exec, 1
    v_mov_b32 v11, s54
    buffer_store_dword v11, v0, s[4:7], s53 offen sc1
    s_mov_b64 exec, -1
Lsg_164:
    s_branch Lxr_153
L_rec_last:
    s_barrier
    s_cmp_eq_u32 s29, 0
    s_cbranch_scc1 L_rec_l2
    v_add_u32 v11, s56, v0
    ds_write_b32 v11, v76 offset:26624
    ds_write_b32 v11, v78 offset:26880
L_rec_l2:
    s_mov_b32 s32, 64
L_rec_done:
    v_add_u32 v36, s56, v6
    ds_read_b64_tr_b16 v[32:33], v36 offset:26624
    ds_read_b64_tr_b16 v[34:35], v36 offset:27136
    ds_read_b64 v[38:39], v36 offset:26624
    s_waitcnt lgkmcnt(0)
    s_cmp_lg_u32 s29, 0
    s_cbranch_scc1 Lt1_165
    buffer_store_dwordx4 v[32:35], v1, s[4:7], s48 offen sc1
    s_branch Ltj_166
Lt1_165:
    buffer_store_dwordx2 v[38:39], v6, s[4:7], s48 offen sc1
Ltj_166:
    s_add_u32 s48, s48, s62
    s_mov_b32 s62, 0x2000
    s_waitcnt vmcnt(0)
    s_barrier
    s_cmp_lg_u32 s28, 2
    s_cbranch_scc1 Lsg_167
    s_lshl_b32 s53, s30, 7
    s_lshl_b32 s54, s29, 2
    s_add_u32 s53, s53, s54
    s_add_u32 s53, s53, 0x5c00080
    s_sub_u32 s54, s32, 0
    s_mov_b64 exec, 1
    v_mov_b32 v11, s54
    buffer_store_dword v11, v0, s[4:7], s53 offen sc1
    s_mov_b64 exec, -1
Lsg_167:
    s_branch L_end
L_abort:
    s_mov_b64 exec, 1
    v_mov_b32 v0, 16
    v_mov_b32 v11, 1
    buffer_store_dword v11, v0, s[24:27], 0 offen
    s_branch L_end
L_worker:
    s_mov_b32 s26, s28
    s_mov_b32 s73, s28
    s_sub_u32 s70, s55, 64
    s_mov_b32 s64, s24
    s_mov_b32 s65, s25
    s_mov_b32 s66, 256
    s_mov_b32 s67, 0x20000
    s_load_dwordx2 s[54:55], s[0:1], 0
    s_load_dwordx4 s[16:19], s[0:1], 16
    s_load_dwordx2 s[20:21], s[0:1], 32
    s_load_dwordx4 s[56:59], s[0:1], 64
    s_load_dwordx2 s[62:63], s[0:1], 40
    s_waitcnt lgkmcnt(0)
    s_mov_b64 s[22:23], s[56:57]
    s_mov_b64 s[24:25], s[58:59]
    s_mov_b32 s8, s54
    s_mov_b32 s9, s55
    s_mov_b32 s10, 0x280000
    s_mov_b32 s11, 0x20000
    s_and_b32 s27, s70, 3
    s_lshr_b32 s28, s70, 2
    s_sub_u32 s28, 47, s28
    s_mov_b32 s99, 0
    v_lshlrev_b32 v1, 4, v0
    v_lshrrev_b32 v2, 2, v0
    v_lshrrev_b32 v3, 5, v0
    v_lshlrev_b32 v3, 1, v3
    v_and_b32 v4, 3, v0
    v_xor_b32 v3, v3, v4
    v_lshlrev_b32 v3, 4, v3
    v_lshrrev_b32 v5, 4, v0
    v_bfe_u32 v6, v0, 2, 2
    v_lshl_add_u32 v6, v5, 3, v6
    v_lshlrev_b32 v6, 6, v6
    v_lshl_add_u32 v6, v4, 3, v6
    v_and_b32 v5, 1, v5
    v_lshl_add_u32 v6, v5, 5, v6
    v_xor_b32 v7, 32, v6
    v_add_u32 v8, 0x10000, v6
    v_add_u32 v9, 0x10000, v7
    s_lshr_b32 s44, s26, 1
    s_and_b32 s45, s26, 1
    s_lshl_b32 s45, s45, 6
    s_lshl_b32 s46, s26, 12
    s_mov_b32 s15, 0x20000
L_g1_pass:
    s_mov_b32 s51, 1
    s_mov_b32 s29, s28
    s_mov_b32 s30, s28
    s_lshl_b32 s33, s27, 2
    s_add_u32 s47, s33, s26
    s_mul_i32 s33, s47, 40960
    v_mul_u32_u24 v4, 1280, v2
    v_and_b32 v5, 3, v0
    v_lshl_add_u32 v4, v5, 4, v4
    s_mul_i32 s38, s26, 20480
    s_add_u32 s38, s38, 81920
    s_mov_b32 s39, s33
    v_and_b32 v5, 15, v0
    v_lshlrev_b32 v5, 6, v5
    v_lshrrev_b32 v11, 4, v0
    v_lshl_add_u32 v5, v11, 4, v5
    v_add_u32 v5, s38, v5
    s_add_u32 m0, s38, 0
    s_add_u32 s33, s39, 0
    buffer_load_dwordx4 v4, s[8:11], s33 offen lds
    s_add_u32 m0, s38, 1024
    s_add_u32 s33, s39, 64
    buffer_load_dwordx4 v4, s[8:11], s33 offen lds
    s_add_u32 m0, s38, 2048
    s_add_u32 s33, s39, 128
    buffer_load_dwordx4 v4, s[8:11], s33 offen lds
    s_add_u32 m0, s38, 3072
    s_add_u32 s33, s39, 192
    buffer_load_dwordx4 v4, s[8:11], s33 offen lds
    s_add_u32 m0, s38, 4096
    s_add_u32 s33, s39, 256
    buffer_load_dwordx4 v4, s[8:11], s33 offen lds
    s_add_u32 m0, s38, 5120
    s_add_u32 s33, s39, 320
    buffer_load_dwordx4 v4, s[8:11], s33 offen lds
    s_add_u32 m0, s38, 6144
    s_add_u32 s33, s39, 384
    buffer_load_dwordx4 v4, s[8:11], s33 offen lds
    s_add_u32 m0, s38, 7168
    s_add_u32 s33, s39, 448
    buffer_load_dwordx4 v4, s[8:11], s33 offen lds
    s_add_u32 m0, s38, 8192
    s_add_u32 s33, s39, 512
    buffer_load_dwordx4 v4, s[8:11], s33 offen lds
    s_add_u32 m0, s38, 9216
    s_add_u32 s33, s39, 576
    buffer_load_dwordx4 v4, s[8:11], s33 offen lds
    s_add_u32 m0, s38, 10240
    s_add_u32 s33, s39, 640
    buffer_load_dwordx4 v4, s[8:11], s33 offen lds
    s_add_u32 m0, s38, 11264
    s_add_u32 s33, s39, 704
    buffer_load_dwordx4 v4, s[8:11], s33 offen lds
    s_add_u32 m0, s38, 12288
    s_add_u32 s33, s39, 768
    buffer_load_dwordx4 v4, s[8:11], s33 offen lds
    s_add_u32 m0, s38, 13312
    s_add_u32 s33, s39, 832
    buffer_load_dwordx4 v4, s[8:11], s33 offen lds
    s_add_u32 m0, s38, 14336
    s_add_u32 s33, s39, 896
    buffer_load_dwordx4 v4, s[8:11], s33 offen lds
    s_add_u32 m0, s38, 15360
    s_add_u32 s33, s39, 960
    buffer_load_dwordx4 v4, s[8:11], s33 offen lds
    s_add_u32 m0, s38, 16384
    s_add_u32 s33, s39, 1024
    buffer_load_dwordx4 v4, s[8:11], s33 offen lds
    s_add_u32 m0, s38, 17408
    s_add_u32 s33, s39, 1088
    buffer_load_dwordx4 v4, s[8:11], s33 offen lds
    s_add_u32 m0, s38, 18432
    s_add_u32 s33, s39, 1152
    buffer_load_dwordx4 v4, s[8:11], s33 offen lds
    s_add_u32 m0, s38, 19456
    s_add_u32 s33, s39, 1216
    buffer_load_dwordx4 v4, s[8:11], s33 offen lds
    s_lshr_b32 s33, s30, 6
    s_and_b32 s34, s30, 63
    s_cmp_eq_u32 s33, 0
    s_cselect_b64 s[12:13], s[18:19], s[20:21]
    s_cmp_eq_u32 s33, 2
    s_cselect_b64 s[12:13], s[16:17], s[12:13]
    s_cmp_eq_u32 s44, 0
    s_cselect_b64 s[36:37], s[22:23], s[24:25]
    s_lshl_b32 s35, s34, 1
    s_add_u32 s35, s35, s44
    s_cmp_eq_u32 s33, 3
    s_cselect_b64 s[12:13], s[36:37], s[12:13]
    s_mov_b32 s31, 8192
    s_cmov_b32 s31, 3456
    s_mov_b32 s14, 5242880
    s_cmov_b32 s14, 2211840
    s_cselect_b32 s35, s34, s35
    s_lshl_b32 s35, s35, 6
    s_cmp_ge_u32 s30, 248
    s_cselect_b32 s14, 0, s14
    s_mul_i32 s32, s45, s31
    s_add_u32 s32, s32, s35
    v_mad_u32_u24 v10, v2, s31, v3
    s_add_u32 m0, s46, 0
    s_mul_i32 s33, s31, 0
    s_add_u32 s33, s33, s32
    buffer_load_dwordx4 v10, s[12:15], s33 offen lds
    s_add_u32 m0, s46, 1024
    s_mul_i32 s33, s31, 16
    s_add_u32 s33, s33, s32
    buffer_load_dwordx4 v10, s[12:15], s33 offen lds
    s_add_u32 m0, s46, 2048
    s_mul_i32 s33, s31, 32
    s_add_u32 s33, s33, s32
    buffer_load_dwordx4 v10, s[12:15], s33 offen lds
    s_add_u32 m0, s46, 3072
    s_mul_i32 s33, s31, 48
    s_add_u32 s33, s33, s32
    buffer_load_dwordx4 v10, s[12:15], s33 offen lds
    s_add_u32 m0, s46, 16384
    s_mul_i32 s33, s31, 128
    s_add_u32 s33, s33, s32
    buffer_load_dwordx4 v10, s[12:15], s33 offen lds
    s_add_u32 m0, s46, 17408
    s_mul_i32 s33, s31, 144
    s_add_u32 s33, s33, s32
    buffer_load_dwordx4 v10, s[12:15], s33 offen lds
    s_add_u32 m0, s46, 18432
    s_mul_i32 s33, s31, 160
    s_add_u32 s33, s33, s32
    buffer_load_dwordx4 v10, s[12:15], s33 offen lds
    s_add_u32 m0, s46, 19456
    s_mul_i32 s33, s31, 176
    s_add_u32 s33, s33, s32
    buffer_load_dwordx4 v10, s[12:15], s33 offen lds
    v_mov_b32 v16, 0x3f803f80
    v_mov_b32 v17, 0x3f803f80
    v_mov_b32 v18, 0x3f803f80
    v_mov_b32 v19, 0x3f803f80
    v_and_b32 v11, 3, v0
    v_bfe_u32 v12, v0, 2, 2
    v_lshrrev_b32 v13, 4, v0
    v_cmp_eq_u32 s[78:79], 1, v11
    v_cmp_eq_u32 s[80:81], 2, v11
    v_cmp_eq_u32 s[82:83], 3, v11
    v_cmp_eq_u32 s[76:77], v12, v13
    s_waitcnt vmcnt(8)
    ds_read_b128 v[96:99], v5 offset:0
    ds_read_b128 v[100:103], v5 offset:1024
    ds_read_b128 v[104:107], v5 offset:2048
    ds_read_b128 v[108:111], v5 offset:3072
    ds_read_b128 v[112:115], v5 offset:4096
    ds_read_b128 v[116:119], v5 offset:5120
    ds_read_b128 v[120:123], v5 offset:6144
    ds_read_b128 v[124:127], v5 offset:7168
    ds_read_b128 v[128:131], v5 offset:8192
    ds_read_b128 v[132:135], v5 offset:9216
    ds_read_b128 v[136:139], v5 offset:10240
    ds_read_b128 v[140:143], v5 offset:11264
    s_waitcnt lgkmcnt(6)
    ds_read_b128 v[144:147], v5 offset:12288
    ds_read_b128 v[148:151], v5 offset:13312
    ds_read_b128 v[152:155], v5 offset:14336
    ds_read_b128 v[156:159], v5 offset:15360
    ds_read_b128 v[160:163], v5 offset:16384
    ds_read_b128 v[164:167], v5 offset:17408
    ds_read_b128 v[168:171], v5 offset:18432
    ds_read_b128 v[172:175], v5 offset:19456
    s_waitcnt lgkmcnt(0)
    s_add_u32 m0, s38, 0
    s_add_u32 s33, s39, 20480
    buffer_load_dwordx4 v4, s[8:11], s33 offen lds
    s_add_u32 m0, s38, 1024
    s_add_u32 s33, s39, 20544
    buffer_load_dwordx4 v4, s[8:11], s33 offen lds
    s_add_u32 m0, s38, 2048
    s_add_u32 s33, s39, 20608
    buffer_load_dwordx4 v4, s[8:11], s33 offen lds
    s_add_u32 m0, s38, 3072
    s_add_u32 s33, s39, 20672
    buffer_load_dwordx4 v4, s[8:11], s33 offen lds
    s_add_u32 m0, s38, 4096
    s_add_u32 s33, s39, 20736
    buffer_load_dwordx4 v4, s[8:11], s33 offen lds
    s_add_u32 m0, s38, 5120
    s_add_u32 s33, s39, 20800
    buffer_load_dwordx4 v4, s[8:11], s33 offen lds
    s_add_u32 m0, s38, 6144
    s_add_u32 s33, s39, 20864
    buffer_load_dwordx4 v4, s[8:11], s33 offen lds
    s_add_u32 m0, s38, 7168
    s_add_u32 s33, s39, 20928
    buffer_load_dwordx4 v4, s[8:11], s33 offen lds
    s_add_u32 m0, s38, 8192
    s_add_u32 s33, s39, 20992
    buffer_load_dwordx4 v4, s[8:11], s33 offen lds
    s_add_u32 m0, s38, 9216
    s_add_u32 s33, s39, 21056
    buffer_load_dwordx4 v4, s[8:11], s33 offen lds
    s_add_u32 m0, s38, 10240
    s_add_u32 s33, s39, 21120
    buffer_load_dwordx4 v4, s[8:11], s33 offen lds
    s_add_u32 m0, s38, 11264
    s_add_u32 s33, s39, 21184
    buffer_load_dwordx4 v4, s[8:11], s33 offen lds
    s_add_u32 m0, s38, 12288
    s_add_u32 s33, s39, 21248
    buffer_load_dwordx4 v4, s[8:11], s33 offen lds
    s_add_u32 m0, s38, 13312
    s_add_u32 s33, s39, 21312
    buffer_load_dwordx4 v4, s[8:11], s33 offen lds
    s_add_u32 m0, s38, 14336
    s_add_u32 s33, s39, 21376
    buffer_load_dwordx4 v4, s[8:11], s33 offen lds
    s_add_u32 m0, s38, 15360
    s_add_u32 s33, s39, 21440
    buffer_load_dwordx4 v4, s[8:11], s33 offen lds
    s_add_u32 m0, s38, 16384
    s_add_u32 s33, s39, 21504
    buffer_load_dwordx4 v4, s[8:11], s33 offen lds
    s_add_u32 m0, s38, 17408
    s_add_u32 s33, s39, 21568
    buffer_load_dwordx4 v4, s[8:11], s33 offen lds
    s_add_u32 m0, s38, 18432
    s_add_u32 s33, s39, 21632
    buffer_load_dwordx4 v4, s[8:11], s33 offen lds
    s_add_u32 m0, s38, 19456
    s_add_u32 s33, s39, 21696
    buffer_load_dwordx4 v4, s[8:11], s33 offen lds
    s_add_u32 m0, s46, 32768
    s_mul_i32 s33, s31, 256
    s_add_u32 s33, s33, s32
    buffer_load_dwordx4 v10, s[12:15], s33 offen lds
    s_add_u32 m0, s46, 33792
    s_mul_i32 s33, s31, 272
    s_add_u32 s33, s33, s32
    buffer_load_dwordx4 v10, s[12:15], s33 offen lds
    s_add_u32 m0, s46, 34816
    s_mul_i32 s33, s31, 288
    s_add_u32 s33, s33, s32
    buffer_load_dwordx4 v10, s[12:15], s33 offen lds
    s_add_u32 m0, s46, 35840
    s_mul_i32 s33, s31, 304
    s_add_u32 s33, s33, s32
    buffer_load_dwordx4 v10, s[12:15], s33 offen lds
    s_add_u32 m0, s46, 49152
    s_mul_i32 s33, s31, 384
    s_add_u32 s33, s33, s32
    buffer_load_dwordx4 v10, s[12:15], s33 offen lds
    s_add_u32 m0, s46, 50176
    s_mul_i32 s33, s31, 400
    s_add_u32 s33, s33, s32
    buffer_load_dwordx4 v10, s[12:15], s33 offen lds
    s_add_u32 m0, s46, 51200
    s_mul_i32 s33, s31, 416
    s_add_u32 s33, s33, s32
    buffer_load_dwordx4 v10, s[12:15], s33 offen lds
    s_add_u32 m0, s46, 52224
    s_mul_i32 s33, s31, 432
    s_add_u32 s33, s33, s32
    buffer_load_dwordx4 v10, s[12:15], s33 offen lds
    s_cmp_eq_u32 s26, 1
    s_cselect_b64 s[40:41], s[18:19], s[16:17]
    s_cmp_eq_u32 s26, 2
    s_cselect_b64 s[40:41], s[20:21], s[40:41]
    s_cmp_eq_u32 s26, 3
    s_cselect_b64 s[40:41], s[62:63], s[40:41]
    s_mov_b32 s42, 5242880
    s_cmp_ge_u32 s27, 4
    s_cmov_b32 s42, 0
    s_mov_b32 s43, 0x20000
    v_lshlrev_b32 v11, 6, v0
    s_lshl_b32 s35, s26, 8
    s_add_u32 m0, s35, 65536
    s_lshl_b32 s35, s70, 12
    buffer_load_dword v11, s[40:43], s35 offen lds
    s_add_u32 s35, s35, 786432
    buffer_load_dword v11, s[40:43], s35 offen lds
    s_add_u32 s35, s35, 786432
    buffer_load_dword v11, s[40:43], s35 offen lds
    s_add_u32 s35, s35, 786432
    buffer_load_dword v11, s[40:43], s35 offen lds
    s_add_u32 s35, s35, 786432
    buffer_load_dword v11, s[40:43], s35 offen lds
    s_add_u32 s35, s35, 786432
    buffer_load_dword v11, s[40:43], s35 offen lds
    s_add_u32 s35, s35, 786432
    buffer_load_dword v11, s[40:43], s35 offen lds
    s_add_u32 s35, s35, 786432
    v_mfma_f32_16x16x32_bf16 v[48:51], v[16:19], v[96:99], 0
    v_mfma_f32_16x16x32_bf16 v[52:55], v[96:99], v[96:99], 0
    v_mfma_f32_16x16x32_bf16 v[48:51], v[16:19], v[100:103], v[48:51]
    v_mfma_f32_16x16x32_bf16 v[52:55], v[100:103], v[100:103], v[52:55]
    v_mfma_f32_16x16x32_bf16 v[48:51], v[16:19], v[104:107], v[48:51]
    v_mfma_f32_16x16x32_bf16 v[52:55], v[104:107], v[104:107], v[52:55]
    v_mfma_f32_16x16x32_bf16 v[48:51], v[16:19], v[108:111], v[48:51]
    v_mfma_f32_16x16x32_bf16 v[52:55], v[108:111], v[108:111], v[52:55]
    v_mfma_f32_16x16x32_bf16 v[48:51], v[16:19], v[112:115], v[48:51]
    v_mfma_f32_16x16x32_bf16 v[52:55], v[112:115], v[112:115], v[52:55]
    v_mfma_f32_16x16x32_bf16 v[48:51], v[16:19], v[116:119], v[48:51]
    v_mfma_f32_16x16x32_bf16 v[52:55], v[116:119], v[116:119], v[52:55]
    v_mfma_f32_16x16x32_bf16 v[48:51], v[16:19], v[120:123], v[48:51]
    v_mfma_f32_16x16x32_bf16 v[52:55], v[120:123], v[120:123], v[52:55]
    v_mfma_f32_16x16x32_bf16 v[48:51], v[16:19], v[124:127], v[48:51]
    v_mfma_f32_16x16x32_bf16 v[52:55], v[124:127], v[124:127], v[52:55]
    v_mfma_f32_16x16x32_bf16 v[48:51], v[16:19], v[128:131], v[48:51]
    v_mfma_f32_16x16x32_bf16 v[52:55], v[128:131], v[128:131], v[52:55]
    v_mfma_f32_16x16x32_bf16 v[48:51], v[16:19], v[132:135], v[48:51]
    v_mfma_f32_16x16x32_bf16 v[52:55], v[132:135], v[132:135], v[52:55]
    v_mfma_f32_16x16x32_bf16 v[48:51], v[16:19], v[136:139], v[48:51]
    v_mfma_f32_16x16x32_bf16 v[52:55], v[136:139], v[136:139], v[52:55]
    v_mfma_f32_16x16x32_bf16 v[48:51], v[16:19], v[140:143], v[48:51]
    v_mfma_f32_16x16x32_bf16 v[52:55], v[140:143], v[140:143], v[52:55]
    v_mfma_f32_16x16x32_bf16 v[48:51], v[16:19], v[144:147], v[48:51]
    v_mfma_f32_16x16x32_bf16 v[52:55], v[144:147], v[144:147], v[52:55]
    v_mfma_f32_16x16x32_bf16 v[48:51], v[16:19], v[148:151], v[48:51]
    v_mfma_f32_16x16x32_bf16 v[52:55], v[148:151], v[148:151], v[52:55]
    v_mfma_f32_16x16x32_bf16 v[48:51], v[16:19], v[152:155], v[48:51]
    v_mfma_f32_16x16x32_bf16 v[52:55], v[152:155], v[152:155], v[52:55]
    v_mfma_f32_16x16x32_bf16 v[48:51], v[16:19], v[156:159], v[48:51]
    v_mfma_f32_16x16x32_bf16 v[52:55], v[156:159], v[156:159], v[52:55]
    v_mfma_f32_16x16x32_bf16 v[48:51], v[16:19], v[160:163], v[48:51]
    v_mfma_f32_16x16x32_bf16 v[52:55], v[160:163], v[160:163], v[52:55]
    v_mfma_f32_16x16x32_bf16 v[48:51], v[16:19], v[164:167], v[48:51]
    v_mfma_f32_16x16x32_bf16 v[52:55], v[164:167], v[164:167], v[52:55]
    v_mfma_f32_16x16x32_bf16 v[48:51], v[16:19], v[168:171], v[48:51]
    v_mfma_f32_16x16x32_bf16 v[52:55], v[168:171], v[168:171], v[52:55]
    v_mfma_f32_16x16x32_bf16 v[48:51], v[16:19], v[172:175], v[48:51]
    v_mfma_f32_16x16x32_bf16 v[52:55], v[172:175], v[172:175], v[52:55]
    s_nop 7
    v_cndmask_b32 v52, v52, v53, s[78:79]
    v_cndmask_b32 v52, v52, v54, s[80:81]
    v_cndmask_b32 v52, v52, v55, s[82:83]
    v_cndmask_b32 v82, 0, v52, s[76:77]
    v_mov_b32 v83, v82
    s_nop 1
    v_permlane16_swap_b32 v82, v83
    v_add_f32 v82, v82, v83
    v_mov_b32 v83, v82
    s_nop 1
    v_permlane32_swap_b32 v82, v83
    v_add_f32 v82, v82, v83
    v_mul_f32 v80, 0x3acccccd, v48
    v_mul_f32 v82, 0x3acccccd, v82
    v_fma_f32 v82, -v80, v80, v82
    v_max_f32 v82, 0, v82
    v_add_f32 v82, 0x3727c5ac, v82
    v_rsq_f32 v82, v82
    s_nop 0
    v_mul_f32 v80, v80, v82
    v_lshlrev_b32 v84, 16, v96
    v_and_b32 v85, 0xffff0000, v96
    v_fma_f32 v84, v84, v82, -v80
    v_fma_f32 v85, v85, v82, -v80
    v_cvt_pk_bf16_f32 v96, v84, v85
    v_lshlrev_b32 v86, 16, v97
    v_and_b32 v87, 0xffff0000, v97
    v_fma_f32 v86, v86, v82, -v80
    v_fma_f32 v87, v87, v82, -v80
    v_cvt_pk_bf16_f32 v97, v86, v87
    v_lshlrev_b32 v88, 16, v98
    v_and_b32 v89, 0xffff0000, v98
    v_fma_f32 v88, v88, v82, -v80
    v_fma_f32 v89, v89, v82, -v80
    v_cvt_pk_bf16_f32 v98, v88, v89
    v_lshlrev_b32 v90, 16, v99
    v_and_b32 v91, 0xffff0000, v99
    v_fma_f32 v90, v90, v82, -v80
    v_fma_f32 v91, v91, v82, -v80
    v_cvt_pk_bf16_f32 v99, v90, v91
    v_lshlrev_b32 v84, 16, v100
    v_and_b32 v85, 0xffff0000, v100
    v_fma_f32 v84, v84, v82, -v80
    v_fma_f32 v85, v85, v82, -v80
    v_cvt_pk_bf16_f32 v100, v84, v85
    v_lshlrev_b32 v86, 16, v101
    v_and_b32 v87, 0xffff0000, v101
    v_fma_f32 v86, v86, v82, -v80
    v_fma_f32 v87, v87, v82, -v80
    v_cvt_pk_bf16_f32 v101, v86, v87
    v_lshlrev_b32 v88, 16, v102
    v_and_b32 v89, 0xffff0000, v102
    v_fma_f32 v88, v88, v82, -v80
    v_fma_f32 v89, v89, v82, -v80
    v_cvt_pk_bf16_f32 v102, v88, v89
    v_lshlrev_b32 v90, 16, v103
    v_and_b32 v91, 0xffff0000, v103
    v_fma_f32 v90, v90, v82, -v80
    v_fma_f32 v91, v91, v82, -v80
    v_cvt_pk_bf16_f32 v103, v90, v91
    v_lshlrev_b32 v84, 16, v104
    v_and_b32 v85, 0xffff0000, v104
    v_fma_f32 v84, v84, v82, -v80
    v_fma_f32 v85, v85, v82, -v80
    v_cvt_pk_bf16_f32 v104, v84, v85
    v_lshlrev_b32 v86, 16, v105
    v_and_b32 v87, 0xffff0000, v105
    v_fma_f32 v86, v86, v82, -v80
    v_fma_f32 v87, v87, v82, -v80
    v_cvt_pk_bf16_f32 v105, v86, v87
    v_lshlrev_b32 v88, 16, v106
    v_and_b32 v89, 0xffff0000, v106
    v_fma_f32 v88, v88, v82, -v80
    v_fma_f32 v89, v89, v82, -v80
    v_cvt_pk_bf16_f32 v106, v88, v89
    v_lshlrev_b32 v90, 16, v107
    v_and_b32 v91, 0xffff0000, v107
    v_fma_f32 v90, v90, v82, -v80
    v_fma_f32 v91, v91, v82, -v80
    v_cvt_pk_bf16_f32 v107, v90, v91
    v_lshlrev_b32 v84, 16, v108
    v_and_b32 v85, 0xffff0000, v108
    v_fma_f32 v84, v84, v82, -v80
    v_fma_f32 v85, v85, v82, -v80
    v_cvt_pk_bf16_f32 v108, v84, v85
    v_lshlrev_b32 v86, 16, v109
    v_and_b32 v87, 0xffff0000, v109
    v_fma_f32 v86, v86, v82, -v80
    v_fma_f32 v87, v87, v82, -v80
    v_cvt_pk_bf16_f32 v109, v86, v87
    v_lshlrev_b32 v88, 16, v110
    v_and_b32 v89, 0xffff0000, v110
    v_fma_f32 v88, v88, v82, -v80
    v_fma_f32 v89, v89, v82, -v80
    v_cvt_pk_bf16_f32 v110, v88, v89
    v_lshlrev_b32 v90, 16, v111
    v_and_b32 v91, 0xffff0000, v111
    v_fma_f32 v90, v90, v82, -v80
    v_fma_f32 v91, v91, v82, -v80
    v_cvt_pk_bf16_f32 v111, v90, v91
    v_lshlrev_b32 v84, 16, v112
    v_and_b32 v85, 0xffff0000, v112
    v_fma_f32 v84, v84, v82, -v80
    v_fma_f32 v85, v85, v82, -v80
    v_cvt_pk_bf16_f32 v112, v84, v85
    v_lshlrev_b32 v86, 16, v113
    v_and_b32 v87, 0xffff0000, v113
    v_fma_f32 v86, v86, v82, -v80
    v_fma_f32 v87, v87, v82, -v80
    v_cvt_pk_bf16_f32 v113, v86, v87
    v_lshlrev_b32 v88, 16, v114
    v_and_b32 v89, 0xffff0000, v114
    v_fma_f32 v88, v88, v82, -v80
    v_fma_f32 v89, v89, v82, -v80
    v_cvt_pk_bf16_f32 v114, v88, v89
    v_lshlrev_b32 v90, 16, v115
    v_and_b32 v91, 0xffff0000, v115
    v_fma_f32 v90, v90, v82, -v80
    v_fma_f32 v91, v91, v82, -v80
    v_cvt_pk_bf16_f32 v115, v90, v91
    v_lshlrev_b32 v84, 16, v116
    v_and_b32 v85, 0xffff0000, v116
    v_fma_f32 v84, v84, v82, -v80
    v_fma_f32 v85, v85, v82, -v80
    v_cvt_pk_bf16_f32 v116, v84, v85
    v_lshlrev_b32 v86, 16, v117
    v_and_b32 v87, 0xffff0000, v117
    v_fma_f32 v86, v86, v82, -v80
    v_fma_f32 v87, v87, v82, -v80
    v_cvt_pk_bf16_f32 v117, v86, v87
    v_lshlrev_b32 v88, 16, v118
    v_and_b32 v89, 0xffff0000, v118
    v_fma_f32 v88, v88, v82, -v80
    v_fma_f32 v89, v89, v82, -v80
    v_cvt_pk_bf16_f32 v118, v88, v89
    v_lshlrev_b32 v90, 16, v119
    v_and_b32 v91, 0xffff0000, v119
    v_fma_f32 v90, v90, v82, -v80
    v_fma_f32 v91, v91, v82, -v80
    v_cvt_pk_bf16_f32 v119, v90, v91
    v_lshlrev_b32 v84, 16, v120
    v_and_b32 v85, 0xffff0000, v120
    v_fma_f32 v84, v84, v82, -v80
    v_fma_f32 v85, v85, v82, -v80
    v_cvt_pk_bf16_f32 v120, v84, v85
    v_lshlrev_b32 v86, 16, v121
    v_and_b32 v87, 0xffff0000, v121
    v_fma_f32 v86, v86, v82, -v80
    v_fma_f32 v87, v87, v82, -v80
    v_cvt_pk_bf16_f32 v121, v86, v87
    v_lshlrev_b32 v88, 16, v122
    v_and_b32 v89, 0xffff0000, v122
    v_fma_f32 v88, v88, v82, -v80
    v_fma_f32 v89, v89, v82, -v80
    v_cvt_pk_bf16_f32 v122, v88, v89
    v_lshlrev_b32 v90, 16, v123
    v_and_b32 v91, 0xffff0000, v123
    v_fma_f32 v90, v90, v82, -v80
    v_fma_f32 v91, v91, v82, -v80
    v_cvt_pk_bf16_f32 v123, v90, v91
    v_lshlrev_b32 v84, 16, v124
    v_and_b32 v85, 0xffff0000, v124
    v_fma_f32 v84, v84, v82, -v80
    v_fma_f32 v85, v85, v82, -v80
    v_cvt_pk_bf16_f32 v124, v84, v85
    v_lshlrev_b32 v86, 16, v125
    v_and_b32 v87, 0xffff0000, v125
    v_fma_f32 v86, v86, v82, -v80
    v_fma_f32 v87, v87, v82, -v80
    v_cvt_pk_bf16_f32 v125, v86, v87
    v_lshlrev_b32 v88, 16, v126
    v_and_b32 v89, 0xffff0000, v126
    v_fma_f32 v88, v88, v82, -v80
    v_fma_f32 v89, v89, v82, -v80
    v_cvt_pk_bf16_f32 v126, v88, v89
    v_lshlrev_b32 v90, 16, v127
    v_and_b32 v91, 0xffff0000, v127
    v_fma_f32 v90, v90, v82, -v80
    v_fma_f32 v91, v91, v82, -v80
    v_cvt_pk_bf16_f32 v127, v90, v91
    v_lshlrev_b32 v84, 16, v128
    v_and_b32 v85, 0xffff0000, v128
    v_fma_f32 v84, v84, v82, -v80
    v_fma_f32 v85, v85, v82, -v80
    v_cvt_pk_bf16_f32 v128, v84, v85
    v_lshlrev_b32 v86, 16, v129
    v_and_b32 v87, 0xffff0000, v129
    v_fma_f32 v86, v86, v82, -v80
    v_fma_f32 v87, v87, v82, -v80
    v_cvt_pk_bf16_f32 v129, v86, v87
    v_lshlrev_b32 v88, 16, v130
    v_and_b32 v89, 0xffff0000, v130
    v_fma_f32 v88, v88, v82, -v80
    v_fma_f32 v89, v89, v82, -v80
    v_cvt_pk_bf16_f32 v130, v88, v89
    v_lshlrev_b32 v90, 16, v131
    v_and_b32 v91, 0xffff0000, v131
    v_fma_f32 v90, v90, v82, -v80
    v_fma_f32 v91, v91, v82, -v80
    v_cvt_pk_bf16_f32 v131, v90, v91
    v_lshlrev_b32 v84, 16, v132
    v_and_b32 v85, 0xffff0000, v132
    v_fma_f32 v84, v84, v82, -v80
    v_fma_f32 v85, v85, v82, -v80
    v_cvt_pk_bf16_f32 v132, v84, v85
    v_lshlrev_b32 v86, 16, v133
    v_and_b32 v87, 0xffff0000, v133
    v_fma_f32 v86, v86, v82, -v80
    v_fma_f32 v87, v87, v82, -v80
    v_cvt_pk_bf16_f32 v133, v86, v87
    v_lshlrev_b32 v88, 16, v134
    v_and_b32 v89, 0xffff0000, v134
    v_fma_f32 v88, v88, v82, -v80
    v_fma_f32 v89, v89, v82, -v80
    v_cvt_pk_bf16_f32 v134, v88, v89
    v_lshlrev_b32 v90, 16, v135
    v_and_b32 v91, 0xffff0000, v135
    v_fma_f32 v90, v90, v82, -v80
    v_fma_f32 v91, v91, v82, -v80
    v_cvt_pk_bf16_f32 v135, v90, v91
    v_lshlrev_b32 v84, 16, v136
    v_and_b32 v85, 0xffff0000, v136
    v_fma_f32 v84, v84, v82, -v80
    v_fma_f32 v85, v85, v82, -v80
    v_cvt_pk_bf16_f32 v136, v84, v85
    v_lshlrev_b32 v86, 16, v137
    v_and_b32 v87, 0xffff0000, v137
    v_fma_f32 v86, v86, v82, -v80
    v_fma_f32 v87, v87, v82, -v80
    v_cvt_pk_bf16_f32 v137, v86, v87
    v_lshlrev_b32 v88, 16, v138
    v_and_b32 v89, 0xffff0000, v138
    v_fma_f32 v88, v88, v82, -v80
    v_fma_f32 v89, v89, v82, -v80
    v_cvt_pk_bf16_f32 v138, v88, v89
    v_lshlrev_b32 v90, 16, v139
    v_and_b32 v91, 0xffff0000, v139
    v_fma_f32 v90, v90, v82, -v80
    v_fma_f32 v91, v91, v82, -v80
    v_cvt_pk_bf16_f32 v139, v90, v91
    v_lshlrev_b32 v84, 16, v140
    v_and_b32 v85, 0xffff0000, v140
    v_fma_f32 v84, v84, v82, -v80
    v_fma_f32 v85, v85, v82, -v80
    v_cvt_pk_bf16_f32 v140, v84, v85
    v_lshlrev_b32 v86, 16, v141
    v_and_b32 v87, 0xffff0000, v141
    v_fma_f32 v86, v86, v82, -v80
    v_fma_f32 v87, v87, v82, -v80
    v_cvt_pk_bf16_f32 v141, v86, v87
    v_lshlrev_b32 v88, 16, v142
    v_and_b32 v89, 0xffff0000, v142
    v_fma_f32 v88, v88, v82, -v80
    v_fma_f32 v89, v89, v82, -v80
    v_cvt_pk_bf16_f32 v142, v88, v89
    v_lshlrev_b32 v90, 16, v143
    v_and_b32 v91, 0xffff0000, v143
    v_fma_f32 v90, v90, v82, -v80
    v_fma_f32 v91, v91, v82, -v80
    v_cvt_pk_bf16_f32 v143, v90, v91
    v_lshlrev_b32 v84, 16, v144
    v_and_b32 v85, 0xffff0000, v144
    v_fma_f32 v84, v84, v82, -v80
    v_fma_f32 v85, v85, v82, -v80
    v_cvt_pk_bf16_f32 v144, v84, v85
    v_lshlrev_b32 v86, 16, v145
    v_and_b32 v87, 0xffff0000, v145
    v_fma_f32 v86, v86, v82, -v80
    v_fma_f32 v87, v87, v82, -v80
    v_cvt_pk_bf16_f32 v145, v86, v87
    v_lshlrev_b32 v88, 16, v146
    v_and_b32 v89, 0xffff0000, v146
    v_fma_f32 v88, v88, v82, -v80
    v_fma_f32 v89, v89, v82, -v80
    v_cvt_pk_bf16_f32 v146, v88, v89
    v_lshlrev_b32 v90, 16, v147
    v_and_b32 v91, 0xffff0000, v147
    v_fma_f32 v90, v90, v82, -v80
    v_fma_f32 v91, v91, v82, -v80
    v_cvt_pk_bf16_f32 v147, v90, v91
    v_lshlrev_b32 v84, 16, v148
    v_and_b32 v85, 0xffff0000, v148
    v_fma_f32 v84, v84, v82, -v80
    v_fma_f32 v85, v85, v82, -v80
    v_cvt_pk_bf16_f32 v148, v84, v85
    v_lshlrev_b32 v86, 16, v149
    v_and_b32 v87, 0xffff0000, v149
    v_fma_f32 v86, v86, v82, -v80
    v_fma_f32 v87, v87, v82, -v80
    v_cvt_pk_bf16_f32 v149, v86, v87
    v_lshlrev_b32 v88, 16, v150
    v_and_b32 v89, 0xffff0000, v150
    v_fma_f32 v88, v88, v82, -v80
    v_fma_f32 v89, v89, v82, -v80
    v_cvt_pk_bf16_f32 v150, v88, v89
    v_lshlrev_b32 v90, 16, v151
    v_and_b32 v91, 0xffff0000, v151
    v_fma_f32 v90, v90, v82, -v80
    v_fma_f32 v91, v91, v82, -v80
    v_cvt_pk_bf16_f32 v151, v90, v91
    v_lshlrev_b32 v84, 16, v152
    v_and_b32 v85, 0xffff0000, v152
    v_fma_f32 v84, v84, v82, -v80
    v_fma_f32 v85, v85, v82, -v80
    v_cvt_pk_bf16_f32 v152, v84, v85
    v_lshlrev_b32 v86, 16, v153
    v_and_b32 v87, 0xffff0000, v153
    v_fma_f32 v86, v86, v82, -v80
    v_fma_f32 v87, v87, v82, -v80
    v_cvt_pk_bf16_f32 v153, v86, v87
    v_lshlrev_b32 v88, 16, v154
    v_and_b32 v89, 0xffff0000, v154
    v_fma_f32 v88, v88, v82, -v80
    v_fma_f32 v89, v89, v82, -v80
    v_cvt_pk_bf16_f32 v154, v88, v89
    v_lshlrev_b32 v90, 16, v155
    v_and_b32 v91, 0xffff0000, v155
    v_fma_f32 v90, v90, v82, -v80
    v_fma_f32 v91, v91, v82, -v80
    v_cvt_pk_bf16_f32 v155, v90, v91
    v_lshlrev_b32 v84, 16, v156
    v_and_b32 v85, 0xffff0000, v156
    v_fma_f32 v84, v84, v82, -v80
    v_fma_f32 v85, v85, v82, -v80
    v_cvt_pk_bf16_f32 v156, v84, v85
    v_lshlrev_b32 v86, 16, v157
    v_and_b32 v87, 0xffff0000, v157
    v_fma_f32 v86, v86, v82, -v80
    v_fma_f32 v87, v87, v82, -v80
    v_cvt_pk_bf16_f32 v157, v86, v87
    v_lshlrev_b32 v88, 16, v158
    v_and_b32 v89, 0xffff0000, v158
    v_fma_f32 v88, v88, v82, -v80
    v_fma_f32 v89, v89, v82, -v80
    v_cvt_pk_bf16_f32 v158, v88, v89
    v_lshlrev_b32 v90, 16, v159
    v_and_b32 v91, 0xffff0000, v159
    v_fma_f32 v90, v90, v82, -v80
    v_fma_f32 v91, v91, v82, -v80
    v_cvt_pk_bf16_f32 v159, v90, v91
    v_lshlrev_b32 v84, 16, v160
    v_and_b32 v85, 0xffff0000, v160
    v_fma_f32 v84, v84, v82, -v80
    v_fma_f32 v85, v85, v82, -v80
    v_cvt_pk_bf16_f32 v160, v84, v85
    v_lshlrev_b32 v86, 16, v161
    v_and_b32 v87, 0xffff0000, v161
    v_fma_f32 v86, v86, v82, -v80
    v_fma_f32 v87, v87, v82, -v80
    v_cvt_pk_bf16_f32 v161, v86, v87
    v_lshlrev_b32 v88, 16, v162
    v_and_b32 v89, 0xffff0000, v162
    v_fma_f32 v88, v88, v82, -v80
    v_fma_f32 v89, v89, v82, -v80
    v_cvt_pk_bf16_f32 v162, v88, v89
    v_lshlrev_b32 v90, 16, v163
    v_and_b32 v91, 0xffff0000, v163
    v_fma_f32 v90, v90, v82, -v80
    v_fma_f32 v91, v91, v82, -v80
    v_cvt_pk_bf16_f32 v163, v90, v91
    v_lshlrev_b32 v84, 16, v164
    v_and_b32 v85, 0xffff0000, v164
    v_fma_f32 v84, v84, v82, -v80
    v_fma_f32 v85, v85, v82, -v80
    v_cvt_pk_bf16_f32 v164, v84, v85
    v_lshlrev_b32 v86, 16, v165
    v_and_b32 v87, 0xffff0000, v165
    v_fma_f32 v86, v86, v82, -v80
    v_fma_f32 v87, v87, v82, -v80
    v_cvt_pk_bf16_f32 v165, v86, v87
    v_lshlrev_b32 v88, 16, v166
    v_and_b32 v89, 0xffff0000, v166
    v_fma_f32 v88, v88, v82, -v80
    v_fma_f32 v89, v89, v82, -v80
    v_cvt_pk_bf16_f32 v166, v88, v89
    v_lshlrev_b32 v90, 16, v167
    v_and_b32 v91, 0xffff0000, v167
    v_fma_f32 v90, v90, v82, -v80
    v_fma_f32 v91, v91, v82, -v80
    v_cvt_pk_bf16_f32 v167, v90, v91
    v_lshlrev_b32 v84, 16, v168
    v_and_b32 v85, 0xffff0000, v168
    v_fma_f32 v84, v84, v82, -v80
    v_fma_f32 v85, v85, v82, -v80
    v_cvt_pk_bf16_f32 v168, v84, v85
    v_lshlrev_b32 v86, 16, v169
    v_and_b32 v87, 0xffff0000, v169
    v_fma_f32 v86, v86, v82, -v80
    v_fma_f32 v87, v87, v82, -v80
    v_cvt_pk_bf16_f32 v169, v86, v87
    v_lshlrev_b32 v88, 16, v170
    v_and_b32 v89, 0xffff0000, v170
    v_fma_f32 v88, v88, v82, -v80
    v_fma_f32 v89, v89, v82, -v80
    v_cvt_pk_bf16_f32 v170, v88, v89
    v_lshlrev_b32 v90, 16, v171
    v_and_b32 v91, 0xffff0000, v171
    v_fma_f32 v90, v90, v82, -v80
    v_fma_f32 v91, v91, v82, -v80
    v_cvt_pk_bf16_f32 v171, v90, v91
    v_lshlrev_b32 v84, 16, v172
    v_and_b32 v85, 0xffff0000, v172
    v_fma_f32 v84, v84, v82, -v80
    v_fma_f32 v85, v85, v82, -v80
    v_cvt_pk_bf16_f32 v172, v84, v85
    v_lshlrev_b32 v86, 16, v173
    v_and_b32 v87, 0xffff0000, v173
    v_fma_f32 v86, v86, v82, -v80
    v_fma_f32 v87, v87, v82, -v80
    v_cvt_pk_bf16_f32 v173, v86, v87
    v_lshlrev_b32 v88, 16, v174
    v_and_b32 v89, 0xffff0000, v174
    v_fma_f32 v88, v88, v82, -v80
    v_fma_f32 v89, v89, v82, -v80
    v_cvt_pk_bf16_f32 v174, v88, v89
    v_lshlrev_b32 v90, 16, v175
    v_and_b32 v91, 0xffff0000, v175
    v_fma_f32 v90, v90, v82, -v80
    v_fma_f32 v91, v91, v82, -v80
    v_cvt_pk_bf16_f32 v175, v90, v91
    s_waitcnt vmcnt(15)
    ds_read_b128 v[176:179], v5 offset:0
    ds_read_b128 v[180:183], v5 offset:1024
    ds_read_b128 v[184:187], v5 offset:2048
    ds_read_b128 v[188:191], v5 offset:3072
    ds_read_b128 v[192:195], v5 offset:4096
    ds_read_b128 v[196:199], v5 offset:5120
    ds_read_b128 v[200:203], v5 offset:6144
    ds_read_b128 v[204:207], v5 offset:7168
    ds_read_b128 v[208:211], v5 offset:8192
    ds_read_b128 v[212:215], v5 offset:9216
    ds_read_b128 v[216:219], v5 offset:10240
    ds_read_b128 v[220:223], v5 offset:11264
    s_waitcnt lgkmcnt(6)
    ds_read_b128 v[224:227], v5 offset:12288
    ds_read_b128 v[228:231], v5 offset:13312
    ds_read_b128 v[232:235], v5 offset:14336
    ds_read_b128 v[236:239], v5 offset:15360
    ds_read_b128 v[240:243], v5 offset:16384
    ds_read_b128 v[244:247], v5 offset:17408
    ds_read_b128 v[248:251], v5 offset:18432
    ds_read_b128 v[252:255], v5 offset:19456
    s_waitcnt lgkmcnt(0)
    v_mfma_f32_16x16x32_bf16 v[56:59], v[16:19], v[176:179], 0
    v_mfma_f32_16x16x32_bf16 v[60:63], v[176:179], v[176:179], 0
    v_mfma_f32_16x16x32_bf16 v[56:59], v[16:19], v[180:183], v[56:59]
    v_mfma_f32_16x16x32_bf16 v[60:63], v[180:183], v[180:183], v[60:63]
    v_mfma_f32_16x16x32_bf16 v[56:59], v[16:19], v[184:187], v[56:59]
    v_mfma_f32_16x16x32_bf16 v[60:63], v[184:187], v[184:187], v[60:63]
    v_mfma_f32_16x16x32_bf16 v[56:59], v[16:19], v[188:191], v[56:59]
    v_mfma_f32_16x16x32_bf16 v[60:63], v[188:191], v[188:191], v[60:63]
    v_mfma_f32_16x16x32_bf16 v[56:59], v[16:19], v[192:195], v[56:59]
    v_mfma_f32_16x16x32_bf16 v[60:63], v[192:195], v[192:195], v[60:63]
    v_mfma_f32_16x16x32_bf16 v[56:59], v[16:19], v[196:199], v[56:59]
    v_mfma_f32_16x16x32_bf16 v[60:63], v[196:199], v[196:199], v[60:63]
    v_mfma_f32_16x16x32_bf16 v[56:59], v[16:19], v[200:203], v[56:59]
    v_mfma_f32_16x16x32_bf16 v[60:63], v[200:203], v[200:203], v[60:63]
    v_mfma_f32_16x16x32_bf16 v[56:59], v[16:19], v[204:207], v[56:59]
    v_mfma_f32_16x16x32_bf16 v[60:63], v[204:207], v[204:207], v[60:63]
    v_mfma_f32_16x16x32_bf16 v[56:59], v[16:19], v[208:211], v[56:59]
    v_mfma_f32_16x16x32_bf16 v[60:63], v[208:211], v[208:211], v[60:63]
    v_mfma_f32_16x16x32_bf16 v[56:59], v[16:19], v[212:215], v[56:59]
    v_mfma_f32_16x16x32_bf16 v[60:63], v[212:215], v[212:215], v[60:63]
    v_mfma_f32_16x16x32_bf16 v[56:59], v[16:19], v[216:219], v[56:59]
    v_mfma_f32_16x16x32_bf16 v[60:63], v[216:219], v[216:219], v[60:63]
    v_mfma_f32_16x16x32_bf16 v[56:59], v[16:19], v[220:223], v[56:59]
    v_mfma_f32_16x16x32_bf16 v[60:63], v[220:223], v[220:223], v[60:63]
    v_mfma_f32_16x16x32_bf16 v[56:59], v[16:19], v[224:227], v[56:59]
    v_mfma_f32_16x16x32_bf16 v[60:63], v[224:227], v[224:227], v[60:63]
    v_mfma_f32_16x16x32_bf16 v[56:59], v[16:19], v[228:231], v[56:59]
    v_mfma_f32_16x16x32_bf16 v[60:63], v[228:231], v[228:231], v[60:63]
    v_mfma_f32_16x16x32_bf16 v[56:59], v[16:19], v[232:235], v[56:59]
    v_mfma_f32_16x16x32_bf16 v[60:63], v[232:235], v[232:235], v[60:63]
    v_mfma_f32_16x16x32_bf16 v[56:59], v[16:19], v[236:239], v[56:59]
    v_mfma_f32_16x16x32_bf16 v[60:63], v[236:239], v[236:239], v[60:63]
    v_mfma_f32_16x16x32_bf16 v[56:59], v[16:19], v[240:243], v[56:59]
    v_mfma_f32_16x16x32_bf16 v[60:63], v[240:243], v[240:243], v[60:63]
    v_mfma_f32_16x16x32_bf16 v[56:59], v[16:19], v[244:247], v[56:59]
    v_mfma_f32_16x16x32_bf16 v[60:63], v[244:247], v[244:247], v[60:63]
    v_mfma_f32_16x16x32_bf16 v[56:59], v[16:19], v[248:251], v[56:59]
    v_mfma_f32_16x16x32_bf16 v[60:63], v[248:251], v[248:251], v[60:63]
    v_mfma_f32_16x16x32_bf16 v[56:59], v[16:19], v[252:255], v[56:59]
    v_mfma_f32_16x16x32_bf16 v[60:63], v[252:255], v[252:255], v[60:63]
    s_nop 7
    v_cndmask_b32 v60, v60, v61, s[78:79]
    v_cndmask_b32 v60, v60, v62, s[80:81]
    v_cndmask_b32 v60, v60, v63, s[82:83]
    v_cndmask_b32 v82, 0, v60, s[76:77]
    v_mov_b32 v83, v82
    s_nop 1
    v_permlane16_swap_b32 v82, v83
    v_add_f32 v82, v82, v83
    v_mov_b32 v83, v82
    s_nop 1
    v_permlane32_swap_b32 v82, v83
    v_add_f32 v82, v82, v83
    v_mul_f32 v80, 0x3acccccd, v56
    v_mul_f32 v82, 0x3acccccd, v82
    v_fma_f32 v82, -v80, v80, v82
    v_max_f32 v82, 0, v82
    v_add_f32 v82, 0x3727c5ac, v82
    v_rsq_f32 v82, v82
    s_nop 0
    v_mul_f32 v80, v80, v82
    v_lshlrev_b32 v84, 16, v176
    v_and_b32 v85, 0xffff0000, v176
    v_fma_f32 v84, v84, v82, -v80
    v_fma_f32 v85, v85, v82, -v80
    v_cvt_pk_bf16_f32 v176, v84, v85
    v_lshlrev_b32 v86, 16, v177
    v_and_b32 v87, 0xffff0000, v177
    v_fma_f32 v86, v86, v82, -v80
    v_fma_f32 v87, v87, v82, -v80
    v_cvt_pk_bf16_f32 v177, v86, v87
    v_lshlrev_b32 v88, 16, v178
    v_and_b32 v89, 0xffff0000, v178
    v_fma_f32 v88, v88, v82, -v80
    v_fma_f32 v89, v89, v82, -v80
    v_cvt_pk_bf16_f32 v178, v88, v89
    v_lshlrev_b32 v90, 16, v179
    v_and_b32 v91, 0xffff0000, v179
    v_fma_f32 v90, v90, v82, -v80
    v_fma_f32 v91, v91, v82, -v80
    v_cvt_pk_bf16_f32 v179, v90, v91
    v_lshlrev_b32 v84, 16, v180
    v_and_b32 v85, 0xffff0000, v180
    v_fma_f32 v84, v84, v82, -v80
    v_fma_f32 v85, v85, v82, -v80
    v_cvt_pk_bf16_f32 v180, v84, v85
    v_lshlrev_b32 v86, 16, v181
    v_and_b32 v87, 0xffff0000, v181
    v_fma_f32 v86, v86, v82, -v80
    v_fma_f32 v87, v87, v82, -v80
    v_cvt_pk_bf16_f32 v181, v86, v87
    v_lshlrev_b32 v88, 16, v182
    v_and_b32 v89, 0xffff0000, v182
    v_fma_f32 v88, v88, v82, -v80
    v_fma_f32 v89, v89, v82, -v80
    v_cvt_pk_bf16_f32 v182, v88, v89
    v_lshlrev_b32 v90, 16, v183
    v_and_b32 v91, 0xffff0000, v183
    v_fma_f32 v90, v90, v82, -v80
    v_fma_f32 v91, v91, v82, -v80
    v_cvt_pk_bf16_f32 v183, v90, v91
    v_lshlrev_b32 v84, 16, v184
    v_and_b32 v85, 0xffff0000, v184
    v_fma_f32 v84, v84, v82, -v80
    v_fma_f32 v85, v85, v82, -v80
    v_cvt_pk_bf16_f32 v184, v84, v85
    v_lshlrev_b32 v86, 16, v185
    v_and_b32 v87, 0xffff0000, v185
    v_fma_f32 v86, v86, v82, -v80
    v_fma_f32 v87, v87, v82, -v80
    v_cvt_pk_bf16_f32 v185, v86, v87
    v_lshlrev_b32 v88, 16, v186
    v_and_b32 v89, 0xffff0000, v186
    v_fma_f32 v88, v88, v82, -v80
    v_fma_f32 v89, v89, v82, -v80
    v_cvt_pk_bf16_f32 v186, v88, v89
    v_lshlrev_b32 v90, 16, v187
    v_and_b32 v91, 0xffff0000, v187
    v_fma_f32 v90, v90, v82, -v80
    v_fma_f32 v91, v91, v82, -v80
    v_cvt_pk_bf16_f32 v187, v90, v91
    v_lshlrev_b32 v84, 16, v188
    v_and_b32 v85, 0xffff0000, v188
    v_fma_f32 v84, v84, v82, -v80
    v_fma_f32 v85, v85, v82, -v80
    v_cvt_pk_bf16_f32 v188, v84, v85
    v_lshlrev_b32 v86, 16, v189
    v_and_b32 v87, 0xffff0000, v189
    v_fma_f32 v86, v86, v82, -v80
    v_fma_f32 v87, v87, v82, -v80
    v_cvt_pk_bf16_f32 v189, v86, v87
    v_lshlrev_b32 v88, 16, v190
    v_and_b32 v89, 0xffff0000, v190
    v_fma_f32 v88, v88, v82, -v80
    v_fma_f32 v89, v89, v82, -v80
    v_cvt_pk_bf16_f32 v190, v88, v89
    v_lshlrev_b32 v90, 16, v191
    v_and_b32 v91, 0xffff0000, v191
    v_fma_f32 v90, v90, v82, -v80
    v_fma_f32 v91, v91, v82, -v80
    v_cvt_pk_bf16_f32 v191, v90, v91
    v_lshlrev_b32 v84, 16, v192
    v_and_b32 v85, 0xffff0000, v192
    v_fma_f32 v84, v84, v82, -v80
    v_fma_f32 v85, v85, v82, -v80
    v_cvt_pk_bf16_f32 v192, v84, v85
    v_lshlrev_b32 v86, 16, v193
    v_and_b32 v87, 0xffff0000, v193
    v_fma_f32 v86, v86, v82, -v80
    v_fma_f32 v87, v87, v82, -v80
    v_cvt_pk_bf16_f32 v193, v86, v87
    v_lshlrev_b32 v88, 16, v194
    v_and_b32 v89, 0xffff0000, v194
    v_fma_f32 v88, v88, v82, -v80
    v_fma_f32 v89, v89, v82, -v80
    v_cvt_pk_bf16_f32 v194, v88, v89
    v_lshlrev_b32 v90, 16, v195
    v_and_b32 v91, 0xffff0000, v195
    v_fma_f32 v90, v90, v82, -v80
    v_fma_f32 v91, v91, v82, -v80
    v_cvt_pk_bf16_f32 v195, v90, v91
    v_lshlrev_b32 v84, 16, v196
    v_and_b32 v85, 0xffff0000, v196
    v_fma_f32 v84, v84, v82, -v80
    v_fma_f32 v85, v85, v82, -v80
    v_cvt_pk_bf16_f32 v196, v84, v85
    v_lshlrev_b32 v86, 16, v197
    v_and_b32 v87, 0xffff0000, v197
    v_fma_f32 v86, v86, v82, -v80
    v_fma_f32 v87, v87, v82, -v80
    v_cvt_pk_bf16_f32 v197, v86, v87
    v_lshlrev_b32 v88, 16, v198
    v_and_b32 v89, 0xffff0000, v198
    v_fma_f32 v88, v88, v82, -v80
    v_fma_f32 v89, v89, v82, -v80
    v_cvt_pk_bf16_f32 v198, v88, v89
    v_lshlrev_b32 v90, 16, v199
    v_and_b32 v91, 0xffff0000, v199
    v_fma_f32 v90, v90, v82, -v80
    v_fma_f32 v91, v91, v82, -v80
    v_cvt_pk_bf16_f32 v199, v90, v91
    v_lshlrev_b32 v84, 16, v200
    v_and_b32 v85, 0xffff0000, v200
    v_fma_f32 v84, v84, v82, -v80
    v_fma_f32 v85, v85, v82, -v80
    v_cvt_pk_bf16_f32 v200, v84, v85
    v_lshlrev_b32 v86, 16, v201
    v_and_b32 v87, 0xffff0000, v201
    v_fma_f32 v86, v86, v82, -v80
    v_fma_f32 v87, v87, v82, -v80
    v_cvt_pk_bf16_f32 v201, v86, v87
    v_lshlrev_b32 v88, 16, v202
    v_and_b32 v89, 0xffff0000, v202
    v_fma_f32 v88, v88, v82, -v80
    v_fma_f32 v89, v89, v82, -v80
    v_cvt_pk_bf16_f32 v202, v88, v89
    v_lshlrev_b32 v90, 16, v203
    v_and_b32 v91, 0xffff0000, v203
    v_fma_f32 v90, v90, v82, -v80
    v_fma_f32 v91, v91, v82, -v80
    v_cvt_pk_bf16_f32 v203, v90, v91
    v_lshlrev_b32 v84, 16, v204
    v_and_b32 v85, 0xffff0000, v204
    v_fma_f32 v84, v84, v82, -v80
    v_fma_f32 v85, v85, v82, -v80
    v_cvt_pk_bf16_f32 v204, v84, v85
    v_lshlrev_b32 v86, 16, v205
    v_and_b32 v87, 0xffff0000, v205
    v_fma_f32 v86, v86, v82, -v80
    v_fma_f32 v87, v87, v82, -v80
    v_cvt_pk_bf16_f32 v205, v86, v87
    v_lshlrev_b32 v88, 16, v206
    v_and_b32 v89, 0xffff0000, v206
    v_fma_f32 v88, v88, v82, -v80
    v_fma_f32 v89, v89, v82, -v80
    v_cvt_pk_bf16_f32 v206, v88, v89
    v_lshlrev_b32 v90, 16, v207
    v_and_b32 v91, 0xffff0000, v207
    v_fma_f32 v90, v90, v82, -v80
    v_fma_f32 v91, v91, v82, -v80
    v_cvt_pk_bf16_f32 v207, v90, v91
    v_lshlrev_b32 v84, 16, v208
    v_and_b32 v85, 0xffff0000, v208
    v_fma_f32 v84, v84, v82, -v80
    v_fma_f32 v85, v85, v82, -v80
    v_cvt_pk_bf16_f32 v208, v84, v85
    v_lshlrev_b32 v86, 16, v209
    v_and_b32 v87, 0xffff0000, v209
    v_fma_f32 v86, v86, v82, -v80
    v_fma_f32 v87, v87, v82, -v80
    v_cvt_pk_bf16_f32 v209, v86, v87
    v_lshlrev_b32 v88, 16, v210
    v_and_b32 v89, 0xffff0000, v210
    v_fma_f32 v88, v88, v82, -v80
    v_fma_f32 v89, v89, v82, -v80
    v_cvt_pk_bf16_f32 v210, v88, v89
    v_lshlrev_b32 v90, 16, v211
    v_and_b32 v91, 0xffff0000, v211
    v_fma_f32 v90, v90, v82, -v80
    v_fma_f32 v91, v91, v82, -v80
    v_cvt_pk_bf16_f32 v211, v90, v91
    v_lshlrev_b32 v84, 16, v212
    v_and_b32 v85, 0xffff0000, v212
    v_fma_f32 v84, v84, v82, -v80
    v_fma_f32 v85, v85, v82, -v80
    v_cvt_pk_bf16_f32 v212, v84, v85
    v_lshlrev_b32 v86, 16, v213
    v_and_b32 v87, 0xffff0000, v213
    v_fma_f32 v86, v86, v82, -v80
    v_fma_f32 v87, v87, v82, -v80
    v_cvt_pk_bf16_f32 v213, v86, v87
    v_lshlrev_b32 v88, 16, v214
    v_and_b32 v89, 0xffff0000, v214
    v_fma_f32 v88, v88, v82, -v80
    v_fma_f32 v89, v89, v82, -v80
    v_cvt_pk_bf16_f32 v214, v88, v89
    v_lshlrev_b32 v90, 16, v215
    v_and_b32 v91, 0xffff0000, v215
    v_fma_f32 v90, v90, v82, -v80
    v_fma_f32 v91, v91, v82, -v80
    v_cvt_pk_bf16_f32 v215, v90, v91
    v_lshlrev_b32 v84, 16, v216
    v_and_b32 v85, 0xffff0000, v216
    v_fma_f32 v84, v84, v82, -v80
    v_fma_f32 v85, v85, v82, -v80
    v_cvt_pk_bf16_f32 v216, v84, v85
    v_lshlrev_b32 v86, 16, v217
    v_and_b32 v87, 0xffff0000, v217
    v_fma_f32 v86, v86, v82, -v80
    v_fma_f32 v87, v87, v82, -v80
    v_cvt_pk_bf16_f32 v217, v86, v87
    v_lshlrev_b32 v88, 16, v218
    v_and_b32 v89, 0xffff0000, v218
    v_fma_f32 v88, v88, v82, -v80
    v_fma_f32 v89, v89, v82, -v80
    v_cvt_pk_bf16_f32 v218, v88, v89
    v_lshlrev_b32 v90, 16, v219
    v_and_b32 v91, 0xffff0000, v219
    v_fma_f32 v90, v90, v82, -v80
    v_fma_f32 v91, v91, v82, -v80
    v_cvt_pk_bf16_f32 v219, v90, v91
    v_lshlrev_b32 v84, 16, v220
    v_and_b32 v85, 0xffff0000, v220
    v_fma_f32 v84, v84, v82, -v80
    v_fma_f32 v85, v85, v82, -v80
    v_cvt_pk_bf16_f32 v220, v84, v85
    v_lshlrev_b32 v86, 16, v221
    v_and_b32 v87, 0xffff0000, v221
    v_fma_f32 v86, v86, v82, -v80
    v_fma_f32 v87, v87, v82, -v80
    v_cvt_pk_bf16_f32 v221, v86, v87
    v_lshlrev_b32 v88, 16, v222
    v_and_b32 v89, 0xffff0000, v222
    v_fma_f32 v88, v88, v82, -v80
    v_fma_f32 v89, v89, v82, -v80
    v_cvt_pk_bf16_f32 v222, v88, v89
    v_lshlrev_b32 v90, 16, v223
    v_and_b32 v91, 0xffff0000, v223
    v_fma_f32 v90, v90, v82, -v80
    v_fma_f32 v91, v91, v82, -v80
    v_cvt_pk_bf16_f32 v223, v90, v91
    v_lshlrev_b32 v84, 16, v224
    v_and_b32 v85, 0xffff0000, v224
    v_fma_f32 v84, v84, v82, -v80
    v_fma_f32 v85, v85, v82, -v80
    v_cvt_pk_bf16_f32 v224, v84, v85
    v_lshlrev_b32 v86, 16, v225
    v_and_b32 v87, 0xffff0000, v225
    v_fma_f32 v86, v86, v82, -v80
    v_fma_f32 v87, v87, v82, -v80
    v_cvt_pk_bf16_f32 v225, v86, v87
    v_lshlrev_b32 v88, 16, v226
    v_and_b32 v89, 0xffff0000, v226
    v_fma_f32 v88, v88, v82, -v80
    v_fma_f32 v89, v89, v82, -v80
    v_cvt_pk_bf16_f32 v226, v88, v89
    v_lshlrev_b32 v90, 16, v227
    v_and_b32 v91, 0xffff0000, v227
    v_fma_f32 v90, v90, v82, -v80
    v_fma_f32 v91, v91, v82, -v80
    v_cvt_pk_bf16_f32 v227, v90, v91
    v_lshlrev_b32 v84, 16, v228
    v_and_b32 v85, 0xffff0000, v228
    v_fma_f32 v84, v84, v82, -v80
    v_fma_f32 v85, v85, v82, -v80
    v_cvt_pk_bf16_f32 v228, v84, v85
    v_lshlrev_b32 v86, 16, v229
    v_and_b32 v87, 0xffff0000, v229
    v_fma_f32 v86, v86, v82, -v80
    v_fma_f32 v87, v87, v82, -v80
    v_cvt_pk_bf16_f32 v229, v86, v87
    v_lshlrev_b32 v88, 16, v230
    v_and_b32 v89, 0xffff0000, v230
    v_fma_f32 v88, v88, v82, -v80
    v_fma_f32 v89, v89, v82, -v80
    v_cvt_pk_bf16_f32 v230, v88, v89
    v_lshlrev_b32 v90, 16, v231
    v_and_b32 v91, 0xffff0000, v231
    v_fma_f32 v90, v90, v82, -v80
    v_fma_f32 v91, v91, v82, -v80
    v_cvt_pk_bf16_f32 v231, v90, v91
    v_lshlrev_b32 v84, 16, v232
    v_and_b32 v85, 0xffff0000, v232
    v_fma_f32 v84, v84, v82, -v80
    v_fma_f32 v85, v85, v82, -v80
    v_cvt_pk_bf16_f32 v232, v84, v85
    v_lshlrev_b32 v86, 16, v233
    v_and_b32 v87, 0xffff0000, v233
    v_fma_f32 v86, v86, v82, -v80
    v_fma_f32 v87, v87, v82, -v80
    v_cvt_pk_bf16_f32 v233, v86, v87
    v_lshlrev_b32 v88, 16, v234
    v_and_b32 v89, 0xffff0000, v234
    v_fma_f32 v88, v88, v82, -v80
    v_fma_f32 v89, v89, v82, -v80
    v_cvt_pk_bf16_f32 v234, v88, v89
    v_lshlrev_b32 v90, 16, v235
    v_and_b32 v91, 0xffff0000, v235
    v_fma_f32 v90, v90, v82, -v80
    v_fma_f32 v91, v91, v82, -v80
    v_cvt_pk_bf16_f32 v235, v90, v91
    v_lshlrev_b32 v84, 16, v236
    v_and_b32 v85, 0xffff0000, v236
    v_fma_f32 v84, v84, v82, -v80
    v_fma_f32 v85, v85, v82, -v80
    v_cvt_pk_bf16_f32 v236, v84, v85
    v_lshlrev_b32 v86, 16, v237
    v_and_b32 v87, 0xffff0000, v237
    v_fma_f32 v86, v86, v82, -v80
    v_fma_f32 v87, v87, v82, -v80
    v_cvt_pk_bf16_f32 v237, v86, v87
    v_lshlrev_b32 v88, 16, v238
    v_and_b32 v89, 0xffff0000, v238
    v_fma_f32 v88, v88, v82, -v80
    v_fma_f32 v89, v89, v82, -v80
    v_cvt_pk_bf16_f32 v238, v88, v89
    v_lshlrev_b32 v90, 16, v239
    v_and_b32 v91, 0xffff0000, v239
    v_fma_f32 v90, v90, v82, -v80
    v_fma_f32 v91, v91, v82, -v80
    v_cvt_pk_bf16_f32 v239, v90, v91
    v_lshlrev_b32 v84, 16, v240
    v_and_b32 v85, 0xffff0000, v240
    v_fma_f32 v84, v84, v82, -v80
    v_fma_f32 v85, v85, v82, -v80
    v_cvt_pk_bf16_f32 v240, v84, v85
    v_lshlrev_b32 v86, 16, v241
    v_and_b32 v87, 0xffff0000, v241
    v_fma_f32 v86, v86, v82, -v80
    v_fma_f32 v87, v87, v82, -v80
    v_cvt_pk_bf16_f32 v241, v86, v87
    v_lshlrev_b32 v88, 16, v242
    v_and_b32 v89, 0xffff0000, v242
    v_fma_f32 v88, v88, v82, -v80
    v_fma_f32 v89, v89, v82, -v80
    v_cvt_pk_bf16_f32 v242, v88, v89
    v_lshlrev_b32 v90, 16, v243
    v_and_b32 v91, 0xffff0000, v243
    v_fma_f32 v90, v90, v82, -v80
    v_fma_f32 v91, v91, v82, -v80
    v_cvt_pk_bf16_f32 v243, v90, v91
    v_lshlrev_b32 v84, 16, v244
    v_and_b32 v85, 0xffff0000, v244
    v_fma_f32 v84, v84, v82, -v80
    v_fma_f32 v85, v85, v82, -v80
    v_cvt_pk_bf16_f32 v244, v84, v85
    v_lshlrev_b32 v86, 16, v245
    v_and_b32 v87, 0xffff0000, v245
    v_fma_f32 v86, v86, v82, -v80
    v_fma_f32 v87, v87, v82, -v80
    v_cvt_pk_bf16_f32 v245, v86, v87
    v_lshlrev_b32 v88, 16, v246
    v_and_b32 v89, 0xffff0000, v246
    v_fma_f32 v88, v88, v82, -v80
    v_fma_f32 v89, v89, v82, -v80
    v_cvt_pk_bf16_f32 v246, v88, v89
    v_lshlrev_b32 v90, 16, v247
    v_and_b32 v91, 0xffff0000, v247
    v_fma_f32 v90, v90, v82, -v80
    v_fma_f32 v91, v91, v82, -v80
    v_cvt_pk_bf16_f32 v247, v90, v91
    v_lshlrev_b32 v84, 16, v248
    v_and_b32 v85, 0xffff0000, v248
    v_fma_f32 v84, v84, v82, -v80
    v_fma_f32 v85, v85, v82, -v80
    v_cvt_pk_bf16_f32 v248, v84, v85
    v_lshlrev_b32 v86, 16, v249
    v_and_b32 v87, 0xffff0000, v249
    v_fma_f32 v86, v86, v82, -v80
    v_fma_f32 v87, v87, v82, -v80
    v_cvt_pk_bf16_f32 v249, v86, v87
    v_lshlrev_b32 v88, 16, v250
    v_and_b32 v89, 0xffff0000, v250
    v_fma_f32 v88, v88, v82, -v80
    v_fma_f32 v89, v89, v82, -v80
    v_cvt_pk_bf16_f32 v250, v88, v89
    v_lshlrev_b32 v90, 16, v251
    v_and_b32 v91, 0xffff0000, v251
    v_fma_f32 v90, v90, v82, -v80
    v_fma_f32 v91, v91, v82, -v80
    v_cvt_pk_bf16_f32 v251, v90, v91
    v_lshlrev_b32 v84, 16, v252
    v_and_b32 v85, 0xffff0000, v252
    v_fma_f32 v84, v84, v82, -v80
    v_fma_f32 v85, v85, v82, -v80
    v_cvt_pk_bf16_f32 v252, v84, v85
    v_lshlrev_b32 v86, 16, v253
    v_and_b32 v87, 0xffff0000, v253
    v_fma_f32 v86, v86, v82, -v80
    v_fma_f32 v87, v87, v82, -v80
    v_cvt_pk_bf16_f32 v253, v86, v87
    v_lshlrev_b32 v88, 16, v254
    v_and_b32 v89, 0xffff0000, v254
    v_fma_f32 v88, v88, v82, -v80
    v_fma_f32 v89, v89, v82, -v80
    v_cvt_pk_bf16_f32 v254, v88, v89
    v_lshlrev_b32 v90, 16, v255
    v_and_b32 v91, 0xffff0000, v255
    v_fma_f32 v90, v90, v82, -v80
    v_fma_f32 v91, v91, v82, -v80
    v_cvt_pk_bf16_f32 v255, v90, v91
    s_lshl_b32 s48, s47, 14
    s_mul_i32 s49, s47, 114688
    s_add_u32 s49, s49, 0x3400000
    s_mov_b32 s50, 0xbfb8aa3b
    s_waitcnt vmcnt(0)
    s_barrier
    ds_read_b64_tr_b16 v[16:17], v6 offset:0
    ds_read_b64_tr_b16 v[18:19], v6 offset:256
    ds_read_b64_tr_b16 v[20:21], v7 offset:0
    ds_read_b64_tr_b16 v[22:23], v7 offset:256
    ds_read_b64_tr_b16 v[24:25], v6 offset:8192
    ds_read_b64_tr_b16 v[26:27], v6 offset:8448
    ds_read_b64_tr_b16 v[28:29], v7 offset:8192
    ds_read_b64_tr_b16 v[30:31], v7 offset:8448
    ds_read_b64_tr_b16 v[32:33], v6 offset:2048
    ds_read_b64_tr_b16 v[34:35], v6 offset:2304
    ds_read_b64_tr_b16 v[36:37], v7 offset:2048
    ds_read_b64_tr_b16 v[38:39], v7 offset:2304
L_g1_loop:
    s_lshr_b32 s33, s29, 6
    s_cmp_eq_u32 s33, 1
    s_cbranch_scc1 L_g1_bodyV
L_g1_bodyN:
    s_waitcnt vmcnt(8)
    s_barrier
    s_add_u32 m0, s46, 65536
    s_mul_i32 s33, s31, 512
    s_add_u32 s33, s33, s32
    buffer_load_dwordx4 v10, s[12:15], s33 offen lds
    s_add_u32 m0, s46, 66560
    s_mul_i32 s33, s31, 528
    s_add_u32 s33, s33, s32
    buffer_load_dwordx4 v10, s[12:15], s33 offen lds
    s_add_u32 m0, s46, 67584
    s_mul_i32 s33, s31, 544
    s_add_u32 s33, s33, s32
    buffer_load_dwordx4 v10, s[12:15], s33 offen lds
    s_add_u32 m0, s46, 68608
    s_mul_i32 s33, s31, 560
    s_add_u32 s33, s33, s32
    buffer_load_dwordx4 v10, s[12:15], s33 offen lds
    ds_read_b64_tr_b16 v[40:41], v6 offset:10240
    ds_read_b64_tr_b16 v[42:43], v6 offset:10496
    s_waitcnt lgkmcnt(12)
    v_mfma_f32_16x16x32_bf16 v[48:51], v[16:19], v[96:99], 0
    v_mfma_f32_16x16x32_bf16 v[52:55], v[16:19], v[176:179], 0
    ds_read_b64_tr_b16 v[44:45], v7 offset:10240
    ds_read_b64_tr_b16 v[46:47], v7 offset:10496
    s_waitcnt lgkmcnt(12)
    v_mfma_f32_16x16x32_bf16 v[56:59], v[20:23], v[96:99], 0
    v_mfma_f32_16x16x32_bf16 v[60:63], v[20:23], v[176:179], 0
    ds_read_b64_tr_b16 v[16:17], v6 offset:4096
    ds_read_b64_tr_b16 v[18:19], v6 offset:4352
    s_waitcnt lgkmcnt(12)
    v_mfma_f32_16x16x32_bf16 v[64:67], v[24:27], v[96:99], 0
    v_mfma_f32_16x16x32_bf16 v[68:71], v[24:27], v[176:179], 0
    ds_read_b64_tr_b16 v[20:21], v7 offset:4096
    ds_read_b64_tr_b16 v[22:23], v7 offset:4352
    s_waitcnt lgkmcnt(12)
    v_mfma_f32_16x16x32_bf16 v[72:75], v[28:31], v[96:99], 0
    v_mfma_f32_16x16x32_bf16 v[76:79], v[28:31], v[176:179], 0
    ds_read_b64_tr_b16 v[24:25], v6 offset:12288
    ds_read_b64_tr_b16 v[26:27], v6 offset:12544
    s_waitcnt lgkmcnt(12)
    v_mfma_f32_16x16x32_bf16 v[48:51], v[32:35], v[100:103], v[48:51]
    v_mfma_f32_16x16x32_bf16 v[52:55], v[32:35], v[180:183], v[52:55]
    ds_read_b64_tr_b16 v[28:29], v7 offset:12288
    ds_read_b64_tr_b16 v[30:31], v7 offset:12544
    s_waitcnt lgkmcnt(12)
    v_mfma_f32_16x16x32_bf16 v[56:59], v[36:39], v[100:103], v[56:59]
    v_mfma_f32_16x16x32_bf16 v[60:63], v[36:39], v[180:183], v[60:63]
    ds_read_b64_tr_b16 v[32:33], v6 offset:6144
    ds_read_b64_tr_b16 v[34:35], v6 offset:6400
    s_waitcnt lgkmcnt(12)
    v_mfma_f32_16x16x32_bf16 v[64:67], v[40:43], v[100:103], v[64:67]
    v_mfma_f32_16x16x32_bf16 v[68:71], v[40:43], v[180:183], v[68:71]
    ds_read_b64_tr_b16 v[36:37], v7 offset:6144
    ds_read_b64_tr_b16 v[38:39], v7 offset:6400
    s_waitcnt lgkmcnt(12)
    v_mfma_f32_16x16x32_bf16 v[72:75], v[44:47], v[100:103], v[72:75]
    v_mfma_f32_16x16x32_bf16 v[76:79], v[44:47], v[180:183], v[76:79]
    ds_read_b64_tr_b16 v[40:41], v6 offset:14336
    ds_read_b64_tr_b16 v[42:43], v6 offset:14592
    s_waitcnt lgkmcnt(12)
    v_mfma_f32_16x16x32_bf16 v[48:51], v[16:19], v[104:107], v[48:51]
    v_mfma_f32_16x16x32_bf16 v[52:55], v[16:19], v[184:187], v[52:55]
    ds_read_b64_tr_b16 v[44:45], v7 offset:14336
    ds_read_b64_tr_b16 v[46:47], v7 offset:14592
    s_waitcnt lgkmcnt(12)
    v_mfma_f32_16x16x32_bf16 v[56:59], v[20:23], v[104:107], v[56:59]
    v_mfma_f32_16x16x32_bf16 v[60:63], v[20:23], v[184:187], v[60:63]
    ds_read_b64_tr_b16 v[16:17], v6 offset:16384
    ds_read_b64_tr_b16 v[18:19], v6 offset:16640
    s_waitcnt lgkmcnt(12)
    v_mfma_f32_16x16x32_bf16 v[64:67], v[24:27], v[104:107], v[64:67]
    v_mfma_f32_16x16x32_bf16 v[68:71], v[24:27], v[184:187], v[68:71]
    ds_read_b64_tr_b16 v[20:21], v7 offset:16384
    ds_read_b64_tr_b16 v[22:23], v7 offset:16640
    s_waitcnt lgkmcnt(12)
    v_mfma_f32_16x16x32_bf16 v[72:75], v[28:31], v[104:107], v[72:75]
    v_mfma_f32_16x16x32_bf16 v[76:79], v[28:31], v[184:187], v[76:79]
    ds_read_b64_tr_b16 v[24:25], v6 offset:24576
    ds_read_b64_tr_b16 v[26:27], v6 offset:24832
    s_waitcnt lgkmcnt(12)
    v_mfma_f32_16x16x32_bf16 v[48:51], v[32:35], v[108:111], v[48:51]
    v_mfma_f32_16x16x32_bf16 v[52:55], v[32:35], v[188:191], v[52:55]
    ds_read_b64_tr_b16 v[28:29], v7 offset:24576
    ds_read_b64_tr_b16 v[30:31], v7 offset:24832
    s_waitcnt lgkmcnt(12)
    v_mfma_f32_16x16x32_bf16 v[56:59], v[36:39], v[108:111], v[56:59]
    v_mfma_f32_16x16x32_bf16 v[60:63], v[36:39], v[188:191], v[60:63]
    ds_read_b64_tr_b16 v[32:33], v6 offset:18432
    ds_read_b64_tr_b16 v[34:35], v6 offset:18688
    s_waitcnt lgkmcnt(12)
    v_mfma_f32_16x16x32_bf16 v[64:67], v[40:43], v[108:111], v[64:67]
    v_mfma_f32_16x16x32_bf16 v[68:71], v[40:43], v[188:191], v[68:71]
    ds_read_b64_tr_b16 v[36:37], v7 offset:18432
    ds_read_b64_tr_b16 v[38:39], v7 offset:18688
    s_waitcnt lgkmcnt(12)
    v_mfma_f32_16x16x32_bf16 v[72:75], v[44:47], v[108:111], v[72:75]
    v_mfma_f32_16x16x32_bf16 v[76:79], v[44:47], v[188:191], v[76:79]
    s_waitcnt vmcnt(8)
    s_barrier
    s_add_u32 s30, s30, 48
    s_lshr_b32 s33, s30, 6
    s_and_b32 s34, s30, 63
    s_cmp_eq_u32 s33, 0
    s_cselect_b64 s[12:13], s[18:19], s[20:21]
    s_cmp_eq_u32 s33, 2
    s_cselect_b64 s[12:13], s[16:17], s[12:13]
    s_cmp_eq_u32 s44, 0
    s_cselect_b64 s[36:37], s[22:23], s[24:25]
    s_lshl_b32 s35, s34, 1
    s_add_u32 s35, s35, s44
    s_cmp_eq_u32 s33, 3
    s_cselect_b64 s[12:13], s[36:37], s[12:13]
    s_mov_b32 s31, 8192
    s_cmov_b32 s31, 3456
    s_mov_b32 s14, 5242880
    s_cmov_b32 s14, 2211840
    s_cselect_b32 s35, s34, s35
    s_lshl_b32 s35, s35, 6
    s_cmp_ge_u32 s30, 248
    s_cselect_b32 s14, 0, s14
    s_mul_i32 s32, s45, s31
    s_add_u32 s32, s32, s35
    v_mad_u32_u24 v10, v2, s31, v3
    s_add_u32 m0, s46, 0
    s_mul_i32 s33, s31, 0
    s_add_u32 s33, s33, s32
    buffer_load_dwordx4 v10, s[12:15], s33 offen lds
    s_add_u32 m0, s46, 1024
    s_mul_i32 s33, s31, 16
    s_add_u32 s33, s33, s32
    buffer_load_dwordx4 v10, s[12:15], s33 offen lds
    s_add_u32 m0, s46, 2048
    s_mul_i32 s33, s31, 32
    s_add_u32 s33, s33, s32
    buffer_load_dwordx4 v10, s[12:15], s33 offen lds
    s_add_u32 m0, s46, 3072
    s_mul_i32 s33, s31, 48
    s_add_u32 s33, s33, s32
    buffer_load_dwordx4 v10, s[12:15], s33 offen lds
    ds_read_b64_tr_b16 v[40:41], v6 offset:26624
    ds_read_b64_tr_b16 v[42:43], v6 offset:26880
    s_waitcnt lgkmcnt(12)
    v_mfma_f32_16x16x32_bf16 v[48:51], v[16:19], v[112:115], v[48:51]
    v_mfma_f32_16x16x32_bf16 v[52:55], v[16:19], v[192:195], v[52:55]
    ds_read_b64_tr_b16 v[44:45], v7 offset:26624
    ds_read_b64_tr_b16 v[46:47], v7 offset:26880
    s_waitcnt lgkmcnt(12)
    v_mfma_f32_16x16x32_bf16 v[56:59], v[20:23], v[112:115], v[56:59]
    v_mfma_f32_16x16x32_bf16 v[60:63], v[20:23], v[192:195], v[60:63]
    ds_read_b64_tr_b16 v[16:17], v6 offset:20480
    ds_read_b64_tr_b16 v[18:19], v6 offset:20736
    s_waitcnt lgkmcnt(12)
    v_mfma_f32_16x16x32_bf16 v[64:67], v[24:27], v[112:115], v[64:67]
    v_mfma_f32_16x16x32_bf16 v[68:71], v[24:27], v[192:195], v[68:71]
    ds_read_b64_tr_b16 v[20:21], v7 offset:20480
    ds_read_b64_tr_b16 v[22:23], v7 offset:20736
    s_waitcnt lgkmcnt(12)
    v_mfma_f32_16x16x32_bf16 v[72:75], v[28:31], v[112:115], v[72:75]
    v_mfma_f32_16x16x32_bf16 v[76:79], v[28:31], v[192:195], v[76:79]
    ds_read_b64_tr_b16 v[24:25], v6 offset:28672
    ds_read_b64_tr_b16 v[26:27], v6 offset:28928
    s_waitcnt lgkmcnt(12)
    v_mfma_f32_16x16x32_bf16 v[48:51], v[32:35], v[116:119], v[48:51]
    v_mfma_f32_16x16x32_bf16 v[52:55], v[32:35], v[196:199], v[52:55]
    ds_read_b64_tr_b16 v[28:29], v7 offset:28672
    ds_read_b64_tr_b16 v[30:31], v7 offset:28928
    s_waitcnt lgkmcnt(12)
    v_mfma_f32_16x16x32_bf16 v[56:59], v[36:39], v[116:119], v[56:59]
    v_mfma_f32_16x16x32_bf16 v[60:63], v[36:39], v[196:199], v[60:63]
    ds_read_b64_tr_b16 v[32:33], v6 offset:22528
    ds_read_b64_tr_b16 v[34:35], v6 offset:22784
    s_waitcnt lgkmcnt(12)
    v_mfma_f32_16x16x32_bf16 v[64:67], v[40:43], v[116:119], v[64:67]
    v_mfma_f32_16x16x32_bf16 v[68:71], v[40:43], v[196:199], v[68:71]
    ds_read_b64_tr_b16 v[36:37], v7 offset:22528
    ds_read_b64_tr_b16 v[38:39], v7 offset:22784
    s_waitcnt lgkmcnt(12)
    v_mfma_f32_16x16x32_bf16 v[72:75], v[44:47], v[116:119], v[72:75]
    v_mfma_f32_16x16x32_bf16 v[76:79], v[44:47], v[196:199], v[76:79]
    ds_read_b64_tr_b16 v[40:41], v6 offset:30720
    ds_read_b64_tr_b16 v[42:43], v6 offset:30976
    s_waitcnt lgkmcnt(12)
    v_mfma_f32_16x16x32_bf16 v[48:51], v[16:19], v[120:123], v[48:51]
    v_mfma_f32_16x16x32_bf16 v[52:55], v[16:19], v[200:203], v[52:55]
    ds_read_b64_tr_b16 v[44:45], v7 offset:30720
    ds_read_b64_tr_b16 v[46:47], v7 offset:30976
    s_waitcnt lgkmcnt(12)
    v_mfma_f32_16x16x32_bf16 v[56:59], v[20:23], v[120:123], v[56:59]
    v_mfma_f32_16x16x32_bf16 v[60:63], v[20:23], v[200:203], v[60:63]
    ds_read_b64_tr_b16 v[16:17], v6 offset:32768
    ds_read_b64_tr_b16 v[18:19], v6 offset:33024
    s_waitcnt lgkmcnt(12)
    v_mfma_f32_16x16x32_bf16 v[64:67], v[24:27], v[120:123], v[64:67]
    v_mfma_f32_16x16x32_bf16 v[68:71], v[24:27], v[200:203], v[68:71]
    ds_read_b64_tr_b16 v[20:21], v7 offset:32768
    ds_read_b64_tr_b16 v[22:23], v7 offset:33024
    s_waitcnt lgkmcnt(12)
    v_mfma_f32_16x16x32_bf16 v[72:75], v[28:31], v[120:123], v[72:75]
    v_mfma_f32_16x16x32_bf16 v[76:79], v[28:31], v[200:203], v[76:79]
    ds_read_b64_tr_b16 v[24:25], v6 offset:40960
    ds_read_b64_tr_b16 v[26:27], v6 offset:41216
    s_waitcnt lgkmcnt(12)
    v_mfma_f32_16x16x32_bf16 v[48:51], v[32:35], v[124:127], v[48:51]
    v_mfma_f32_16x16x32_bf16 v[52:55], v[32:35], v[204:207], v[52:55]
    ds_read_b64_tr_b16 v[28:29], v7 offset:40960
    ds_read_b64_tr_b16 v[30:31], v7 offset:41216
    s_waitcnt lgkmcnt(12)
    v_mfma_f32_16x16x32_bf16 v[56:59], v[36:39], v[124:127], v[56:59]
    v_mfma_f32_16x16x32_bf16 v[60:63], v[36:39], v[204:207], v[60:63]
    ds_read_b64_tr_b16 v[32:33], v6 offset:34816
    ds_read_b64_tr_b16 v[34:35], v6 offset:35072
    s_waitcnt lgkmcnt(12)
    v_mfma_f32_16x16x32_bf16 v[64:67], v[40:43], v[124:127], v[64:67]
    v_mfma_f32_16x16x32_bf16 v[68:71], v[40:43], v[204:207], v[68:71]
    ds_read_b64_tr_b16 v[36:37], v7 offset:34816
    ds_read_b64_tr_b16 v[38:39], v7 offset:35072
    s_waitcnt lgkmcnt(12)
    v_mfma_f32_16x16x32_bf16 v[72:75], v[44:47], v[124:127], v[72:75]
    v_mfma_f32_16x16x32_bf16 v[76:79], v[44:47], v[204:207], v[76:79]
    s_waitcnt vmcnt(8)
    s_barrier
    s_add_u32 m0, s46, 16384
    s_mul_i32 s33, s31, 128
    s_add_u32 s33, s33, s32
    buffer_load_dwordx4 v10, s[12:15], s33 offen lds
    s_add_u32 m0, s46, 17408
    s_mul_i32 s33, s31, 144
    s_add_u32 s33, s33, s32
    buffer_load_dwordx4 v10, s[12:15], s33 offen lds
    s_add_u32 m0, s46, 18432
    s_mul_i32 s33, s31, 160
    s_add_u32 s33, s33, s32
    buffer_load_dwordx4 v10, s[12:15], s33 offen lds
    s_add_u32 m0, s46, 19456
    s_mul_i32 s33, s31, 176
    s_add_u32 s33, s33, s32
    buffer_load_dwordx4 v10, s[12:15], s33 offen lds
    s_cmp_eq_u32 s51, 1
    s_mov_b32 s51, 0
    s_cbranch_scc1 Lg1f_168
    s_sub_u32 s37, s29, 48
    s_cmp_lg_u32 s26, 0
    s_cbranch_scc1 Lg1s_169
    s_lshr_b32 s33, s37, 6
    s_mov_b32 s34, 1
    s_cmp_eq_u32 s33, 2
    s_cmov_b32 s34, 0x400
    s_cmp_eq_u32 s33, 3
    s_cmov_b32 s34, 0x100000
    s_lshl_b32 s33, s27, 2
    s_mov_b64 exec, 1
    v_mov_b32 v11, s34
    v_mov_b32 v12, s33
    buffer_atomic_add v11, v12, s[64:67], 0 offen offset:64 sc1
    s_mov_b64 exec, -1
Lg1s_169:
Lg1f_168:
    ds_read_b64_tr_b16 v[40:41], v6 offset:43008
    ds_read_b64_tr_b16 v[42:43], v6 offset:43264
    s_waitcnt lgkmcnt(12)
    v_mfma_f32_16x16x32_bf16 v[48:51], v[16:19], v[128:131], v[48:51]
    v_mfma_f32_16x16x32_bf16 v[52:55], v[16:19], v[208:211], v[52:55]
    ds_read_b64_tr_b16 v[44:45], v7 offset:43008
    ds_read_b64_tr_b16 v[46:47], v7 offset:43264
    s_waitcnt lgkmcnt(12)
    v_mfma_f32_16x16x32_bf16 v[56:59], v[20:23], v[128:131], v[56:59]
    v_mfma_f32_16x16x32_bf16 v[60:63], v[20:23], v[208:211], v[60:63]
    ds_read_b64_tr_b16 v[16:17], v6 offset:36864
    ds_read_b64_tr_b16 v[18:19], v6 offset:37120
    s_waitcnt lgkmcnt(12)
    v_mfma_f32_16x16x32_bf16 v[64:67], v[24:27], v[128:131], v[64:67]
    v_mfma_f32_16x16x32_bf16 v[68:71], v[24:27], v[208:211], v[68:71]
    ds_read_b64_tr_b16 v[20:21], v7 offset:36864
    ds_read_b64_tr_b16 v[22:23], v7 offset:37120
    s_waitcnt lgkmcnt(12)
    v_mfma_f32_16x16x32_bf16 v[72:75], v[28:31], v[128:131], v[72:75]
    v_mfma_f32_16x16x32_bf16 v[76:79], v[28:31], v[208:211], v[76:79]
    ds_read_b64_tr_b16 v[24:25], v6 offset:45056
    ds_read_b64_tr_b16 v[26:27], v6 offset:45312
    s_waitcnt lgkmcnt(12)
    v_mfma_f32_16x16x32_bf16 v[48:51], v[32:35], v[132:135], v[48:51]
    v_mfma_f32_16x16x32_bf16 v[52:55], v[32:35], v[212:215], v[52:55]
    ds_read_b64_tr_b16 v[28:29], v7 offset:45056
    ds_read_b64_tr_b16 v[30:31], v7 offset:45312
    s_waitcnt lgkmcnt(12)
    v_mfma_f32_16x16x32_bf16 v[56:59], v[36:39], v[132:135], v[56:59]
    v_mfma_f32_16x16x32_bf16 v[60:63], v[36:39], v[212:215], v[60:63]
    ds_read_b64_tr_b16 v[32:33], v6 offset:38912
    ds_read_b64_tr_b16 v[34:35], v6 offset:39168
    s_waitcnt lgkmcnt(12)
    v_mfma_f32_16x16x32_bf16 v[64:67], v[40:43], v[132:135], v[64:67]
    v_mfma_f32_16x16x32_bf16 v[68:71], v[40:43], v[212:215], v[68:71]
    ds_read_b64_tr_b16 v[36:37], v7 offset:38912
    ds_read_b64_tr_b16 v[38:39], v7 offset:39168
    s_waitcnt lgkmcnt(12)
    v_mfma_f32_16x16x32_bf16 v[72:75], v[44:47], v[132:135], v[72:75]
    v_mfma_f32_16x16x32_bf16 v[76:79], v[44:47], v[212:215], v[76:79]
    ds_read_b64_tr_b16 v[40:41], v6 offset:47104
    ds_read_b64_tr_b16 v[42:43], v6 offset:47360
    s_waitcnt lgkmcnt(12)
    v_mfma_f32_16x16x32_bf16 v[48:51], v[16:19], v[136:139], v[48:51]
    v_mfma_f32_16x16x32_bf16 v[52:55], v[16:19], v[216:219], v[52:55]
    ds_read_b64_tr_b16 v[44:45], v7 offset:47104
    ds_read_b64_tr_b16 v[46:47], v7 offset:47360
    s_waitcnt lgkmcnt(12)
    v_mfma_f32_16x16x32_bf16 v[56:59], v[20:23], v[136:139], v[56:59]
    v_mfma_f32_16x16x32_bf16 v[60:63], v[20:23], v[216:219], v[60:63]
    ds_read_b64_tr_b16 v[16:17], v6 offset:49152
    ds_read_b64_tr_b16 v[18:19], v6 offset:49408
    s_waitcnt lgkmcnt(12)
    v_mfma_f32_16x16x32_bf16 v[64:67], v[24:27], v[136:139], v[64:67]
    v_mfma_f32_16x16x32_bf16 v[68:71], v[24:27], v[216:219], v[68:71]
    ds_read_b64_tr_b16 v[20:21], v7 offset:49152
    ds_read_b64_tr_b16 v[22:23], v7 offset:49408
    s_waitcnt lgkmcnt(12)
    v_mfma_f32_16x16x32_bf16 v[72:75], v[28:31], v[136:139], v[72:75]
    v_mfma_f32_16x16x32_bf16 v[76:79], v[28:31], v[216:219], v[76:79]
    ds_read_b64_tr_b16 v[24:25], v6 offset:57344
    ds_read_b64_tr_b16 v[26:27], v6 offset:57600
    s_waitcnt lgkmcnt(12)
    v_mfma_f32_16x16x32_bf16 v[48:51], v[32:35], v[140:143], v[48:51]
    v_mfma_f32_16x16x32_bf16 v[52:55], v[32:35], v[220:223], v[52:55]
    ds_read_b64_tr_b16 v[28:29], v7 offset:57344
    ds_read_b64_tr_b16 v[30:31], v7 offset:57600
    s_waitcnt lgkmcnt(12)
    v_mfma_f32_16x16x32_bf16 v[56:59], v[36:39], v[140:143], v[56:59]
    v_mfma_f32_16x16x32_bf16 v[60:63], v[36:39], v[220:223], v[60:63]
    ds_read_b64_tr_b16 v[32:33], v6 offset:51200
    ds_read_b64_tr_b16 v[34:35], v6 offset:51456
    s_waitcnt lgkmcnt(12)
    v_mfma_f32_16x16x32_bf16 v[64:67], v[40:43], v[140:143], v[64:67]
    v_mfma_f32_16x16x32_bf16 v[68:71], v[40:43], v[220:223], v[68:71]
    ds_read_b64_tr_b16 v[36:37], v7 offset:51200
    ds_read_b64_tr_b16 v[38:39], v7 offset:51456
    s_waitcnt lgkmcnt(12)
    v_mfma_f32_16x16x32_bf16 v[72:75], v[44:47], v[140:143], v[72:75]
    v_mfma_f32_16x16x32_bf16 v[76:79], v[44:47], v[220:223], v[76:79]
    s_waitcnt vmcnt(8)
    s_barrier
    s_add_u32 m0, s46, 32768
    s_mul_i32 s33, s31, 256
    s_add_u32 s33, s33, s32
    buffer_load_dwordx4 v10, s[12:15], s33 offen lds
    s_add_u32 m0, s46, 33792
    s_mul_i32 s33, s31, 272
    s_add_u32 s33, s33, s32
    buffer_load_dwordx4 v10, s[12:15], s33 offen lds
    s_add_u32 m0, s46, 34816
    s_mul_i32 s33, s31, 288
    s_add_u32 s33, s33, s32
    buffer_load_dwordx4 v10, s[12:15], s33 offen lds
    s_add_u32 m0, s46, 35840
    s_mul_i32 s33, s31, 304
    s_add_u32 s33, s33, s32
    buffer_load_dwordx4 v10, s[12:15], s33 offen lds
    ds_read_b64_tr_b16 v[40:41], v6 offset:59392
    ds_read_b64_tr_b16 v[42:43], v6 offset:59648
    s_waitcnt lgkmcnt(12)
    v_mfma_f32_16x16x32_bf16 v[48:51], v[16:19], v[144:147], v[48:51]
    v_mfma_f32_16x16x32_bf16 v[52:55], v[16:19], v[224:227], v[52:55]
    ds_read_b64_tr_b16 v[44:45], v7 offset:59392
    ds_read_b64_tr_b16 v[46:47], v7 offset:59648
    s_waitcnt lgkmcnt(12)
    v_mfma_f32_16x16x32_bf16 v[56:59], v[20:23], v[144:147], v[56:59]
    v_mfma_f32_16x16x32_bf16 v[60:63], v[20:23], v[224:227], v[60:63]
    ds_read_b64_tr_b16 v[16:17], v6 offset:53248
    ds_read_b64_tr_b16 v[18:19], v6 offset:53504
    s_waitcnt lgkmcnt(12)
    v_mfma_f32_16x16x32_bf16 v[64:67], v[24:27], v[144:147], v[64:67]
    v_mfma_f32_16x16x32_bf16 v[68:71], v[24:27], v[224:227], v[68:71]
    ds_read_b64_tr_b16 v[20:21], v7 offset:53248
    ds_read_b64_tr_b16 v[22:23], v7 offset:53504
    s_waitcnt lgkmcnt(12)
    v_mfma_f32_16x16x32_bf16 v[72:75], v[28:31], v[144:147], v[72:75]
    v_mfma_f32_16x16x32_bf16 v[76:79], v[28:31], v[224:227], v[76:79]
    ds_read_b64_tr_b16 v[24:25], v6 offset:61440
    ds_read_b64_tr_b16 v[26:27], v6 offset:61696
    s_waitcnt lgkmcnt(12)
    v_mfma_f32_16x16x32_bf16 v[48:51], v[32:35], v[148:151], v[48:51]
    v_mfma_f32_16x16x32_bf16 v[52:55], v[32:35], v[228:231], v[52:55]
    ds_read_b64_tr_b16 v[28:29], v7 offset:61440
    ds_read_b64_tr_b16 v[30:31], v7 offset:61696
    s_waitcnt lgkmcnt(12)
    v_mfma_f32_16x16x32_bf16 v[56:59], v[36:39], v[148:151], v[56:59]
    v_mfma_f32_16x16x32_bf16 v[60:63], v[36:39], v[228:231], v[60:63]
    ds_read_b64_tr_b16 v[32:33], v6 offset:55296
    ds_read_b64_tr_b16 v[34:35], v6 offset:55552
    s_waitcnt lgkmcnt(12)
    v_mfma_f32_16x16x32_bf16 v[64:67], v[40:43], v[148:151], v[64:67]
    v_mfma_f32_16x16x32_bf16 v[68:71], v[40:43], v[228:231], v[68:71]
    ds_read_b64_tr_b16 v[36:37], v7 offset:55296
    ds_read_b64_tr_b16 v[38:39], v7 offset:55552
    s_waitcnt lgkmcnt(12)
    v_mfma_f32_16x16x32_bf16 v[72:75], v[44:47], v[148:151], v[72:75]
    v_mfma_f32_16x16x32_bf16 v[76:79], v[44:47], v[228:231], v[76:79]
    ds_read_b64_tr_b16 v[40:41], v6 offset:63488
    ds_read_b64_tr_b16 v[42:43], v6 offset:63744
    s_waitcnt lgkmcnt(12)
    v_mfma_f32_16x16x32_bf16 v[48:51], v[16:19], v[152:155], v[48:51]
    v_mfma_f32_16x16x32_bf16 v[52:55], v[16:19], v[232:235], v[52:55]
    ds_read_b64_tr_b16 v[44:45], v7 offset:63488
    ds_read_b64_tr_b16 v[46:47], v7 offset:63744
    s_waitcnt lgkmcnt(12)
    v_mfma_f32_16x16x32_bf16 v[56:59], v[20:23], v[152:155], v[56:59]
    v_mfma_f32_16x16x32_bf16 v[60:63], v[20:23], v[232:235], v[60:63]
    ds_read_b64_tr_b16 v[16:17], v8 offset:0
    ds_read_b64_tr_b16 v[18:19], v8 offset:256
    s_waitcnt lgkmcnt(12)
    v_mfma_f32_16x16x32_bf16 v[64:67], v[24:27], v[152:155], v[64:67]
    v_mfma_f32_16x16x32_bf16 v[68:71], v[24:27], v[232:235], v[68:71]
    ds_read_b64_tr_b16 v[20:21], v9 offset:0
    ds_read_b64_tr_b16 v[22:23], v9 offset:256
    s_waitcnt lgkmcnt(12)
    v_mfma_f32_16x16x32_bf16 v[72:75], v[28:31], v[152:155], v[72:75]
    v_mfma_f32_16x16x32_bf16 v[76:79], v[28:31], v[232:235], v[76:79]
    ds_read_b64_tr_b16 v[24:25], v8 offset:8192
    ds_read_b64_tr_b16 v[26:27], v8 offset:8448
    s_waitcnt lgkmcnt(12)
    v_mfma_f32_16x16x32_bf16 v[48:51], v[32:35], v[156:159], v[48:51]
    v_mfma_f32_16x16x32_bf16 v[52:55], v[32:35], v[236:239], v[52:55]
    ds_read_b64_tr_b16 v[28:29], v9 offset:8192
    ds_read_b64_tr_b16 v[30:31], v9 offset:8448
    s_waitcnt lgkmcnt(12)
    v_mfma_f32_16x16x32_bf16 v[56:59], v[36:39], v[156:159], v[56:59]
    v_mfma_f32_16x16x32_bf16 v[60:63], v[36:39], v[236:239], v[60:63]
    ds_read_b64_tr_b16 v[32:33], v8 offset:2048
    ds_read_b64_tr_b16 v[34:35], v8 offset:2304
    s_waitcnt lgkmcnt(12)
    v_mfma_f32_16x16x32_bf16 v[64:67], v[40:43], v[156:159], v[64:67]
    v_mfma_f32_16x16x32_bf16 v[68:71], v[40:43], v[236:239], v[68:71]
    ds_read_b64_tr_b16 v[36:37], v9 offset:2048
    ds_read_b64_tr_b16 v[38:39], v9 offset:2304
    s_waitcnt lgkmcnt(12)
    v_mfma_f32_16x16x32_bf16 v[72:75], v[44:47], v[156:159], v[72:75]
    v_mfma_f32_16x16x32_bf16 v[76:79], v[44:47], v[236:239], v[76:79]
    s_waitcnt vmcnt(8)
    s_barrier
    s_add_u32 m0, s46, 49152
    s_mul_i32 s33, s31, 384
    s_add_u32 s33, s33, s32
    buffer_load_dwordx4 v10, s[12:15], s33 offen lds
    s_add_u32 m0, s46, 50176
    s_mul_i32 s33, s31, 400
    s_add_u32 s33, s33, s32
    buffer_load_dwordx4 v10, s[12:15], s33 offen lds
    s_add_u32 m0, s46, 51200
    s_mul_i32 s33, s31, 416
    s_add_u32 s33, s33, s32
    buffer_load_dwordx4 v10, s[12:15], s33 offen lds
    s_add_u32 m0, s46, 52224
    s_mul_i32 s33, s31, 432
    s_add_u32 s33, s33, s32
    buffer_load_dwordx4 v10, s[12:15], s33 offen lds
    ds_read_b64_tr_b16 v[40:41], v8 offset:10240
    ds_read_b64_tr_b16 v[42:43], v8 offset:10496
    s_waitcnt lgkmcnt(12)
    v_mfma_f32_16x16x32_bf16 v[48:51], v[16:19], v[160:163], v[48:51]
    v_mfma_f32_16x16x32_bf16 v[52:55], v[16:19], v[240:243], v[52:55]
    ds_read_b64_tr_b16 v[44:45], v9 offset:10240
    ds_read_b64_tr_b16 v[46:47], v9 offset:10496
    s_waitcnt lgkmcnt(12)
    v_mfma_f32_16x16x32_bf16 v[56:59], v[20:23], v[160:163], v[56:59]
    v_mfma_f32_16x16x32_bf16 v[60:63], v[20:23], v[240:243], v[60:63]
    ds_read_b64_tr_b16 v[16:17], v8 offset:4096
    ds_read_b64_tr_b16 v[18:19], v8 offset:4352
    s_waitcnt lgkmcnt(12)
    v_mfma_f32_16x16x32_bf16 v[64:67], v[24:27], v[160:163], v[64:67]
    v_mfma_f32_16x16x32_bf16 v[68:71], v[24:27], v[240:243], v[68:71]
    ds_read_b64_tr_b16 v[20:21], v9 offset:4096
    ds_read_b64_tr_b16 v[22:23], v9 offset:4352
    s_waitcnt lgkmcnt(12)
    v_mfma_f32_16x16x32_bf16 v[72:75], v[28:31], v[160:163], v[72:75]
    v_mfma_f32_16x16x32_bf16 v[76:79], v[28:31], v[240:243], v[76:79]
    ds_read_b64_tr_b16 v[24:25], v8 offset:12288
    ds_read_b64_tr_b16 v[26:27], v8 offset:12544
    s_waitcnt lgkmcnt(12)
    v_mfma_f32_16x16x32_bf16 v[48:51], v[32:35], v[164:167], v[48:51]
    v_mfma_f32_16x16x32_bf16 v[52:55], v[32:35], v[244:247], v[52:55]
    ds_read_b64_tr_b16 v[28:29], v9 offset:12288
    ds_read_b64_tr_b16 v[30:31], v9 offset:12544
    s_waitcnt lgkmcnt(12)
    v_mfma_f32_16x16x32_bf16 v[56:59], v[36:39], v[164:167], v[56:59]
    v_mfma_f32_16x16x32_bf16 v[60:63], v[36:39], v[244:247], v[60:63]
    ds_read_b64_tr_b16 v[32:33], v8 offset:6144
    ds_read_b64_tr_b16 v[34:35], v8 offset:6400
    s_waitcnt lgkmcnt(12)
    v_mfma_f32_16x16x32_bf16 v[64:67], v[40:43], v[164:167], v[64:67]
    v_mfma_f32_16x16x32_bf16 v[68:71], v[40:43], v[244:247], v[68:71]
    ds_read_b64_tr_b16 v[36:37], v9 offset:6144
    ds_read_b64_tr_b16 v[38:39], v9 offset:6400
    s_waitcnt lgkmcnt(12)
    v_mfma_f32_16x16x32_bf16 v[72:75], v[44:47], v[164:167], v[72:75]
    v_mfma_f32_16x16x32_bf16 v[76:79], v[44:47], v[244:247], v[76:79]
    ds_read_b64_tr_b16 v[40:41], v8 offset:14336
    ds_read_b64_tr_b16 v[42:43], v8 offset:14592
    s_waitcnt lgkmcnt(12)
    v_mfma_f32_16x16x32_bf16 v[48:51], v[16:19], v[168:171], v[48:51]
    v_mfma_f32_16x16x32_bf16 v[52:55], v[16:19], v[248:251], v[52:55]
    ds_read_b64_tr_b16 v[44:45], v9 offset:14336
    ds_read_b64_tr_b16 v[46:47], v9 offset:14592
    s_waitcnt lgkmcnt(12)
    v_mfma_f32_16x16x32_bf16 v[56:59], v[20:23], v[168:171], v[56:59]
    v_mfma_f32_16x16x32_bf16 v[60:63], v[20:23], v[248:251], v[60:63]
    ds_read_b64_tr_b16 v[16:17], v6 offset:0
    ds_read_b64_tr_b16 v[18:19], v6 offset:256
    s_waitcnt lgkmcnt(12)
    v_mfma_f32_16x16x32_bf16 v[64:67], v[24:27], v[168:171], v[64:67]
    v_mfma_f32_16x16x32_bf16 v[68:71], v[24:27], v[248:251], v[68:71]
    ds_read_b64_tr_b16 v[20:21], v7 offset:0
    ds_read_b64_tr_b16 v[22:23], v7 offset:256
    s_waitcnt lgkmcnt(12)
    v_mfma_f32_16x16x32_bf16 v[72:75], v[28:31], v[168:171], v[72:75]
    v_mfma_f32_16x16x32_bf16 v[76:79], v[28:31], v[248:251], v[76:79]
    ds_read_b64_tr_b16 v[24:25], v6 offset:8192
    ds_read_b64_tr_b16 v[26:27], v6 offset:8448
    s_waitcnt lgkmcnt(12)
    v_mfma_f32_16x16x32_bf16 v[48:51], v[32:35], v[172:175], v[48:51]
    v_mfma_f32_16x16x32_bf16 v[52:55], v[32:35], v[252:255], v[52:55]
    ds_read_b64_tr_b16 v[28:29], v7 offset:8192
    ds_read_b64_tr_b16 v[30:31], v7 offset:8448
    s_waitcnt lgkmcnt(12)
    v_mfma_f32_16x16x32_bf16 v[56:59], v[36:39], v[172:175], v[56:59]
    v_mfma_f32_16x16x32_bf16 v[60:63], v[36:39], v[252:255], v[60:63]
    ds_read_b64_tr_b16 v[32:33], v6 offset:2048
    ds_read_b64_tr_b16 v[34:35], v6 offset:2304
    s_waitcnt lgkmcnt(12)
    v_mfma_f32_16x16x32_bf16 v[64:67], v[40:43], v[172:175], v[64:67]
    v_mfma_f32_16x16x32_bf16 v[68:71], v[40:43], v[252:255], v[68:71]
    ds_read_b64_tr_b16 v[36:37], v7 offset:2048
    ds_read_b64_tr_b16 v[38:39], v7 offset:2304
    s_waitcnt lgkmcnt(12)
    v_mfma_f32_16x16x32_bf16 v[72:75], v[44:47], v[172:175], v[72:75]
    v_mfma_f32_16x16x32_bf16 v[76:79], v[44:47], v[252:255], v[76:79]
    s_and_b32 s34, s29, 63
    s_lshr_b32 s35, s34, 1
    s_lshl_b32 s35, s35, 20
    s_add_u32 s35, s35, s48
    s_and_b32 s36, s34, 1
    s_lshr_b32 s33, s29, 6
    s_cmp_eq_u32 s33, 3
    s_cbranch_scc1 L_g1_epiF
    s_lshr_b32 s37, s35, 1
    s_add_u32 s37, s37, 0x400000
    s_add_u32 s35, s35, 0x1400000
    s_cmp_eq_u32 s33, 0
    s_cselect_b32 s35, s35, s37
    s_lshl_b32 s36, s36, 11
    s_add_u32 s35, s35, s36
    s_add_u32 s36, s35, 4096
    v_cvt_pk_bf16_f32 v80, v48, v49
    v_cvt_pk_bf16_f32 v81, v50, v51
    v_cvt_pk_bf16_f32 v82, v56, v57
    v_cvt_pk_bf16_f32 v83, v58, v59
    buffer_store_dwordx4 v[80:83], v1, s[4:7], s35 offen offset:0 sc1
    v_cvt_pk_bf16_f32 v84, v52, v53
    v_cvt_pk_bf16_f32 v85, v54, v55
    v_cvt_pk_bf16_f32 v86, v60, v61
    v_cvt_pk_bf16_f32 v87, v62, v63
    buffer_store_dwordx4 v[84:87], v1, s[4:7], s36 offen offset:0 sc1
    v_cvt_pk_bf16_f32 v88, v64, v65
    v_cvt_pk_bf16_f32 v89, v66, v67
    v_cvt_pk_bf16_f32 v90, v72, v73
    v_cvt_pk_bf16_f32 v91, v74, v75
    buffer_store_dwordx4 v[88:91], v1, s[4:7], s35 offen offset:1024 sc1
    v_cvt_pk_bf16_f32 v92, v68, v69
    v_cvt_pk_bf16_f32 v93, v70, v71
    v_cvt_pk_bf16_f32 v94, v76, v77
    v_cvt_pk_bf16_f32 v95, v78, v79
    buffer_store_dwordx4 v[92:95], v1, s[4:7], s36 offen offset:1024 sc1
    s_branch L_g1_next
L_g1_epiF:
    s_lshl_b32 s35, s34, 10
    s_add_u32 s35, s35, s49
    s_add_u32 s36, s35, 57344
    v_mul_f32 v80, s50, v48
    v_mul_f32 v81, s50, v49
    v_mul_f32 v82, s50, v50
    v_mul_f32 v83, s50, v51
    v_mul_f32 v84, s50, v56
    v_mul_f32 v85, s50, v57
    v_mul_f32 v86, s50, v58
    v_mul_f32 v87, s50, v59
    v_exp_f32 v80, v80
    v_exp_f32 v81, v81
    v_exp_f32 v82, v82
    v_exp_f32 v83, v83
    v_exp_f32 v84, v84
    v_exp_f32 v85, v85
    v_exp_f32 v86, v86
    v_exp_f32 v87, v87
    v_add_f32 v80, 1.0, v80
    v_add_f32 v81, 1.0, v81
    v_add_f32 v82, 1.0, v82
    v_add_f32 v83, 1.0, v83
    v_add_f32 v84, 1.0, v84
    v_add_f32 v85, 1.0, v85
    v_add_f32 v86, 1.0, v86
    v_add_f32 v87, 1.0, v87
    v_rcp_f32 v80, v80
    v_rcp_f32 v81, v81
    v_rcp_f32 v82, v82
    v_rcp_f32 v83, v83
    v_rcp_f32 v84, v84
    v_rcp_f32 v85, v85
    v_rcp_f32 v86, v86
    v_rcp_f32 v87, v87
    v_mul_f32 v48, v48, v64
    v_mul_f32 v49, v49, v65
    v_mul_f32 v50, v50, v66
    v_mul_f32 v51, v51, v67
    v_mul_f32 v56, v56, v72
    v_mul_f32 v57, v57, v73
    v_mul_f32 v58, v58, v74
    v_mul_f32 v59, v59, v75
    v_mul_f32 v48, v48, v80
    v_mul_f32 v49, v49, v81
    v_mul_f32 v50, v50, v82
    v_mul_f32 v51, v51, v83
    v_mul_f32 v56, v56, v84
    v_mul_f32 v57, v57, v85
    v_mul_f32 v58, v58, v86
    v_mul_f32 v59, v59, v87
    v_cvt_pk_bf16_f32 v88, v48, v49
    v_cvt_pk_bf16_f32 v89, v50, v51
    v_cvt_pk_bf16_f32 v90, v56, v57
    v_cvt_pk_bf16_f32 v91, v58, v59
    buffer_store_dwordx4 v[88:91], v1, s[4:7], s35 offen sc1
    v_mul_f32 v80, s50, v52
    v_mul_f32 v81, s50, v53
    v_mul_f32 v82, s50, v54
    v_mul_f32 v83, s50, v55
    v_mul_f32 v84, s50, v60
    v_mul_f32 v85, s50, v61
    v_mul_f32 v86, s50, v62
    v_mul_f32 v87, s50, v63
    v_exp_f32 v80, v80
    v_exp_f32 v81, v81
    v_exp_f32 v82, v82
    v_exp_f32 v83, v83
    v_exp_f32 v84, v84
    v_exp_f32 v85, v85
    v_exp_f32 v86, v86
    v_exp_f32 v87, v87
    v_add_f32 v80, 1.0, v80
    v_add_f32 v81, 1.0, v81
    v_add_f32 v82, 1.0, v82
    v_add_f32 v83, 1.0, v83
    v_add_f32 v84, 1.0, v84
    v_add_f32 v85, 1.0, v85
    v_add_f32 v86, 1.0, v86
    v_add_f32 v87, 1.0, v87
    v_rcp_f32 v80, v80
    v_rcp_f32 v81, v81
    v_rcp_f32 v82, v82
    v_rcp_f32 v83, v83
    v_rcp_f32 v84, v84
    v_rcp_f32 v85, v85
    v_rcp_f32 v86, v86
    v_rcp_f32 v87, v87
    v_mul_f32 v52, v52, v68
    v_mul_f32 v53, v53, v69
    v_mul_f32 v54, v54, v70
    v_mul_f32 v55, v55, v71
    v_mul_f32 v60, v60, v76
    v_mul_f32 v61, v61, v77
    v_mul_f32 v62, v62, v78
    v_mul_f32 v63, v63, v79
    v_mul_f32 v52, v52, v80
    v_mul_f32 v53, v53, v81
    v_mul_f32 v54, v54, v82
    v_mul_f32 v55, v55, v83
    v_mul_f32 v60, v60, v84
    v_mul_f32 v61, v61, v85
    v_mul_f32 v62, v62, v86
    v_mul_f32 v63, v63, v87
    v_cvt_pk_bf16_f32 v92, v52, v53
    v_cvt_pk_bf16_f32 v93, v54, v55
    v_cvt_pk_bf16_f32 v94, v60, v61
    v_cvt_pk_bf16_f32 v95, v62, v63
    buffer_store_dwordx4 v[92:95], v1, s[4:7], s36 offen sc1
    s_branch L_g1_next
L_g1_bodyV:
    s_waitcnt vmcnt(8)
    s_barrier
    s_add_u32 m0, s46, 65536
    s_mul_i32 s33, s31, 512
    s_add_u32 s33, s33, s32
    buffer_load_dwordx4 v10, s[12:15], s33 offen lds
    s_add_u32 m0, s46, 66560
    s_mul_i32 s33, s31, 528
    s_add_u32 s33, s33, s32
    buffer_load_dwordx4 v10, s[12:15], s33 offen lds
    s_add_u32 m0, s46, 67584
    s_mul_i32 s33, s31, 544
    s_add_u32 s33, s33, s32
    buffer_load_dwordx4 v10, s[12:15], s33 offen lds
    s_add_u32 m0, s46, 68608
    s_mul_i32 s33, s31, 560
    s_add_u32 s33, s33, s32
    buffer_load_dwordx4 v10, s[12:15], s33 offen lds
    ds_read_b64_tr_b16 v[40:41], v6 offset:10240
    ds_read_b64_tr_b16 v[42:43], v6 offset:10496
    s_waitcnt lgkmcnt(12)
    v_mfma_f32_16x16x32_bf16 v[48:51], v[96:99], v[16:19], 0
    v_mfma_f32_16x16x32_bf16 v[52:55], v[176:179], v[16:19], 0
    ds_read_b64_tr_b16 v[44:45], v7 offset:10240
    ds_read_b64_tr_b16 v[46:47], v7 offset:10496
    s_waitcnt lgkmcnt(12)
    v_mfma_f32_16x16x32_bf16 v[56:59], v[96:99], v[20:23], 0
    v_mfma_f32_16x16x32_bf16 v[60:63], v[176:179], v[20:23], 0
    ds_read_b64_tr_b16 v[16:17], v6 offset:4096
    ds_read_b64_tr_b16 v[18:19], v6 offset:4352
    s_waitcnt lgkmcnt(12)
    v_mfma_f32_16x16x32_bf16 v[64:67], v[96:99], v[24:27], 0
    v_mfma_f32_16x16x32_bf16 v[68:71], v[176:179], v[24:27], 0
    ds_read_b64_tr_b16 v[20:21], v7 offset:4096
    ds_read_b64_tr_b16 v[22:23], v7 offset:4352
    s_waitcnt lgkmcnt(12)
    v_mfma_f32_16x16x32_bf16 v[72:75], v[96:99], v[28:31], 0
    v_mfma_f32_16x16x32_bf16 v[76:79], v[176:179], v[28:31], 0
    ds_read_b64_tr_b16 v[24:25], v6 offset:12288
    ds_read_b64_tr_b16 v[26:27], v6 offset:12544
    s_waitcnt lgkmcnt(12)
    v_mfma_f32_16x16x32_bf16 v[48:51], v[100:103], v[32:35], v[48:51]
    v_mfma_f32_16x16x32_bf16 v[52:55], v[180:183], v[32:35], v[52:55]
    ds_read_b64_tr_b16 v[28:29], v7 offset:12288
    ds_read_b64_tr_b16 v[30:31], v7 offset:12544
    s_waitcnt lgkmcnt(12)
    v_mfma_f32_16x16x32_bf16 v[56:59], v[100:103], v[36:39], v[56:59]
    v_mfma_f32_16x16x32_bf16 v[60:63], v[180:183], v[36:39], v[60:63]
    ds_read_b64_tr_b16 v[32:33], v6 offset:6144
    ds_read_b64_tr_b16 v[34:35], v6 offset:6400
    s_waitcnt lgkmcnt(12)
    v_mfma_f32_16x16x32_bf16 v[64:67], v[100:103], v[40:43], v[64:67]
    v_mfma_f32_16x16x32_bf16 v[68:71], v[180:183], v[40:43], v[68:71]
    ds_read_b64_tr_b16 v[36:37], v7 offset:6144
    ds_read_b64_tr_b16 v[38:39], v7 offset:6400
    s_waitcnt lgkmcnt(12)
    v_mfma_f32_16x16x32_bf16 v[72:75], v[100:103], v[44:47], v[72:75]
    v_mfma_f32_16x16x32_bf16 v[76:79], v[180:183], v[44:47], v[76:79]
    ds_read_b64_tr_b16 v[40:41], v6 offset:14336
    ds_read_b64_tr_b16 v[42:43], v6 offset:14592
    s_waitcnt lgkmcnt(12)
    v_mfma_f32_16x16x32_bf16 v[48:51], v[104:107], v[16:19], v[48:51]
    v_mfma_f32_16x16x32_bf16 v[52:55], v[184:187], v[16:19], v[52:55]
    ds_read_b64_tr_b16 v[44:45], v7 offset:14336
    ds_read_b64_tr_b16 v[46:47], v7 offset:14592
    s_waitcnt lgkmcnt(12)
    v_mfma_f32_16x16x32_bf16 v[56:59], v[104:107], v[20:23], v[56:59]
    v_mfma_f32_16x16x32_bf16 v[60:63], v[184:187], v[20:23], v[60:63]
    ds_read_b64_tr_b16 v[16:17], v6 offset:16384
    ds_read_b64_tr_b16 v[18:19], v6 offset:16640
    s_waitcnt lgkmcnt(12)
    v_mfma_f32_16x16x32_bf16 v[64:67], v[104:107], v[24:27], v[64:67]
    v_mfma_f32_16x16x32_bf16 v[68:71], v[184:187], v[24:27], v[68:71]
    ds_read_b64_tr_b16 v[20:21], v7 offset:16384
    ds_read_b64_tr_b16 v[22:23], v7 offset:16640
    s_waitcnt lgkmcnt(12)
    v_mfma_f32_16x16x32_bf16 v[72:75], v[104:107], v[28:31], v[72:75]
    v_mfma_f32_16x16x32_bf16 v[76:79], v[184:187], v[28:31], v[76:79]
    ds_read_b64_tr_b16 v[24:25], v6 offset:24576
    ds_read_b64_tr_b16 v[26:27], v6 offset:24832
    s_waitcnt lgkmcnt(12)
    v_mfma_f32_16x16x32_bf16 v[48:51], v[108:111], v[32:35], v[48:51]
    v_mfma_f32_16x16x32_bf16 v[52:55], v[188:191], v[32:35], v[52:55]
    ds_read_b64_tr_b16 v[28:29], v7 offset:24576
    ds_read_b64_tr_b16 v[30:31], v7 offset:24832
    s_waitcnt lgkmcnt(12)
    v_mfma_f32_16x16x32_bf16 v[56:59], v[108:111], v[36:39], v[56:59]
    v_mfma_f32_16x16x32_bf16 v[60:63], v[188:191], v[36:39], v[60:63]
    ds_read_b64_tr_b16 v[32:33], v6 offset:18432
    ds_read_b64_tr_b16 v[34:35], v6 offset:18688
    s_waitcnt lgkmcnt(12)
    v_mfma_f32_16x16x32_bf16 v[64:67], v[108:111], v[40:43], v[64:67]
    v_mfma_f32_16x16x32_bf16 v[68:71], v[188:191], v[40:43], v[68:71]
    ds_read_b64_tr_b16 v[36:37], v7 offset:18432
    ds_read_b64_tr_b16 v[38:39], v7 offset:18688
    s_waitcnt lgkmcnt(12)
    v_mfma_f32_16x16x32_bf16 v[72:75], v[108:111], v[44:47], v[72:75]
    v_mfma_f32_16x16x32_bf16 v[76:79], v[188:191], v[44:47], v[76:79]
    s_waitcnt vmcnt(8)
    s_barrier
    s_add_u32 s30, s30, 48
    s_lshr_b32 s33, s30, 6
    s_and_b32 s34, s30, 63
    s_cmp_eq_u32 s33, 0
    s_cselect_b64 s[12:13], s[18:19], s[20:21]
    s_cmp_eq_u32 s33, 2
    s_cselect_b64 s[12:13], s[16:17], s[12:13]
    s_cmp_eq_u32 s44, 0
    s_cselect_b64 s[36:37], s[22:23], s[24:25]
    s_lshl_b32 s35, s34, 1
    s_add_u32 s35, s35, s44
    s_cmp_eq_u32 s33, 3
    s_cselect_b64 s[12:13], s[36:37], s[12:13]
    s_mov_b32 s31, 8192
    s_cmov_b32 s31, 3456
    s_mov_b32 s14, 5242880
    s_cmov_b32 s14, 2211840
    s_cselect_b32 s35, s34, s35
    s_lshl_b32 s35, s35, 6
    s_cmp_ge_u32 s30, 248
    s_cselect_b32 s14, 0, s14
    s_mul_i32 s32, s45, s31
    s_add_u32 s32, s32, s35
    v_mad_u32_u24 v10, v2, s31, v3
    s_add_u32 m0, s46, 0
    s_mul_i32 s33, s31, 0
    s_add_u32 s33, s33, s32
    buffer_load_dwordx4 v10, s[12:15], s33 offen lds
    s_add_u32 m0, s46, 1024
    s_mul_i32 s33, s31, 16
    s_add_u32 s33, s33, s32
    buffer_load_dwordx4 v10, s[12:15], s33 offen lds
    s_add_u32 m0, s46, 2048
    s_mul_i32 s33, s31, 32
    s_add_u32 s33, s33, s32
    buffer_load_dwordx4 v10, s[12:15], s33 offen lds
    s_add_u32 m0, s46, 3072
    s_mul_i32 s33, s31, 48
    s_add_u32 s33, s33, s32
    buffer_load_dwordx4 v10, s[12:15], s33 offen lds
    ds_read_b64_tr_b16 v[40:41], v6 offset:26624
    ds_read_b64_tr_b16 v[42:43], v6 offset:26880
    s_waitcnt lgkmcnt(12)
    v_mfma_f32_16x16x32_bf16 v[48:51], v[112:115], v[16:19], v[48:51]
    v_mfma_f32_16x16x32_bf16 v[52:55], v[192:195], v[16:19], v[52:55]
    ds_read_b64_tr_b16 v[44:45], v7 offset:26624
    ds_read_b64_tr_b16 v[46:47], v7 offset:26880
    s_waitcnt lgkmcnt(12)
    v_mfma_f32_16x16x32_bf16 v[56:59], v[112:115], v[20:23], v[56:59]
    v_mfma_f32_16x16x32_bf16 v[60:63], v[192:195], v[20:23], v[60:63]
    ds_read_b64_tr_b16 v[16:17], v6 offset:20480
    ds_read_b64_tr_b16 v[18:19], v6 offset:20736
    s_waitcnt lgkmcnt(12)
    v_mfma_f32_16x16x32_bf16 v[64:67], v[112:115], v[24:27], v[64:67]
    v_mfma_f32_16x16x32_bf16 v[68:71], v[192:195], v[24:27], v[68:71]
    ds_read_b64_tr_b16 v[20:21], v7 offset:20480
    ds_read_b64_tr_b16 v[22:23], v7 offset:20736
    s_waitcnt lgkmcnt(12)
    v_mfma_f32_16x16x32_bf16 v[72:75], v[112:115], v[28:31], v[72:75]
    v_mfma_f32_16x16x32_bf16 v[76:79], v[192:195], v[28:31], v[76:79]
    ds_read_b64_tr_b16 v[24:25], v6 offset:28672
    ds_read_b64_tr_b16 v[26:27], v6 offset:28928
    s_waitcnt lgkmcnt(12)
    v_mfma_f32_16x16x32_bf16 v[48:51], v[116:119], v[32:35], v[48:51]
    v_mfma_f32_16x16x32_bf16 v[52:55], v[196:199], v[32:35], v[52:55]
    ds_read_b64_tr_b16 v[28:29], v7 offset:28672
    ds_read_b64_tr_b16 v[30:31], v7 offset:28928
    s_waitcnt lgkmcnt(12)
    v_mfma_f32_16x16x32_bf16 v[56:59], v[116:119], v[36:39], v[56:59]
    v_mfma_f32_16x16x32_bf16 v[60:63], v[196:199], v[36:39], v[60:63]
    ds_read_b64_tr_b16 v[32:33], v6 offset:22528
    ds_read_b64_tr_b16 v[34:35], v6 offset:22784
    s_waitcnt lgkmcnt(12)
    v_mfma_f32_16x16x32_bf16 v[64:67], v[116:119], v[40:43], v[64:67]
    v_mfma_f32_16x16x32_bf16 v[68:71], v[196:199], v[40:43], v[68:71]
    ds_read_b64_tr_b16 v[36:37], v7 offset:22528
    ds_read_b64_tr_b16 v[38:39], v7 offset:22784
    s_waitcnt lgkmcnt(12)
    v_mfma_f32_16x16x32_bf16 v[72:75], v[116:119], v[44:47], v[72:75]
    v_mfma_f32_16x16x32_bf16 v[76:79], v[196:199], v[44:47], v[76:79]
    ds_read_b64_tr_b16 v[40:41], v6 offset:30720
    ds_read_b64_tr_b16 v[42:43], v6 offset:30976
    s_waitcnt lgkmcnt(12)
    v_mfma_f32_16x16x32_bf16 v[48:51], v[120:123], v[16:19], v[48:51]
    v_mfma_f32_16x16x32_bf16 v[52:55], v[200:203], v[16:19], v[52:55]
    ds_read_b64_tr_b16 v[44:45], v7 offset:30720
    ds_read_b64_tr_b16 v[46:47], v7 offset:30976
    s_waitcnt lgkmcnt(12)
    v_mfma_f32_16x16x32_bf16 v[56:59], v[120:123], v[20:23], v[56:59]
    v_mfma_f32_16x16x32_bf16 v[60:63], v[200:203], v[20:23], v[60:63]
    ds_read_b64_tr_b16 v[16:17], v6 offset:32768
    ds_read_b64_tr_b16 v[18:19], v6 offset:33024
    s_waitcnt lgkmcnt(12)
    v_mfma_f32_16x16x32_bf16 v[64:67], v[120:123], v[24:27], v[64:67]
    v_mfma_f32_16x16x32_bf16 v[68:71], v[200:203], v[24:27], v[68:71]
    ds_read_b64_tr_b16 v[20:21], v7 offset:32768
    ds_read_b64_tr_b16 v[22:23], v7 offset:33024
    s_waitcnt lgkmcnt(12)
    v_mfma_f32_16x16x32_bf16 v[72:75], v[120:123], v[28:31], v[72:75]
    v_mfma_f32_16x16x32_bf16 v[76:79], v[200:203], v[28:31], v[76:79]
    ds_read_b64_tr_b16 v[24:25], v6 offset:40960
    ds_read_b64_tr_b16 v[26:27], v6 offset:41216
    s_waitcnt lgkmcnt(12)
    v_mfma_f32_16x16x32_bf16 v[48:51], v[124:127], v[32:35], v[48:51]
    v_mfma_f32_16x16x32_bf16 v[52:55], v[204:207], v[32:35], v[52:55]
    ds_read_b64_tr_b16 v[28:29], v7 offset:40960
    ds_read_b64_tr_b16 v[30:31], v7 offset:41216
    s_waitcnt lgkmcnt(12)
    v_mfma_f32_16x16x32_bf16 v[56:59], v[124:127], v[36:39], v[56:59]
    v_mfma_f32_16x16x32_bf16 v[60:63], v[204:207], v[36:39], v[60:63]
    ds_read_b64_tr_b16 v[32:33], v6 offset:34816
    ds_read_b64_tr_b16 v[34:35], v6 offset:35072
    s_waitcnt lgkmcnt(12)
    v_mfma_f32_16x16x32_bf16 v[64:67], v[124:127], v[40:43], v[64:67]
    v_mfma_f32_16x16x32_bf16 v[68:71], v[204:207], v[40:43], v[68:71]
    ds_read_b64_tr_b16 v[36:37], v7 offset:34816
    ds_read_b64_tr_b16 v[38:39], v7 offset:35072
    s_waitcnt lgkmcnt(12)
    v_mfma_f32_16x16x32_bf16 v[72:75], v[124:127], v[44:47], v[72:75]
    v_mfma_f32_16x16x32_bf16 v[76:79], v[204:207], v[44:47], v[76:79]
    s_waitcnt vmcnt(8)
    s_barrier
    s_add_u32 m0, s46, 16384
    s_mul_i32 s33, s31, 128
    s_add_u32 s33, s33, s32
    buffer_load_dwordx4 v10, s[12:15], s33 offen lds
    s_add_u32 m0, s46, 17408
    s_mul_i32 s33, s31, 144
    s_add_u32 s33, s33, s32
    buffer_load_dwordx4 v10, s[12:15], s33 offen lds
    s_add_u32 m0, s46, 18432
    s_mul_i32 s33, s31, 160
    s_add_u32 s33, s33, s32
    buffer_load_dwordx4 v10, s[12:15], s33 offen lds
    s_add_u32 m0, s46, 19456
    s_mul_i32 s33, s31, 176
    s_add_u32 s33, s33, s32
    buffer_load_dwordx4 v10, s[12:15], s33 offen lds
    s_cmp_eq_u32 s51, 1
    s_mov_b32 s51, 0
    s_cbranch_scc1 Lg1f_170
    s_sub_u32 s37, s29, 48
    s_cmp_lg_u32 s26, 0
    s_cbranch_scc1 Lg1s_171
    s_lshr_b32 s33, s37, 6
    s_mov_b32 s34, 1
    s_cmp_eq_u32 s33, 2
    s_cmov_b32 s34, 0x400
    s_cmp_eq_u32 s33, 3
    s_cmov_b32 s34, 0x100000
    s_lshl_b32 s33, s27, 2
    s_mov_b64 exec, 1
    v_mov_b32 v11, s34
    v_mov_b32 v12, s33
    buffer_atomic_add v11, v12, s[64:67], 0 offen offset:64 sc1
    s_mov_b64 exec, -1
Lg1s_171:
Lg1f_170:
    ds_read_b64_tr_b16 v[40:41], v6 offset:43008
    ds_read_b64_tr_b16 v[42:43], v6 offset:43264
    s_waitcnt lgkmcnt(12)
    v_mfma_f32_16x16x32_bf16 v[48:51], v[128:131], v[16:19], v[48:51]
    v_mfma_f32_16x16x32_bf16 v[52:55], v[208:211], v[16:19], v[52:55]
    ds_read_b64_tr_b16 v[44:45], v7 offset:43008
    ds_read_b64_tr_b16 v[46:47], v7 offset:43264
    s_waitcnt lgkmcnt(12)
    v_mfma_f32_16x16x32_bf16 v[56:59], v[128:131], v[20:23], v[56:59]
    v_mfma_f32_16x16x32_bf16 v[60:63], v[208:211], v[20:23], v[60:63]
    ds_read_b64_tr_b16 v[16:17], v6 offset:36864
    ds_read_b64_tr_b16 v[18:19], v6 offset:37120
    s_waitcnt lgkmcnt(12)
    v_mfma_f32_16x16x32_bf16 v[64:67], v[128:131], v[24:27], v[64:67]
    v_mfma_f32_16x16x32_bf16 v[68:71], v[208:211], v[24:27], v[68:71]
    ds_read_b64_tr_b16 v[20:21], v7 offset:36864
    ds_read_b64_tr_b16 v[22:23], v7 offset:37120
    s_waitcnt lgkmcnt(12)
    v_mfma_f32_16x16x32_bf16 v[72:75], v[128:131], v[28:31], v[72:75]
    v_mfma_f32_16x16x32_bf16 v[76:79], v[208:211], v[28:31], v[76:79]
    ds_read_b64_tr_b16 v[24:25], v6 offset:45056
    ds_read_b64_tr_b16 v[26:27], v6 offset:45312
    s_waitcnt lgkmcnt(12)
    v_mfma_f32_16x16x32_bf16 v[48:51], v[132:135], v[32:35], v[48:51]
    v_mfma_f32_16x16x32_bf16 v[52:55], v[212:215], v[32:35], v[52:55]
    ds_read_b64_tr_b16 v[28:29], v7 offset:45056
    ds_read_b64_tr_b16 v[30:31], v7 offset:45312
    s_waitcnt lgkmcnt(12)
    v_mfma_f32_16x16x32_bf16 v[56:59], v[132:135], v[36:39], v[56:59]
    v_mfma_f32_16x16x32_bf16 v[60:63], v[212:215], v[36:39], v[60:63]
    ds_read_b64_tr_b16 v[32:33], v6 offset:38912
    ds_read_b64_tr_b16 v[34:35], v6 offset:39168
    s_waitcnt lgkmcnt(12)
    v_mfma_f32_16x16x32_bf16 v[64:67], v[132:135], v[40:43], v[64:67]
    v_mfma_f32_16x16x32_bf16 v[68:71], v[212:215], v[40:43], v[68:71]
    ds_read_b64_tr_b16 v[36:37], v7 offset:38912
    ds_read_b64_tr_b16 v[38:39], v7 offset:39168
    s_waitcnt lgkmcnt(12)
    v_mfma_f32_16x16x32_bf16 v[72:75], v[132:135], v[44:47], v[72:75]
    v_mfma_f32_16x16x32_bf16 v[76:79], v[212:215], v[44:47], v[76:79]
    ds_read_b64_tr_b16 v[40:41], v6 offset:47104
    ds_read_b64_tr_b16 v[42:43], v6 offset:47360
    s_waitcnt lgkmcnt(12)
    v_mfma_f32_16x16x32_bf16 v[48:51], v[136:139], v[16:19], v[48:51]
    v_mfma_f32_16x16x32_bf16 v[52:55], v[216:219], v[16:19], v[52:55]
    ds_read_b64_tr_b16 v[44:45], v7 offset:47104
    ds_read_b64_tr_b16 v[46:47], v7 offset:47360
    s_waitcnt lgkmcnt(12)
    v_mfma_f32_16x16x32_bf16 v[56:59], v[136:139], v[20:23], v[56:59]
    v_mfma_f32_16x16x32_bf16 v[60:63], v[216:219], v[20:23], v[60:63]
    ds_read_b64_tr_b16 v[16:17], v6 offset:49152
    ds_read_b64_tr_b16 v[18:19], v6 offset:49408
    s_waitcnt lgkmcnt(12)
    v_mfma_f32_16x16x32_bf16 v[64:67], v[136:139], v[24:27], v[64:67]
    v_mfma_f32_16x16x32_bf16 v[68:71], v[216:219], v[24:27], v[68:71]
    ds_read_b64_tr_b16 v[20:21], v7 offset:49152
    ds_read_b64_tr_b16 v[22:23], v7 offset:49408
    s_waitcnt lgkmcnt(12)
    v_mfma_f32_16x16x32_bf16 v[72:75], v[136:139], v[28:31], v[72:75]
    v_mfma_f32_16x16x32_bf16 v[76:79], v[216:219], v[28:31], v[76:79]
    ds_read_b64_tr_b16 v[24:25], v6 offset:57344
    ds_read_b64_tr_b16 v[26:27], v6 offset:57600
    s_waitcnt lgkmcnt(12)
    v_mfma_f32_16x16x32_bf16 v[48:51], v[140:143], v[32:35], v[48:51]
    v_mfma_f32_16x16x32_bf16 v[52:55], v[220:223], v[32:35], v[52:55]
    ds_read_b64_tr_b16 v[28:29], v7 offset:57344
    ds_read_b64_tr_b16 v[30:31], v7 offset:57600
    s_waitcnt lgkmcnt(12)
    v_mfma_f32_16x16x32_bf16 v[56:59], v[140:143], v[36:39], v[56:59]
    v_mfma_f32_16x16x32_bf16 v[60:63], v[220:223], v[36:39], v[60:63]
    ds_read_b64_tr_b16 v[32:33], v6 offset:51200
    ds_read_b64_tr_b16 v[34:35], v6 offset:51456
    s_waitcnt lgkmcnt(12)
    v_mfma_f32_16x16x32_bf16 v[64:67], v[140:143], v[40:43], v[64:67]
    v_mfma_f32_16x16x32_bf16 v[68:71], v[220:223], v[40:43], v[68:71]
    ds_read_b64_tr_b16 v[36:37], v7 offset:51200
    ds_read_b64_tr_b16 v[38:39], v7 offset:51456
    s_waitcnt lgkmcnt(12)
    v_mfma_f32_16x16x32_bf16 v[72:75], v[140:143], v[44:47], v[72:75]
    v_mfma_f32_16x16x32_bf16 v[76:79], v[220:223], v[44:47], v[76:79]
    s_waitcnt vmcnt(8)
    s_barrier
    s_add_u32 m0, s46, 32768
    s_mul_i32 s33, s31, 256
    s_add_u32 s33, s33, s32
    buffer_load_dwordx4 v10, s[12:15], s33 offen lds
    s_add_u32 m0, s46, 33792
    s_mul_i32 s33, s31, 272
    s_add_u32 s33, s33, s32
    buffer_load_dwordx4 v10, s[12:15], s33 offen lds
    s_add_u32 m0, s46, 34816
    s_mul_i32 s33, s31, 288
    s_add_u32 s33, s33, s32
    buffer_load_dwordx4 v10, s[12:15], s33 offen lds
    s_add_u32 m0, s46, 35840
    s_mul_i32 s33, s31, 304
    s_add_u32 s33, s33, s32
    buffer_load_dwordx4 v10, s[12:15], s33 offen lds
    ds_read_b64_tr_b16 v[40:41], v6 offset:59392
    ds_read_b64_tr_b16 v[42:43], v6 offset:59648
    s_waitcnt lgkmcnt(12)
    v_mfma_f32_16x16x32_bf16 v[48:51], v[144:147], v[16:19], v[48:51]
    v_mfma_f32_16x16x32_bf16 v[52:55], v[224:227], v[16:19], v[52:55]
    ds_read_b64_tr_b16 v[44:45], v7 offset:59392
    ds_read_b64_tr_b16 v[46:47], v7 offset:59648
    s_waitcnt lgkmcnt(12)
    v_mfma_f32_16x16x32_bf16 v[56:59], v[144:147], v[20:23], v[56:59]
    v_mfma_f32_16x16x32_bf16 v[60:63], v[224:227], v[20:23], v[60:63]
    ds_read_b64_tr_b16 v[16:17], v6 offset:53248
    ds_read_b64_tr_b16 v[18:19], v6 offset:53504
    s_waitcnt lgkmcnt(12)
    v_mfma_f32_16x16x32_bf16 v[64:67], v[144:147], v[24:27], v[64:67]
    v_mfma_f32_16x16x32_bf16 v[68:71], v[224:227], v[24:27], v[68:71]
    ds_read_b64_tr_b16 v[20:21], v7 offset:53248
    ds_read_b64_tr_b16 v[22:23], v7 offset:53504
    s_waitcnt lgkmcnt(12)
    v_mfma_f32_16x16x32_bf16 v[72:75], v[144:147], v[28:31], v[72:75]
    v_mfma_f32_16x16x32_bf16 v[76:79], v[224:227], v[28:31], v[76:79]
    ds_read_b64_tr_b16 v[24:25], v6 offset:61440
    ds_read_b64_tr_b16 v[26:27], v6 offset:61696
    s_waitcnt lgkmcnt(12)
    v_mfma_f32_16x16x32_bf16 v[48:51], v[148:151], v[32:35], v[48:51]
    v_mfma_f32_16x16x32_bf16 v[52:55], v[228:231], v[32:35], v[52:55]
    ds_read_b64_tr_b16 v[28:29], v7 offset:61440
    ds_read_b64_tr_b16 v[30:31], v7 offset:61696
    s_waitcnt lgkmcnt(12)
    v_mfma_f32_16x16x32_bf16 v[56:59], v[148:151], v[36:39], v[56:59]
    v_mfma_f32_16x16x32_bf16 v[60:63], v[228:231], v[36:39], v[60:63]
    ds_read_b64_tr_b16 v[32:33], v6 offset:55296
    ds_read_b64_tr_b16 v[34:35], v6 offset:55552
    s_waitcnt lgkmcnt(12)
    v_mfma_f32_16x16x32_bf16 v[64:67], v[148:151], v[40:43], v[64:67]
    v_mfma_f32_16x16x32_bf16 v[68:71], v[228:231], v[40:43], v[68:71]
    ds_read_b64_tr_b16 v[36:37], v7 offset:55296
    ds_read_b64_tr_b16 v[38:39], v7 offset:55552
    s_waitcnt lgkmcnt(12)
    v_mfma_f32_16x16x32_bf16 v[72:75], v[148:151], v[44:47], v[72:75]
    v_mfma_f32_16x16x32_bf16 v[76:79], v[228:231], v[44:47], v[76:79]
    ds_read_b64_tr_b16 v[40:41], v6 offset:63488
    ds_read_b64_tr_b16 v[42:43], v6 offset:63744
    s_waitcnt lgkmcnt(12)
    v_mfma_f32_16x16x32_bf16 v[48:51], v[152:155], v[16:19], v[48:51]
    v_mfma_f32_16x16x32_bf16 v[52:55], v[232:235], v[16:19], v[52:55]
    ds_read_b64_tr_b16 v[44:45], v7 offset:63488
    ds_read_b64_tr_b16 v[46:47], v7 offset:63744
    s_waitcnt lgkmcnt(12)
    v_mfma_f32_16x16x32_bf16 v[56:59], v[152:155], v[20:23], v[56:59]
    v_mfma_f32_16x16x32_bf16 v[60:63], v[232:235], v[20:23], v[60:63]
    ds_read_b64_tr_b16 v[16:17], v8 offset:0
    ds_read_b64_tr_b16 v[18:19], v8 offset:256
    s_waitcnt lgkmcnt(12)
    v_mfma_f32_16x16x32_bf16 v[64:67], v[152:155], v[24:27], v[64:67]
    v_mfma_f32_16x16x32_bf16 v[68:71], v[232:235], v[24:27], v[68:71]
    ds_read_b64_tr_b16 v[20:21], v9 offset:0
    ds_read_b64_tr_b16 v[22:23], v9 offset:256
    s_waitcnt lgkmcnt(12)
    v_mfma_f32_16x16x32_bf16 v[72:75], v[152:155], v[28:31], v[72:75]
    v_mfma_f32_16x16x32_bf16 v[76:79], v[232:235], v[28:31], v[76:79]
    ds_read_b64_tr_b16 v[24:25], v8 offset:8192
    ds_read_b64_tr_b16 v[26:27], v8 offset:8448
    s_waitcnt lgkmcnt(12)
    v_mfma_f32_16x16x32_bf16 v[48:51], v[156:159], v[32:35], v[48:51]
    v_mfma_f32_16x16x32_bf16 v[52:55], v[236:239], v[32:35], v[52:55]
    ds_read_b64_tr_b16 v[28:29], v9 offset:8192
    ds_read_b64_tr_b16 v[30:31], v9 offset:8448
    s_waitcnt lgkmcnt(12)
    v_mfma_f32_16x16x32_bf16 v[56:59], v[156:159], v[36:39], v[56:59]
    v_mfma_f32_16x16x32_bf16 v[60:63], v[236:239], v[36:39], v[60:63]
    ds_read_b64_tr_b16 v[32:33], v8 offset:2048
    ds_read_b64_tr_b16 v[34:35], v8 offset:2304
    s_waitcnt lgkmcnt(12)
    v_mfma_f32_16x16x32_bf16 v[64:67], v[156:159], v[40:43], v[64:67]
    v_mfma_f32_16x16x32_bf16 v[68:71], v[236:239], v[40:43], v[68:71]
    ds_read_b64_tr_b16 v[36:37], v9 offset:2048
    ds_read_b64_tr_b16 v[38:39], v9 offset:2304
    s_waitcnt lgkmcnt(12)
    v_mfma_f32_16x16x32_bf16 v[72:75], v[156:159], v[44:47], v[72:75]
    v_mfma_f32_16x16x32_bf16 v[76:79], v[236:239], v[44:47], v[76:79]
    s_waitcnt vmcnt(8)
    s_barrier
    s_add_u32 m0, s46, 49152
    s_mul_i32 s33, s31, 384
    s_add_u32 s33, s33, s32
    buffer_load_dwordx4 v10, s[12:15], s33 offen lds
    s_add_u32 m0, s46, 50176
    s_mul_i32 s33, s31, 400
    s_add_u32 s33, s33, s32
    buffer_load_dwordx4 v10, s[12:15], s33 offen lds
    s_add_u32 m0, s46, 51200
    s_mul_i32 s33, s31, 416
    s_add_u32 s33, s33, s32
    buffer_load_dwordx4 v10, s[12:15], s33 offen lds
    s_add_u32 m0, s46, 52224
    s_mul_i32 s33, s31, 432
    s_add_u32 s33, s33, s32
    buffer_load_dwordx4 v10, s[12:15], s33 offen lds
    ds_read_b64_tr_b16 v[40:41], v8 offset:10240
    ds_read_b64_tr_b16 v[42:43], v8 offset:10496
    s_waitcnt lgkmcnt(12)
    v_mfma_f32_16x16x32_bf16 v[48:51], v[160:163], v[16:19], v[48:51]
    v_mfma_f32_16x16x32_bf16 v[52:55], v[240:243], v[16:19], v[52:55]
    ds_read_b64_tr_b16 v[44:45], v9 offset:10240
    ds_read_b64_tr_b16 v[46:47], v9 offset:10496
    s_waitcnt lgkmcnt(12)
    v_mfma_f32_16x16x32_bf16 v[56:59], v[160:163], v[20:23], v[56:59]
    v_mfma_f32_16x16x32_bf16 v[60:63], v[240:243], v[20:23], v[60:63]
    ds_read_b64_tr_b16 v[16:17], v8 offset:4096
    ds_read_b64_tr_b16 v[18:19], v8 offset:4352
    s_waitcnt lgkmcnt(12)
    v_mfma_f32_16x16x32_bf16 v[64:67], v[160:163], v[24:27], v[64:67]
    v_mfma_f32_16x16x32_bf16 v[68:71], v[240:243], v[24:27], v[68:71]
    ds_read_b64_tr_b16 v[20:21], v9 offset:4096
    ds_read_b64_tr_b16 v[22:23], v9 offset:4352
    s_waitcnt lgkmcnt(12)
    v_mfma_f32_16x16x32_bf16 v[72:75], v[160:163], v[28:31], v[72:75]
    v_mfma_f32_16x16x32_bf16 v[76:79], v[240:243], v[28:31], v[76:79]
    ds_read_b64_tr_b16 v[24:25], v8 offset:12288
    ds_read_b64_tr_b16 v[26:27], v8 offset:12544
    s_waitcnt lgkmcnt(12)
    v_mfma_f32_16x16x32_bf16 v[48:51], v[164:167], v[32:35], v[48:51]
    v_mfma_f32_16x16x32_bf16 v[52:55], v[244:247], v[32:35], v[52:55]
    ds_read_b64_tr_b16 v[28:29], v9 offset:12288
    ds_read_b64_tr_b16 v[30:31], v9 offset:12544
    s_waitcnt lgkmcnt(12)
    v_mfma_f32_16x16x32_bf16 v[56:59], v[164:167], v[36:39], v[56:59]
    v_mfma_f32_16x16x32_bf16 v[60:63], v[244:247], v[36:39], v[60:63]
    ds_read_b64_tr_b16 v[32:33], v8 offset:6144
    ds_read_b64_tr_b16 v[34:35], v8 offset:6400
    s_waitcnt lgkmcnt(12)
    v_mfma_f32_16x16x32_bf16 v[64:67], v[164:167], v[40:43], v[64:67]
    v_mfma_f32_16x16x32_bf16 v[68:71], v[244:247], v[40:43], v[68:71]
    ds_read_b64_tr_b16 v[36:37], v9 offset:6144
    ds_read_b64_tr_b16 v[38:39], v9 offset:6400
    s_waitcnt lgkmcnt(12)
    v_mfma_f32_16x16x32_bf16 v[72:75], v[164:167], v[44:47], v[72:75]
    v_mfma_f32_16x16x32_bf16 v[76:79], v[244:247], v[44:47], v[76:79]
    ds_read_b64_tr_b16 v[40:41], v8 offset:14336
    ds_read_b64_tr_b16 v[42:43], v8 offset:14592
    s_waitcnt lgkmcnt(12)
    v_mfma_f32_16x16x32_bf16 v[48:51], v[168:171], v[16:19], v[48:51]
    v_mfma_f32_16x16x32_bf16 v[52:55], v[248:251], v[16:19], v[52:55]
    ds_read_b64_tr_b16 v[44:45], v9 offset:14336
    ds_read_b64_tr_b16 v[46:47], v9 offset:14592
    s_waitcnt lgkmcnt(12)
    v_mfma_f32_16x16x32_bf16 v[56:59], v[168:171], v[20:23], v[56:59]
    v_mfma_f32_16x16x32_bf16 v[60:63], v[248:251], v[20:23], v[60:63]
    ds_read_b64_tr_b16 v[16:17], v6 offset:0
    ds_read_b64_tr_b16 v[18:19], v6 offset:256
    s_waitcnt lgkmcnt(12)
    v_mfma_f32_16x16x32_bf16 v[64:67], v[168:171], v[24:27], v[64:67]
    v_mfma_f32_16x16x32_bf16 v[68:71], v[248:251], v[24:27], v[68:71]
    ds_read_b64_tr_b16 v[20:21], v7 offset:0
    ds_read_b64_tr_b16 v[22:23], v7 offset:256
    s_waitcnt lgkmcnt(12)
    v_mfma_f32_16x16x32_bf16 v[72:75], v[168:171], v[28:31], v[72:75]
    v_mfma_f32_16x16x32_bf16 v[76:79], v[248:251], v[28:31], v[76:79]
    ds_read_b64_tr_b16 v[24:25], v6 offset:8192
    ds_read_b64_tr_b16 v[26:27], v6 offset:8448
    s_waitcnt lgkmcnt(12)
    v_mfma_f32_16x16x32_bf16 v[48:51], v[172:175], v[32:35], v[48:51]
    v_mfma_f32_16x16x32_bf16 v[52:55], v[252:255], v[32:35], v[52:55]
    ds_read_b64_tr_b16 v[28:29], v7 offset:8192
    ds_read_b64_tr_b16 v[30:31], v7 offset:8448
    s_waitcnt lgkmcnt(12)
    v_mfma_f32_16x16x32_bf16 v[56:59], v[172:175], v[36:39], v[56:59]
    v_mfma_f32_16x16x32_bf16 v[60:63], v[252:255], v[36:39], v[60:63]
    ds_read_b64_tr_b16 v[32:33], v6 offset:2048
    ds_read_b64_tr_b16 v[34:35], v6 offset:2304
    s_waitcnt lgkmcnt(12)
    v_mfma_f32_16x16x32_bf16 v[64:67], v[172:175], v[40:43], v[64:67]
    v_mfma_f32_16x16x32_bf16 v[68:71], v[252:255], v[40:43], v[68:71]
    ds_read_b64_tr_b16 v[36:37], v7 offset:2048
    ds_read_b64_tr_b16 v[38:39], v7 offset:2304
    s_waitcnt lgkmcnt(12)
    v_mfma_f32_16x16x32_bf16 v[72:75], v[172:175], v[44:47], v[72:75]
    v_mfma_f32_16x16x32_bf16 v[76:79], v[252:255], v[44:47], v[76:79]
    s_and_b32 s34, s29, 63
    s_lshr_b32 s35, s34, 1
    s_lshl_b32 s35, s35, 20
    s_add_u32 s35, s35, s48
    s_and_b32 s36, s34, 1
    s_lshl_b32 s36, s36, 12
    s_add_u32 s35, s35, s36
    s_add_u32 s35, s35, 0x1402000
    s_nop 1
    v_cvt_pk_bf16_f32 v80, v48, v49
    v_cvt_pk_bf16_f32 v81, v50, v51
    v_cvt_pk_bf16_f32 v82, v52, v53
    v_cvt_pk_bf16_f32 v83, v54, v55
    buffer_store_dwordx4 v[80:83], v1, s[4:7], s35 offen offset:0 sc1
    v_cvt_pk_bf16_f32 v84, v56, v57
    v_cvt_pk_bf16_f32 v85, v58, v59
    v_cvt_pk_bf16_f32 v86, v60, v61
    v_cvt_pk_bf16_f32 v87, v62, v63
    buffer_store_dwordx4 v[84:87], v1, s[4:7], s35 offen offset:1024 sc1
    v_cvt_pk_bf16_f32 v88, v64, v65
    v_cvt_pk_bf16_f32 v89, v66, v67
    v_cvt_pk_bf16_f32 v90, v68, v69
    v_cvt_pk_bf16_f32 v91, v70, v71
    buffer_store_dwordx4 v[88:91], v1, s[4:7], s35 offen offset:2048 sc1
    v_cvt_pk_bf16_f32 v92, v72, v73
    v_cvt_pk_bf16_f32 v93, v74, v75
    v_cvt_pk_bf16_f32 v94, v76, v77
    v_cvt_pk_bf16_f32 v95, v78, v79
    buffer_store_dwordx4 v[92:95], v1, s[4:7], s35 offen offset:3072 sc1
L_g1_next:
    s_cmp_ge_u32 s29, 128
    s_cbranch_scc1 L_g1_np
    s_cmp_lt_u32 s29, 80
    s_cbranch_scc1 L_g1_np
    s_cmp_ge_u32 s27, 4
    s_cbranch_scc1 L_g1_np
    s_waitcnt vmcnt(0)
    s_barrier
    s_cmp_lg_u32 s26, 0
    s_cbranch_scc1 Lg1s_172
    s_lshr_b32 s33, s29, 6
    s_mov_b32 s34, 1
    s_cmp_eq_u32 s33, 2
    s_cmov_b32 s34, 0x400
    s_cmp_eq_u32 s33, 3
    s_cmov_b32 s34, 0x100000
    s_lshl_b32 s33, s27, 2
    s_mov_b64 exec, 1
    v_mov_b32 v11, s34
    v_mov_b32 v12, s33
    buffer_atomic_add v11, v12, s[64:67], 0 offen offset:64 sc1
    s_mov_b64 exec, -1
Lg1s_172:
    s_mov_b32 s51, 1
L_g1_np:
    s_add_u32 s29, s29, 48
    s_cmp_lt_u32 s29, 248
    s_cbranch_scc1 L_g1_loop
    s_waitcnt vmcnt(0) lgkmcnt(0)
    s_barrier
    s_sub_u32 s37, s29, 48
    s_cmp_lg_u32 s26, 0
    s_cbranch_scc1 Lg1s_173
    s_lshr_b32 s33, s37, 6
    s_mov_b32 s34, 1
    s_cmp_eq_u32 s33, 2
    s_cmov_b32 s34, 0x400
    s_cmp_eq_u32 s33, 3
    s_cmov_b32 s34, 0x100000
    s_lshl_b32 s33, s27, 2
    s_mov_b64 exec, 1
    v_mov_b32 v11, s34
    v_mov_b32 v12, s33
    buffer_atomic_add v11, v12, s[64:67], 0 offen offset:64 sc1
    s_mov_b64 exec, -1
Lg1s_173:
    s_add_u32 s28, s28, 8
    s_cmp_ge_u32 s28, 48
    s_cselect_b32 s33, 48, 0
    s_sub_u32 s28, s28, s33
    s_add_u32 s27, s27, 4
    s_cmp_lt_u32 s27, 16
    s_cbranch_scc1 L_g1_pass
Lp_174:
    v_mov_b32 v11, 0
    buffer_load_dword v11, v11, s[64:67], 0 offen offset:4 sc1
    s_waitcnt vmcnt(0)
    v_readfirstlane_b32 s68, v11
    s_nop 3
    s_bfe_u32 s69, s68, 0xa0000
    s_cmp_lt_u32 s69, 64
    s_cbranch_scc1 Lp_174_n
    s_branch Lpok_175
Lp_174_n:
    s_add_u32 s74, s74, 1
    s_cmp_gt_u32 s74, 60000
    s_cbranch_scc1 L_wabort
    s_sleep 8
    s_branch Lp_174
Lpok_175:
    s_mul_i32 s33, s70, 171
    s_lshr_b32 s71, s33, 10
    s_mul_i32 s33, s71, 6
    s_sub_u32 s72, s70, s33
    s_cmp_eq_u32 s72, 5
    s_cbranch_scc1 L_att_role
    s_load_dwordx2 s[54:55], s[0:1], 40
    s_load_dwordx4 s[56:59], s[0:1], 80
    s_mul_i32 s33, s71, 5
    s_add_u32 s33, s33, s72
    s_mul_i32 s47, s33, 205
    s_lshr_b32 s47, s47, 12
    s_mul_i32 s34, s47, 20
    s_sub_u32 s28, s33, s34
    s_waitcnt lgkmcnt(0)
    s_mov_b32 s16, s58
    s_mov_b32 s17, s59
    s_mov_b32 s18, 0x280000
    s_mov_b32 s19, 0x20000
    s_mov_b32 s12, s56
    s_mov_b32 s13, s57
    s_mov_b32 s14, 0x21c000
    s_mov_b32 s15, 0x20000
    s_mov_b32 s20, s54
    s_mov_b32 s21, s55
    s_mov_b32 s22, 0x500000
    s_mov_b32 s23, 0x20000
    s_barrier
    v_lshlrev_b32 v1, 4, v0
    v_lshrrev_b32 v2, 2, v0
    v_mul_u32_u24 v2, 1280, v2
    v_bfe_u32 v3, v0, 4, 1
    v_lshlrev_b32 v3, 1, v3
    v_and_b32 v4, 3, v0
    v_xor_b32 v3, v3, v4
    v_lshl_add_u32 v10, v3, 4, v2
    s_lshl_b32 s46, s26, 15
    v_lshrrev_b32 v6, 2, v0
    v_lshlrev_b32 v6, 6, v6
    v_lshl_add_u32 v6, v4, 3, v6
    v_bfe_u32 v5, v0, 4, 1
    v_lshl_add_u32 v6, v5, 5, v6
    v_add_u32 v6, s46, v6
    v_xor_b32 v7, 32, v6
    s_lshl_b32 s32, s28, 6
    s_mul_i32 s33, s26, 1310720
    s_add_u32 s33, s33, s32
    s_mul_i32 s34, s26, 573440
    s_add_u32 s34, s34, s32
    s_add_u32 m0, s46, 0
    s_add_u32 s35, s34, 0
    buffer_load_dwordx4 v10, s[12:15], s35 offen lds
    s_add_u32 m0, s46, 1024
    s_add_u32 s35, s34, 20480
    buffer_load_dwordx4 v10, s[12:15], s35 offen lds
    s_add_u32 m0, s46, 2048
    s_add_u32 s35, s34, 40960
    buffer_load_dwordx4 v10, s[12:15], s35 offen lds
    s_add_u32 m0, s46, 3072
    s_add_u32 s35, s34, 61440
    buffer_load_dwordx4 v10, s[12:15], s35 offen lds
    s_add_u32 m0, s46, 4096
    s_add_u32 s35, s34, 81920
    buffer_load_dwordx4 v10, s[12:15], s35 offen lds
    s_add_u32 m0, s46, 5120
    s_add_u32 s35, s34, 102400
    buffer_load_dwordx4 v10, s[12:15], s35 offen lds
    s_add_u32 m0, s46, 6144
    s_add_u32 s35, s34, 122880
    buffer_load_dwordx4 v10, s[12:15], s35 offen lds
    s_add_u32 m0, s46, 7168
    s_add_u32 s35, s34, 143360
    buffer_load_dwordx4 v10, s[12:15], s35 offen lds
    s_add_u32 m0, s46, 8192
    s_add_u32 s35, s34, 163840
    buffer_load_dwordx4 v10, s[12:15], s35 offen lds
    s_add_u32 m0, s46, 9216
    s_add_u32 s35, s34, 184320
    buffer_load_dwordx4 v10, s[12:15], s35 offen lds
    s_add_u32 m0, s46, 10240
    s_add_u32 s35, s34, 204800
    buffer_load_dwordx4 v10, s[12:15], s35 offen lds
    s_add_u32 m0, s46, 11264
    s_add_u32 s35, s34, 225280
    buffer_load_dwordx4 v10, s[12:15], s35 offen lds
    s_add_u32 m0, s46, 12288
    s_add_u32 s35, s34, 245760
    buffer_load_dwordx4 v10, s[12:15], s35 offen lds
    s_add_u32 m0, s46, 13312
    s_add_u32 s35, s34, 266240
    buffer_load_dwordx4 v10, s[12:15], s35 offen lds
    s_add_u32 m0, s46, 14336
    s_add_u32 s35, s34, 286720
    buffer_load_dwordx4 v10, s[12:15], s35 offen lds
    s_add_u32 m0, s46, 15360
    s_add_u32 s35, s34, 307200
    buffer_load_dwordx4 v10, s[12:15], s35 offen lds
    s_add_u32 m0, s46, 16384
    s_add_u32 s35, s34, 327680
    buffer_load_dwordx4 v10, s[12:15], s35 offen lds
    s_add_u32 m0, s46, 17408
    s_add_u32 s35, s34, 348160
    buffer_load_dwordx4 v10, s[12:15], s35 offen lds
    s_add_u32 m0, s46, 18432
    s_add_u32 s35, s34, 368640
    buffer_load_dwordx4 v10, s[12:15], s35 offen lds
    s_add_u32 m0, s46, 19456
    s_add_u32 s35, s34, 389120
    buffer_load_dwordx4 v10, s[12:15], s35 offen lds
    s_add_u32 m0, s46, 20480
    s_add_u32 s35, s34, 409600
    buffer_load_dwordx4 v10, s[12:15], s35 offen lds
    s_add_u32 m0, s46, 21504
    s_add_u32 s35, s34, 430080
    buffer_load_dwordx4 v10, s[12:15], s35 offen lds
    s_add_u32 m0, s46, 22528
    s_add_u32 s35, s34, 450560
    buffer_load_dwordx4 v10, s[12:15], s35 offen lds
    s_add_u32 m0, s46, 23552
    s_add_u32 s35, s34, 471040
    buffer_load_dwordx4 v10, s[12:15], s35 offen lds
    s_add_u32 m0, s46, 24576
    s_add_u32 s35, s34, 491520
    buffer_load_dwordx4 v10, s[12:15], s35 offen lds
    s_add_u32 m0, s46, 25600
    s_add_u32 s35, s34, 512000
    buffer_load_dwordx4 v10, s[12:15], s35 offen lds
    s_add_u32 m0, s46, 26624
    s_add_u32 s35, s34, 532480
    buffer_load_dwordx4 v10, s[12:15], s35 offen lds
    s_add_u32 m0, s46, 27648
    s_add_u32 s35, s34, 552960
    buffer_load_dwordx4 v10, s[12:15], s35 offen lds
    s_add_u32 m0, s46, 28672
    s_add_u32 s35, s33, 0
    buffer_load_dwordx4 v10, s[20:23], s35 offen lds
    s_add_u32 m0, s46, 29696
    s_add_u32 s35, s33, 20480
    buffer_load_dwordx4 v10, s[20:23], s35 offen lds
    s_add_u32 m0, s46, 30720
    s_add_u32 s35, s33, 40960
    buffer_load_dwordx4 v10, s[20:23], s35 offen lds
    s_add_u32 m0, s46, 31744
    s_add_u32 s35, s33, 61440
    buffer_load_dwordx4 v10, s[20:23], s35 offen lds
    s_waitcnt vmcnt(28)
    ds_read_b64_tr_b16 v[144:145], v6 offset:0
    ds_read_b64_tr_b16 v[146:147], v6 offset:1024
    ds_read_b64_tr_b16 v[148:149], v7 offset:0
    ds_read_b64_tr_b16 v[150:151], v7 offset:1024
    ds_read_b64_tr_b16 v[152:153], v6 offset:2048
    ds_read_b64_tr_b16 v[154:155], v6 offset:3072
    ds_read_b64_tr_b16 v[156:157], v7 offset:2048
    ds_read_b64_tr_b16 v[158:159], v7 offset:3072
    s_waitcnt lgkmcnt(0)
    s_add_u32 m0, s46, 0
    s_add_u32 s35, s33, 81920
    buffer_load_dwordx4 v10, s[20:23], s35 offen lds
    s_add_u32 m0, s46, 1024
    s_add_u32 s35, s33, 102400
    buffer_load_dwordx4 v10, s[20:23], s35 offen lds
    s_add_u32 m0, s46, 2048
    s_add_u32 s35, s33, 122880
    buffer_load_dwordx4 v10, s[20:23], s35 offen lds
    s_add_u32 m0, s46, 3072
    s_add_u32 s35, s33, 143360
    buffer_load_dwordx4 v10, s[20:23], s35 offen lds
    s_waitcnt vmcnt(28)
    ds_read_b64_tr_b16 v[160:161], v6 offset:4096
    ds_read_b64_tr_b16 v[162:163], v6 offset:5120
    ds_read_b64_tr_b16 v[164:165], v7 offset:4096
    ds_read_b64_tr_b16 v[166:167], v7 offset:5120
    ds_read_b64_tr_b16 v[168:169], v6 offset:6144
    ds_read_b64_tr_b16 v[170:171], v6 offset:7168
    ds_read_b64_tr_b16 v[172:173], v7 offset:6144
    ds_read_b64_tr_b16 v[174:175], v7 offset:7168
    s_waitcnt lgkmcnt(0)
    s_add_u32 m0, s46, 4096
    s_add_u32 s35, s33, 163840
    buffer_load_dwordx4 v10, s[20:23], s35 offen lds
    s_add_u32 m0, s46, 5120
    s_add_u32 s35, s33, 184320
    buffer_load_dwordx4 v10, s[20:23], s35 offen lds
    s_add_u32 m0, s46, 6144
    s_add_u32 s35, s33, 204800
    buffer_load_dwordx4 v10, s[20:23], s35 offen lds
    s_add_u32 m0, s46, 7168
    s_add_u32 s35, s33, 225280
    buffer_load_dwordx4 v10, s[20:23], s35 offen lds
    s_waitcnt vmcnt(28)
    ds_read_b64_tr_b16 v[176:177], v6 offset:8192
    ds_read_b64_tr_b16 v[178:179], v6 offset:9216
    ds_read_b64_tr_b16 v[180:181], v7 offset:8192
    ds_read_b64_tr_b16 v[182:183], v7 offset:9216
    ds_read_b64_tr_b16 v[184:185], v6 offset:10240
    ds_read_b64_tr_b16 v[186:187], v6 offset:11264
    ds_read_b64_tr_b16 v[188:189], v7 offset:10240
    ds_read_b64_tr_b16 v[190:191], v7 offset:11264
    s_waitcnt lgkmcnt(0)
    s_add_u32 m0, s46, 8192
    s_add_u32 s35, s33, 245760
    buffer_load_dwordx4 v10, s[20:23], s35 offen lds
    s_add_u32 m0, s46, 9216
    s_add_u32 s35, s33, 266240
    buffer_load_dwordx4 v10, s[20:23], s35 offen lds
    s_add_u32 m0, s46, 10240
    s_add_u32 s35, s33, 286720
    buffer_load_dwordx4 v10, s[20:23], s35 offen lds
    s_add_u32 m0, s46, 11264
    s_add_u32 s35, s33, 307200
    buffer_load_dwordx4 v10, s[20:23], s35 offen lds
    s_waitcnt vmcnt(28)
    ds_read_b64_tr_b16 v[192:193], v6 offset:12288
    ds_read_b64_tr_b16 v[194:195], v6 offset:13312
    ds_read_b64_tr_b16 v[196:197], v7 offset:12288
    ds_read_b64_tr_b16 v[198:199], v7 offset:13312
    ds_read_b64_tr_b16 v[200:201], v6 offset:14336
    ds_read_b64_tr_b16 v[202:203], v6 offset:15360
    ds_read_b64_tr_b16 v[204:205], v7 offset:14336
    ds_read_b64_tr_b16 v[206:207], v7 offset:15360
    s_waitcnt lgkmcnt(0)
    s_add_u32 m0, s46, 12288
    s_add_u32 s35, s33, 327680
    buffer_load_dwordx4 v10, s[20:23], s35 offen lds
    s_add_u32 m0, s46, 13312
    s_add_u32 s35, s33, 348160
    buffer_load_dwordx4 v10, s[20:23], s35 offen lds
    s_add_u32 m0, s46, 14336
    s_add_u32 s35, s33, 368640
    buffer_load_dwordx4 v10, s[20:23], s35 offen lds
    s_add_u32 m0, s46, 15360
    s_add_u32 s35, s33, 389120
    buffer_load_dwordx4 v10, s[20:23], s35 offen lds
    s_waitcnt vmcnt(28)
    ds_read_b64_tr_b16 v[208:209], v6 offset:16384
    ds_read_b64_tr_b16 v[210:211], v6 offset:17408
    ds_read_b64_tr_b16 v[212:213], v7 offset:16384
    ds_read_b64_tr_b16 v[214:215], v7 offset:17408
    ds_read_b64_tr_b16 v[216:217], v6 offset:18432
    ds_read_b64_tr_b16 v[218:219], v6 offset:19456
    ds_read_b64_tr_b16 v[220:221], v7 offset:18432
    ds_read_b64_tr_b16 v[222:223], v7 offset:19456
    s_waitcnt lgkmcnt(0)
    s_add_u32 m0, s46, 16384
    s_add_u32 s35, s33, 409600
    buffer_load_dwordx4 v10, s[20:23], s35 offen lds
    s_add_u32 m0, s46, 17408
    s_add_u32 s35, s33, 430080
    buffer_load_dwordx4 v10, s[20:23], s35 offen lds
    s_add_u32 m0, s46, 18432
    s_add_u32 s35, s33, 450560
    buffer_load_dwordx4 v10, s[20:23], s35 offen lds
    s_add_u32 m0, s46, 19456
    s_add_u32 s35, s33, 471040
    buffer_load_dwordx4 v10, s[20:23], s35 offen lds
    s_waitcnt vmcnt(28)
    ds_read_b64_tr_b16 v[224:225], v6 offset:20480
    ds_read_b64_tr_b16 v[226:227], v6 offset:21504
    ds_read_b64_tr_b16 v[228:229], v7 offset:20480
    ds_read_b64_tr_b16 v[230:231], v7 offset:21504
    ds_read_b64_tr_b16 v[232:233], v6 offset:22528
    ds_read_b64_tr_b16 v[234:235], v6 offset:23552
    ds_read_b64_tr_b16 v[236:237], v7 offset:22528
    ds_read_b64_tr_b16 v[238:239], v7 offset:23552
    s_waitcnt lgkmcnt(0)
    s_add_u32 m0, s46, 20480
    s_add_u32 s35, s33, 491520
    buffer_load_dwordx4 v10, s[20:23], s35 offen lds
    s_add_u32 m0, s46, 21504
    s_add_u32 s35, s33, 512000
    buffer_load_dwordx4 v10, s[20:23], s35 offen lds
    s_add_u32 m0, s46, 22528
    s_add_u32 s35, s33, 532480
    buffer_load_dwordx4 v10, s[20:23], s35 offen lds
    s_add_u32 m0, s46, 23552
    s_add_u32 s35, s33, 552960
    buffer_load_dwordx4 v10, s[20:23], s35 offen lds
    s_waitcnt vmcnt(28)
    ds_read_b64_tr_b16 v[240:241], v6 offset:24576
    ds_read_b64_tr_b16 v[242:243], v6 offset:25600
    ds_read_b64_tr_b16 v[244:245], v7 offset:24576
    ds_read_b64_tr_b16 v[246:247], v7 offset:25600
    ds_read_b64_tr_b16 v[248:249], v6 offset:26624
    ds_read_b64_tr_b16 v[250:251], v6 offset:27648
    ds_read_b64_tr_b16 v[252:253], v7 offset:26624
    ds_read_b64_tr_b16 v[254:255], v7 offset:27648
    s_waitcnt lgkmcnt(0)
    s_add_u32 m0, s46, 24576
    s_add_u32 s35, s33, 573440
    buffer_load_dwordx4 v10, s[20:23], s35 offen lds
    s_add_u32 m0, s46, 25600
    s_add_u32 s35, s33, 593920
    buffer_load_dwordx4 v10, s[20:23], s35 offen lds
    s_add_u32 m0, s46, 26624
    s_add_u32 s35, s33, 614400
    buffer_load_dwordx4 v10, s[20:23], s35 offen lds
    s_add_u32 m0, s46, 27648
    s_add_u32 s35, s33, 634880
    buffer_load_dwordx4 v10, s[20:23], s35 offen lds
    s_waitcnt vmcnt(28)
    ds_read_b64_tr_b16 a[0:1], v6 offset:28672
    ds_read_b64_tr_b16 a[2:3], v6 offset:29696
    ds_read_b64_tr_b16 a[4:5], v7 offset:28672
    ds_read_b64_tr_b16 a[6:7], v7 offset:29696
    ds_read_b64_tr_b16 a[8:9], v6 offset:30720
    ds_read_b64_tr_b16 a[10:11], v6 offset:31744
    ds_read_b64_tr_b16 a[12:13], v7 offset:30720
    ds_read_b64_tr_b16 a[14:15], v7 offset:31744
    s_waitcnt lgkmcnt(0)
    s_add_u32 m0, s46, 28672
    s_add_u32 s35, s33, 655360
    buffer_load_dwordx4 v10, s[20:23], s35 offen lds
    s_add_u32 m0, s46, 29696
    s_add_u32 s35, s33, 675840
    buffer_load_dwordx4 v10, s[20:23], s35 offen lds
    s_add_u32 m0, s46, 30720
    s_add_u32 s35, s33, 696320
    buffer_load_dwordx4 v10, s[20:23], s35 offen lds
    s_add_u32 m0, s46, 31744
    s_add_u32 s35, s33, 716800
    buffer_load_dwordx4 v10, s[20:23], s35 offen lds
    s_waitcnt vmcnt(28)
    ds_read_b64_tr_b16 a[16:17], v6 offset:0
    ds_read_b64_tr_b16 a[18:19], v6 offset:1024
    ds_read_b64_tr_b16 a[20:21], v7 offset:0
    ds_read_b64_tr_b16 a[22:23], v7 offset:1024
    ds_read_b64_tr_b16 a[24:25], v6 offset:2048
    ds_read_b64_tr_b16 a[26:27], v6 offset:3072
    ds_read_b64_tr_b16 a[28:29], v7 offset:2048
    ds_read_b64_tr_b16 a[30:31], v7 offset:3072
    s_waitcnt lgkmcnt(0)
    s_add_u32 m0, s46, 0
    s_add_u32 s35, s33, 737280
    buffer_load_dwordx4 v10, s[20:23], s35 offen lds
    s_add_u32 m0, s46, 1024
    s_add_u32 s35, s33, 757760
    buffer_load_dwordx4 v10, s[20:23], s35 offen lds
    s_add_u32 m0, s46, 2048
    s_add_u32 s35, s33, 778240
    buffer_load_dwordx4 v10, s[20:23], s35 offen lds
    s_add_u32 m0, s46, 3072
    s_add_u32 s35, s33, 798720
    buffer_load_dwordx4 v10, s[20:23], s35 offen lds
    s_waitcnt vmcnt(28)
    ds_read_b64_tr_b16 a[32:33], v6 offset:4096
    ds_read_b64_tr_b16 a[34:35], v6 offset:5120
    ds_read_b64_tr_b16 a[36:37], v7 offset:4096
    ds_read_b64_tr_b16 a[38:39], v7 offset:5120
    ds_read_b64_tr_b16 a[40:41], v6 offset:6144
    ds_read_b64_tr_b16 a[42:43], v6 offset:7168
    ds_read_b64_tr_b16 a[44:45], v7 offset:6144
    ds_read_b64_tr_b16 a[46:47], v7 offset:7168
    s_waitcnt lgkmcnt(0)
    s_add_u32 m0, s46, 4096
    s_add_u32 s35, s33, 819200
    buffer_load_dwordx4 v10, s[20:23], s35 offen lds
    s_add_u32 m0, s46, 5120
    s_add_u32 s35, s33, 839680
    buffer_load_dwordx4 v10, s[20:23], s35 offen lds
    s_add_u32 m0, s46, 6144
    s_add_u32 s35, s33, 860160
    buffer_load_dwordx4 v10, s[20:23], s35 offen lds
    s_add_u32 m0, s46, 7168
    s_add_u32 s35, s33, 880640
    buffer_load_dwordx4 v10, s[20:23], s35 offen lds
    s_waitcnt vmcnt(28)
    ds_read_b64_tr_b16 a[48:49], v6 offset:8192
    ds_read_b64_tr_b16 a[50:51], v6 offset:9216
    ds_read_b64_tr_b16 a[52:53], v7 offset:8192
    ds_read_b64_tr_b16 a[54:55], v7 offset:9216
    ds_read_b64_tr_b16 a[56:57], v6 offset:10240
    ds_read_b64_tr_b16 a[58:59], v6 offset:11264
    ds_read_b64_tr_b16 a[60:61], v7 offset:10240
    ds_read_b64_tr_b16 a[62:63], v7 offset:11264
    s_waitcnt lgkmcnt(0)
    s_add_u32 m0, s46, 8192
    s_add_u32 s35, s33, 901120
    buffer_load_dwordx4 v10, s[20:23], s35 offen lds
    s_add_u32 m0, s46, 9216
    s_add_u32 s35, s33, 921600
    buffer_load_dwordx4 v10, s[20:23], s35 offen lds
    s_add_u32 m0, s46, 10240
    s_add_u32 s35, s33, 942080
    buffer_load_dwordx4 v10, s[20:23], s35 offen lds
    s_add_u32 m0, s46, 11264
    s_add_u32 s35, s33, 962560
    buffer_load_dwordx4 v10, s[20:23], s35 offen lds
    s_waitcnt vmcnt(28)
    ds_read_b64_tr_b16 a[64:65], v6 offset:12288
    ds_read_b64_tr_b16 a[66:67], v6 offset:13312
    ds_read_b64_tr_b16 a[68:69], v7 offset:12288
    ds_read_b64_tr_b16 a[70:71], v7 offset:13312
    ds_read_b64_tr_b16 a[72:73], v6 offset:14336
    ds_read_b64_tr_b16 a[74:75], v6 offset:15360
    ds_read_b64_tr_b16 a[76:77], v7 offset:14336
    ds_read_b64_tr_b16 a[78:79], v7 offset:15360
    s_waitcnt lgkmcnt(0)
    s_add_u32 m0, s46, 12288
    s_add_u32 s35, s33, 983040
    buffer_load_dwordx4 v10, s[20:23], s35 offen lds
    s_add_u32 m0, s46, 13312
    s_add_u32 s35, s33, 1003520
    buffer_load_dwordx4 v10, s[20:23], s35 offen lds
    s_add_u32 m0, s46, 14336
    s_add_u32 s35, s33, 1024000
    buffer_load_dwordx4 v10, s[20:23], s35 offen lds
    s_add_u32 m0, s46, 15360
    s_add_u32 s35, s33, 1044480
    buffer_load_dwordx4 v10, s[20:23], s35 offen lds
    s_waitcnt vmcnt(28)
    ds_read_b64_tr_b16 a[80:81], v6 offset:16384
    ds_read_b64_tr_b16 a[82:83], v6 offset:17408
    ds_read_b64_tr_b16 a[84:85], v7 offset:16384
    ds_read_b64_tr_b16 a[86:87], v7 offset:17408
    ds_read_b64_tr_b16 a[88:89], v6 offset:18432
    ds_read_b64_tr_b16 a[90:91], v6 offset:19456
    ds_read_b64_tr_b16 a[92:93], v7 offset:18432
    ds_read_b64_tr_b16 a[94:95], v7 offset:19456
    s_waitcnt lgkmcnt(0)
    s_add_u32 m0, s46, 16384
    s_add_u32 s35, s33, 1064960
    buffer_load_dwordx4 v10, s[20:23], s35 offen lds
    s_add_u32 m0, s46, 17408
    s_add_u32 s35, s33, 1085440
    buffer_load_dwordx4 v10, s[20:23], s35 offen lds
    s_add_u32 m0, s46, 18432
    s_add_u32 s35, s33, 1105920
    buffer_load_dwordx4 v10, s[20:23], s35 offen lds
    s_add_u32 m0, s46, 19456
    s_add_u32 s35, s33, 1126400
    buffer_load_dwordx4 v10, s[20:23], s35 offen lds
    s_waitcnt vmcnt(28)
    ds_read_b64_tr_b16 a[96:97], v6 offset:20480
    ds_read_b64_tr_b16 a[98:99], v6 offset:21504
    ds_read_b64_tr_b16 a[100:101], v7 offset:20480
    ds_read_b64_tr_b16 a[102:103], v7 offset:21504
    ds_read_b64_tr_b16 a[104:105], v6 offset:22528
    ds_read_b64_tr_b16 a[106:107], v6 offset:23552
    ds_read_b64_tr_b16 a[108:109], v7 offset:22528
    ds_read_b64_tr_b16 a[110:111], v7 offset:23552
    s_waitcnt lgkmcnt(0)
    s_add_u32 m0, s46, 20480
    s_add_u32 s35, s33, 1146880
    buffer_load_dwordx4 v10, s[20:23], s35 offen lds
    s_add_u32 m0, s46, 21504
    s_add_u32 s35, s33, 1167360
    buffer_load_dwordx4 v10, s[20:23], s35 offen lds
    s_add_u32 m0, s46, 22528
    s_add_u32 s35, s33, 1187840
    buffer_load_dwordx4 v10, s[20:23], s35 offen lds
    s_add_u32 m0, s46, 23552
    s_add_u32 s35, s33, 1208320
    buffer_load_dwordx4 v10, s[20:23], s35 offen lds
    s_waitcnt vmcnt(28)
    ds_read_b64_tr_b16 a[112:113], v6 offset:24576
    ds_read_b64_tr_b16 a[114:115], v6 offset:25600
    ds_read_b64_tr_b16 a[116:117], v7 offset:24576
    ds_read_b64_tr_b16 a[118:119], v7 offset:25600
    ds_read_b64_tr_b16 a[120:121], v6 offset:26624
    ds_read_b64_tr_b16 a[122:123], v6 offset:27648
    ds_read_b64_tr_b16 a[124:125], v7 offset:26624
    ds_read_b64_tr_b16 a[126:127], v7 offset:27648
    s_waitcnt lgkmcnt(0)
    s_add_u32 m0, s46, 24576
    s_add_u32 s35, s33, 1228800
    buffer_load_dwordx4 v10, s[20:23], s35 offen lds
    s_add_u32 m0, s46, 25600
    s_add_u32 s35, s33, 1249280
    buffer_load_dwordx4 v10, s[20:23], s35 offen lds
    s_add_u32 m0, s46, 26624
    s_add_u32 s35, s33, 1269760
    buffer_load_dwordx4 v10, s[20:23], s35 offen lds
    s_add_u32 m0, s46, 27648
    s_add_u32 s35, s33, 1290240
    buffer_load_dwordx4 v10, s[20:23], s35 offen lds
    s_waitcnt vmcnt(28)
    ds_read_b64_tr_b16 a[128:129], v6 offset:28672
    ds_read_b64_tr_b16 a[130:131], v6 offset:29696
    ds_read_b64_tr_b16 a[132:133], v7 offset:28672
    ds_read_b64_tr_b16 a[134:135], v7 offset:29696
    ds_read_b64_tr_b16 a[136:137], v6 offset:30720
    ds_read_b64_tr_b16 a[138:139], v6 offset:31744
    ds_read_b64_tr_b16 a[140:141], v7 offset:30720
    ds_read_b64_tr_b16 a[142:143], v7 offset:31744
    s_waitcnt lgkmcnt(0)
    s_waitcnt vmcnt(24)
    ds_read_b64_tr_b16 a[144:145], v6 offset:0
    ds_read_b64_tr_b16 a[146:147], v6 offset:1024
    ds_read_b64_tr_b16 a[148:149], v7 offset:0
    ds_read_b64_tr_b16 a[150:151], v7 offset:1024
    ds_read_b64_tr_b16 a[152:153], v6 offset:2048
    ds_read_b64_tr_b16 a[154:155], v6 offset:3072
    ds_read_b64_tr_b16 a[156:157], v7 offset:2048
    ds_read_b64_tr_b16 a[158:159], v7 offset:3072
    s_waitcnt lgkmcnt(0)
    s_waitcnt vmcnt(20)
    ds_read_b64_tr_b16 a[160:161], v6 offset:4096
    ds_read_b64_tr_b16 a[162:163], v6 offset:5120
    ds_read_b64_tr_b16 a[164:165], v7 offset:4096
    ds_read_b64_tr_b16 a[166:167], v7 offset:5120
    ds_read_b64_tr_b16 a[168:169], v6 offset:6144
    ds_read_b64_tr_b16 a[170:171], v6 offset:7168
    ds_read_b64_tr_b16 a[172:173], v7 offset:6144
    ds_read_b64_tr_b16 a[174:175], v7 offset:7168
    s_waitcnt lgkmcnt(0)
    s_waitcnt vmcnt(16)
    ds_read_b64_tr_b16 a[176:177], v6 offset:8192
    ds_read_b64_tr_b16 a[178:179], v6 offset:9216
    ds_read_b64_tr_b16 a[180:181], v7 offset:8192
    ds_read_b64_tr_b16 a[182:183], v7 offset:9216
    ds_read_b64_tr_b16 a[184:185], v6 offset:10240
    ds_read_b64_tr_b16 a[186:187], v6 offset:11264
    ds_read_b64_tr_b16 a[188:189], v7 offset:10240
    ds_read_b64_tr_b16 a[190:191], v7 offset:11264
    s_waitcnt lgkmcnt(0)
    s_waitcnt vmcnt(12)
    ds_read_b64_tr_b16 a[192:193], v6 offset:12288
    ds_read_b64_tr_b16 a[194:195], v6 offset:13312
    ds_read_b64_tr_b16 a[196:197], v7 offset:12288
    ds_read_b64_tr_b16 a[198:199], v7 offset:13312
    ds_read_b64_tr_b16 a[200:201], v6 offset:14336
    ds_read_b64_tr_b16 a[202:203], v6 offset:15360
    ds_read_b64_tr_b16 a[204:205], v7 offset:14336
    ds_read_b64_tr_b16 a[206:207], v7 offset:15360
    s_waitcnt lgkmcnt(0)
    s_waitcnt vmcnt(8)
    ds_read_b64_tr_b16 a[208:209], v6 offset:16384
    ds_read_b64_tr_b16 a[210:211], v6 offset:17408
    ds_read_b64_tr_b16 a[212:213], v7 offset:16384
    ds_read_b64_tr_b16 a[214:215], v7 offset:17408
    ds_read_b64_tr_b16 a[216:217], v6 offset:18432
    ds_read_b64_tr_b16 a[218:219], v6 offset:19456
    ds_read_b64_tr_b16 a[220:221], v7 offset:18432
    ds_read_b64_tr_b16 a[222:223], v7 offset:19456
    s_waitcnt lgkmcnt(0)
    s_waitcnt vmcnt(4)
    ds_read_b64_tr_b16 a[224:225], v6 offset:20480
    ds_read_b64_tr_b16 a[226:227], v6 offset:21504
    ds_read_b64_tr_b16 a[228:229], v7 offset:20480
    ds_read_b64_tr_b16 a[230:231], v7 offset:21504
    ds_read_b64_tr_b16 a[232:233], v6 offset:22528
    ds_read_b64_tr_b16 a[234:235], v6 offset:23552
    ds_read_b64_tr_b16 a[236:237], v7 offset:22528
    ds_read_b64_tr_b16 a[238:239], v7 offset:23552
    s_waitcnt lgkmcnt(0)
    s_waitcnt vmcnt(0)
    ds_read_b64_tr_b16 a[240:241], v6 offset:24576
    ds_read_b64_tr_b16 a[242:243], v6 offset:25600
    ds_read_b64_tr_b16 a[244:245], v7 offset:24576
    ds_read_b64_tr_b16 a[246:247], v7 offset:25600
    ds_read_b64_tr_b16 a[248:249], v6 offset:26624
    ds_read_b64_tr_b16 a[250:251], v6 offset:27648
    ds_read_b64_tr_b16 a[252:253], v7 offset:26624
    ds_read_b64_tr_b16 a[254:255], v7 offset:27648
    s_waitcnt lgkmcnt(0)
    v_and_b32 v2, 15, v0
    v_mul_u32_u24 v2, 1280, v2
    v_lshrrev_b32 v3, 4, v0
    v_lshl_add_u32 v2, v3, 3, v2
    s_and_b32 s34, s26, 1
    s_lshl_b32 s33, s34, 5
    s_add_u32 s33, s33, s32
    v_add_u32 v2, s33, v2
    s_lshl_b32 s33, s26, 13
    v_add_u32 v3, s33, v1
    s_lshl_b32 s33, s34, 10
    v_add_u32 v4, s33, v1
    s_mov_b32 s50, 0xbfb8aa3b
    s_barrier
L_g2_loop:
    s_mul_i32 s36, s47, 57344
    s_mul_i32 s33, s26, 14336
    s_add_u32 s36, s36, s33
    s_add_u32 s36, s36, 0x3400000
    s_lshl_b32 s38, s47, 17
    s_lshl_b32 s33, s26, 15
    s_add_u32 s38, s38, s33
    s_add_u32 s38, s38, 0x3c00000
    s_mul_i32 s40, s47, 20480
    s_lshr_b32 s41, s47, 3
    s_lshl_b32 s41, s41, 2
Lp_176:
    v_mov_b32 v11, 0
    buffer_load_dword v11, v11, s[64:67], s41 offen offset:64 sc1
    s_waitcnt vmcnt(0)
    v_readfirstlane_b32 s68, v11
    s_nop 3
    s_bfe_u32 s69, s68, 0xa0014
    s_cmp_lt_u32 s69, 56
    s_cbranch_scc1 Lp_176_n
    s_branch Lpok_177
Lp_176_n:
    s_add_u32 s74, s74, 1
    s_cmp_gt_u32 s74, 60000
    s_cbranch_scc1 L_wabort
    s_sleep 32
    s_branch Lp_176
Lpok_177:
    s_add_u32 s33, s36, 0
    buffer_load_dwordx4 v[48:51], v1, s[4:7], s33 offen offset:0 sc1
    s_add_u32 s33, s36, 0
    buffer_load_dwordx4 v[52:55], v1, s[4:7], s33 offen offset:1024 sc1
    s_add_u32 s33, s36, 0
    buffer_load_dwordx4 v[56:59], v1, s[4:7], s33 offen offset:2048 sc1
    s_add_u32 s33, s36, 0
    buffer_load_dwordx4 v[60:63], v1, s[4:7], s33 offen offset:3072 sc1
    s_add_u32 s33, s36, 4096
    buffer_load_dwordx4 v[64:67], v1, s[4:7], s33 offen offset:0 sc1
    s_add_u32 s33, s36, 4096
    buffer_load_dwordx4 v[68:71], v1, s[4:7], s33 offen offset:1024 sc1
    s_add_u32 s33, s36, 4096
    buffer_load_dwordx4 v[72:75], v1, s[4:7], s33 offen offset:2048 sc1
    s_add_u32 s33, s36, 4096
    buffer_load_dwordx4 v[76:79], v1, s[4:7], s33 offen offset:3072 sc1
    s_add_u32 s33, s36, 8192
    buffer_load_dwordx4 v[80:83], v1, s[4:7], s33 offen offset:0 sc1
    s_add_u32 s33, s36, 8192
    buffer_load_dwordx4 v[84:87], v1, s[4:7], s33 offen offset:1024 sc1
    s_add_u32 s33, s36, 8192
    buffer_load_dwordx4 v[88:91], v1, s[4:7], s33 offen offset:2048 sc1
    s_add_u32 s33, s36, 8192
    buffer_load_dwordx4 v[92:95], v1, s[4:7], s33 offen offset:3072 sc1
    s_add_u32 s33, s36, 12288
    buffer_load_dwordx4 v[96:99], v1, s[4:7], s33 offen offset:0 sc1
    s_add_u32 s33, s36, 12288
    buffer_load_dwordx4 v[100:103], v1, s[4:7], s33 offen offset:1024 sc1
    s_waitcnt vmcnt(13)
    v_mfma_f32_16x16x32_bf16 v[16:19], v[144:147], v[48:51], 0
    v_mfma_f32_16x16x32_bf16 v[20:23], v[148:151], v[48:51], 0
    s_waitcnt vmcnt(12)
    v_mfma_f32_16x16x32_bf16 v[16:19], v[152:155], v[52:55], v[16:19]
    v_mfma_f32_16x16x32_bf16 v[20:23], v[156:159], v[52:55], v[20:23]
    s_waitcnt vmcnt(11)
    v_mfma_f32_16x16x32_bf16 v[16:19], v[160:163], v[56:59], v[16:19]
    v_mfma_f32_16x16x32_bf16 v[20:23], v[164:167], v[56:59], v[20:23]
    s_waitcnt vmcnt(10)
    v_mfma_f32_16x16x32_bf16 v[16:19], v[168:171], v[60:63], v[16:19]
    v_mfma_f32_16x16x32_bf16 v[20:23], v[172:175], v[60:63], v[20:23]
    s_waitcnt vmcnt(9)
    v_mfma_f32_16x16x32_bf16 v[16:19], v[176:179], v[64:67], v[16:19]
    v_mfma_f32_16x16x32_bf16 v[20:23], v[180:183], v[64:67], v[20:23]
    s_waitcnt vmcnt(8)
    v_mfma_f32_16x16x32_bf16 v[16:19], v[184:187], v[68:71], v[16:19]
    v_mfma_f32_16x16x32_bf16 v[20:23], v[188:191], v[68:71], v[20:23]
    s_waitcnt vmcnt(7)
    v_mfma_f32_16x16x32_bf16 v[16:19], v[192:195], v[72:75], v[16:19]
    v_mfma_f32_16x16x32_bf16 v[20:23], v[196:199], v[72:75], v[20:23]
    s_waitcnt vmcnt(6)
    v_mfma_f32_16x16x32_bf16 v[16:19], v[200:203], v[76:79], v[16:19]
    v_mfma_f32_16x16x32_bf16 v[20:23], v[204:207], v[76:79], v[20:23]
    s_waitcnt vmcnt(5)
    v_mfma_f32_16x16x32_bf16 v[16:19], v[208:211], v[80:83], v[16:19]
    v_mfma_f32_16x16x32_bf16 v[20:23], v[212:215], v[80:83], v[20:23]
    s_waitcnt vmcnt(4)
    v_mfma_f32_16x16x32_bf16 v[16:19], v[216:219], v[84:87], v[16:19]
    v_mfma_f32_16x16x32_bf16 v[20:23], v[220:223], v[84:87], v[20:23]
    s_waitcnt vmcnt(3)
    v_mfma_f32_16x16x32_bf16 v[16:19], v[224:227], v[88:91], v[16:19]
    v_mfma_f32_16x16x32_bf16 v[20:23], v[228:231], v[88:91], v[20:23]
    s_waitcnt vmcnt(2)
    v_mfma_f32_16x16x32_bf16 v[16:19], v[232:235], v[92:95], v[16:19]
    v_mfma_f32_16x16x32_bf16 v[20:23], v[236:239], v[92:95], v[20:23]
    s_waitcnt vmcnt(1)
    v_mfma_f32_16x16x32_bf16 v[16:19], v[240:243], v[96:99], v[16:19]
    v_mfma_f32_16x16x32_bf16 v[20:23], v[244:247], v[96:99], v[20:23]
    s_waitcnt vmcnt(0)
    v_mfma_f32_16x16x32_bf16 v[16:19], v[248:251], v[100:103], v[16:19]
    v_mfma_f32_16x16x32_bf16 v[20:23], v[252:255], v[100:103], v[20:23]
    buffer_load_dwordx2 v[8:9], v2, s[8:11], s40 offen
    s_lshr_b32 s41, s47, 1
    s_cmp_lg_u32 s26, 0
    s_cbranch_scc1 L_g2_nopoll
    s_min_u32 s75, s41, 58
Lpp_178:
    v_mov_b32 v10, 0
    s_mov_b32 s69, 0x5c00000
    buffer_load_dword v10, v10, s[4:7], s69 offen sc1
    s_waitcnt vmcnt(0)
    v_readfirstlane_b32 s68, v10
    s_nop 3
    s_cmp_gt_u32 s68, s75
    s_cbranch_scc1 Lppok_179
    s_add_u32 s74, s74, 1
    s_cmp_gt_u32 s74, 60000
    s_cbranch_scc1 L_wabort
    s_sleep 8
    s_cmp_ge_u32 s68, s75
    s_cbranch_scc1 Lpp_178
    s_sleep 40
    s_branch Lpp_178
Lppok_179:
    s_lshl_b32 s41, s41, 7
    s_add_u32 s41, s41, 0x5c02000
Lp_181:
    v_mov_b32 v11, 0
    buffer_load_dword v11, v11, s[4:7], s41 offen offset:0 sc1
    s_waitcnt vmcnt(0)
    v_readfirstlane_b32 s68, v11
    s_nop 3
    s_bfe_u32 s69, s68, 0xa0000
    s_cmp_lt_u32 s69, 32
    s_cbranch_scc1 Lp_181_n
    s_branch Lpok_182
Lp_181_n:
    s_add_u32 s74, s74, 1
    s_cmp_gt_u32 s74, 60000
    s_cbranch_scc1 L_wabort
    s_sleep 4
    s_branch Lp_181
Lpok_182:
L_g2_nopoll:
    s_barrier
    s_waitcnt vmcnt(0)
    s_add_u32 s33, s38, 0
    buffer_load_dwordx4 v[48:51], v1, s[4:7], s33 offen offset:0 sc1
    s_add_u32 s33, s38, 0
    buffer_load_dwordx4 v[52:55], v1, s[4:7], s33 offen offset:1024 sc1
    s_add_u32 s33, s38, 0
    buffer_load_dwordx4 v[56:59], v1, s[4:7], s33 offen offset:2048 sc1
    s_add_u32 s33, s38, 0
    buffer_load_dwordx4 v[60:63], v1, s[4:7], s33 offen offset:3072 sc1
    s_add_u32 s33, s38, 4096
    buffer_load_dwordx4 v[64:67], v1, s[4:7], s33 offen offset:0 sc1
    s_add_u32 s33, s38, 4096
    buffer_load_dwordx4 v[68:71], v1, s[4:7], s33 offen offset:1024 sc1
    s_add_u32 s33, s38, 4096
    buffer_load_dwordx4 v[72:75], v1, s[4:7], s33 offen offset:2048 sc1
    s_add_u32 s33, s38, 4096
    buffer_load_dwordx4 v[76:79], v1, s[4:7], s33 offen offset:3072 sc1
    s_add_u32 s33, s38, 8192
    buffer_load_dwordx4 v[80:83], v1, s[4:7], s33 offen offset:0 sc1
    s_add_u32 s33, s38, 8192
    buffer_load_dwordx4 v[84:87], v1, s[4:7], s33 offen offset:1024 sc1
    s_add_u32 s33, s38, 8192
    buffer_load_dwordx4 v[88:91], v1, s[4:7], s33 offen offset:2048 sc1
    s_add_u32 s33, s38, 8192
    buffer_load_dwordx4 v[92:95], v1, s[4:7], s33 offen offset:3072 sc1
    s_add_u32 s33, s38, 12288
    buffer_load_dwordx4 v[96:99], v1, s[4:7], s33 offen offset:0 sc1
    s_add_u32 s33, s38, 12288
    buffer_load_dwordx4 v[100:103], v1, s[4:7], s33 offen offset:1024 sc1
    s_add_u32 s33, s38, 12288
    buffer_load_dwordx4 v[104:107], v1, s[4:7], s33 offen offset:2048 sc1
    s_add_u32 s33, s38, 12288
    buffer_load_dwordx4 v[108:111], v1, s[4:7], s33 offen offset:3072 sc1
    s_add_u32 s33, s38, 16384
    buffer_load_dwordx4 v[112:115], v1, s[4:7], s33 offen offset:0 sc1
    s_add_u32 s33, s38, 16384
    buffer_load_dwordx4 v[116:119], v1, s[4:7], s33 offen offset:1024 sc1
    s_add_u32 s33, s38, 16384
    buffer_load_dwordx4 v[120:123], v1, s[4:7], s33 offen offset:2048 sc1
    s_add_u32 s33, s38, 16384
    buffer_load_dwordx4 v[124:127], v1, s[4:7], s33 offen offset:3072 sc1
    s_add_u32 s33, s38, 20480
    buffer_load_dwordx4 v[128:131], v1, s[4:7], s33 offen offset:0 sc1
    s_add_u32 s33, s38, 20480
    buffer_load_dwordx4 v[132:135], v1, s[4:7], s33 offen offset:1024 sc1
    s_add_u32 s33, s38, 20480
    buffer_load_dwordx4 v[136:139], v1, s[4:7], s33 offen offset:2048 sc1
    s_add_u32 s33, s38, 20480
    buffer_load_dwordx4 v[140:143], v1, s[4:7], s33 offen offset:3072 sc1
    s_waitcnt vmcnt(23)
    v_mfma_f32_16x16x32_bf16 v[24:27], a[0:3], v[48:51], 0
    v_mfma_f32_16x16x32_bf16 v[28:31], a[4:7], v[48:51], 0
    s_add_u32 s33, s38, 24576
    buffer_load_dwordx4 v[48:51], v1, s[4:7], s33 offen offset:0 sc1
    s_waitcnt vmcnt(23)
    v_mfma_f32_16x16x32_bf16 v[24:27], a[8:11], v[52:55], v[24:27]
    v_mfma_f32_16x16x32_bf16 v[28:31], a[12:15], v[52:55], v[28:31]
    s_add_u32 s33, s38, 24576
    buffer_load_dwordx4 v[52:55], v1, s[4:7], s33 offen offset:1024 sc1
    s_waitcnt vmcnt(23)
    v_mfma_f32_16x16x32_bf16 v[24:27], a[16:19], v[56:59], v[24:27]
    v_mfma_f32_16x16x32_bf16 v[28:31], a[20:23], v[56:59], v[28:31]
    s_add_u32 s33, s38, 24576
    buffer_load_dwordx4 v[56:59], v1, s[4:7], s33 offen offset:2048 sc1
    s_waitcnt vmcnt(23)
    v_mfma_f32_16x16x32_bf16 v[24:27], a[24:27], v[60:63], v[24:27]
    v_mfma_f32_16x16x32_bf16 v[28:31], a[28:31], v[60:63], v[28:31]
    s_add_u32 s33, s38, 24576
    buffer_load_dwordx4 v[60:63], v1, s[4:7], s33 offen offset:3072 sc1
    s_waitcnt vmcnt(23)
    v_mfma_f32_16x16x32_bf16 v[24:27], a[32:35], v[64:67], v[24:27]
    v_mfma_f32_16x16x32_bf16 v[28:31], a[36:39], v[64:67], v[28:31]
    s_add_u32 s33, s38, 28672
    buffer_load_dwordx4 v[64:67], v1, s[4:7], s33 offen offset:0 sc1
    s_waitcnt vmcnt(23)
    v_mfma_f32_16x16x32_bf16 v[24:27], a[40:43], v[68:71], v[24:27]
    v_mfma_f32_16x16x32_bf16 v[28:31], a[44:47], v[68:71], v[28:31]
    s_add_u32 s33, s38, 28672
    buffer_load_dwordx4 v[68:71], v1, s[4:7], s33 offen offset:1024 sc1
    s_waitcnt vmcnt(23)
    v_mfma_f32_16x16x32_bf16 v[24:27], a[48:51], v[72:75], v[24:27]
    v_mfma_f32_16x16x32_bf16 v[28:31], a[52:55], v[72:75], v[28:31]
    s_add_u32 s33, s38, 28672
    buffer_load_dwordx4 v[72:75], v1, s[4:7], s33 offen offset:2048 sc1
    s_waitcnt vmcnt(23)
    v_mfma_f32_16x16x32_bf16 v[24:27], a[56:59], v[76:79], v[24:27]
    v_mfma_f32_16x16x32_bf16 v[28:31], a[60:63], v[76:79], v[28:31]
    s_add_u32 s33, s38, 28672
    buffer_load_dwordx4 v[76:79], v1, s[4:7], s33 offen offset:3072 sc1
    s_waitcnt vmcnt(23)
    v_mfma_f32_16x16x32_bf16 v[24:27], a[64:67], v[80:83], v[24:27]
    v_mfma_f32_16x16x32_bf16 v[28:31], a[68:71], v[80:83], v[28:31]
    s_waitcnt vmcnt(22)
    v_mfma_f32_16x16x32_bf16 v[24:27], a[72:75], v[84:87], v[24:27]
    v_mfma_f32_16x16x32_bf16 v[28:31], a[76:79], v[84:87], v[28:31]
    s_waitcnt vmcnt(21)
    v_mfma_f32_16x16x32_bf16 v[24:27], a[80:83], v[88:91], v[24:27]
    v_mfma_f32_16x16x32_bf16 v[28:31], a[84:87], v[88:91], v[28:31]
    s_waitcnt vmcnt(20)
    v_mfma_f32_16x16x32_bf16 v[24:27], a[88:91], v[92:95], v[24:27]
    v_mfma_f32_16x16x32_bf16 v[28:31], a[92:95], v[92:95], v[28:31]
    s_waitcnt vmcnt(19)
    v_mfma_f32_16x16x32_bf16 v[24:27], a[96:99], v[96:99], v[24:27]
    v_mfma_f32_16x16x32_bf16 v[28:31], a[100:103], v[96:99], v[28:31]
    s_waitcnt vmcnt(18)
    v_mfma_f32_16x16x32_bf16 v[24:27], a[104:107], v[100:103], v[24:27]
    v_mfma_f32_16x16x32_bf16 v[28:31], a[108:111], v[100:103], v[28:31]
    s_waitcnt vmcnt(17)
    v_mfma_f32_16x16x32_bf16 v[24:27], a[112:115], v[104:107], v[24:27]
    v_mfma_f32_16x16x32_bf16 v[28:31], a[116:119], v[104:107], v[28:31]
    s_waitcnt vmcnt(16)
    v_mfma_f32_16x16x32_bf16 v[24:27], a[120:123], v[108:111], v[24:27]
    v_mfma_f32_16x16x32_bf16 v[28:31], a[124:127], v[108:111], v[28:31]
    s_waitcnt vmcnt(15)
    v_mfma_f32_16x16x32_bf16 v[24:27], a[128:131], v[112:115], v[24:27]
    v_mfma_f32_16x16x32_bf16 v[28:31], a[132:135], v[112:115], v[28:31]
    s_waitcnt vmcnt(14)
    v_mfma_f32_16x16x32_bf16 v[24:27], a[136:139], v[116:119], v[24:27]
    v_mfma_f32_16x16x32_bf16 v[28:31], a[140:143], v[116:119], v[28:31]
    s_waitcnt vmcnt(13)
    v_mfma_f32_16x16x32_bf16 v[24:27], a[144:147], v[120:123], v[24:27]
    v_mfma_f32_16x16x32_bf16 v[28:31], a[148:151], v[120:123], v[28:31]
    s_waitcnt vmcnt(12)
    v_mfma_f32_16x16x32_bf16 v[24:27], a[152:155], v[124:127], v[24:27]
    v_mfma_f32_16x16x32_bf16 v[28:31], a[156:159], v[124:127], v[28:31]
    s_waitcnt vmcnt(11)
    v_mfma_f32_16x16x32_bf16 v[24:27], a[160:163], v[128:131], v[24:27]
    v_mfma_f32_16x16x32_bf16 v[28:31], a[164:167], v[128:131], v[28:31]
    s_waitcnt vmcnt(10)
    v_mfma_f32_16x16x32_bf16 v[24:27], a[168:171], v[132:135], v[24:27]
    v_mfma_f32_16x16x32_bf16 v[28:31], a[172:175], v[132:135], v[28:31]
    s_waitcnt vmcnt(9)
    v_mfma_f32_16x16x32_bf16 v[24:27], a[176:179], v[136:139], v[24:27]
    v_mfma_f32_16x16x32_bf16 v[28:31], a[180:183], v[136:139], v[28:31]
    s_waitcnt vmcnt(8)
    v_mfma_f32_16x16x32_bf16 v[24:27], a[184:187], v[140:143], v[24:27]
    v_mfma_f32_16x16x32_bf16 v[28:31], a[188:191], v[140:143], v[28:31]
    s_waitcnt vmcnt(7)
    v_mfma_f32_16x16x32_bf16 v[24:27], a[192:195], v[48:51], v[24:27]
    v_mfma_f32_16x16x32_bf16 v[28:31], a[196:199], v[48:51], v[28:31]
    s_waitcnt vmcnt(6)
    v_mfma_f32_16x16x32_bf16 v[24:27], a[200:203], v[52:55], v[24:27]
    v_mfma_f32_16x16x32_bf16 v[28:31], a[204:207], v[52:55], v[28:31]
    s_waitcnt vmcnt(5)
    v_mfma_f32_16x16x32_bf16 v[24:27], a[208:211], v[56:59], v[24:27]
    v_mfma_f32_16x16x32_bf16 v[28:31], a[212:215], v[56:59], v[28:31]
    s_waitcnt vmcnt(4)
    v_mfma_f32_16x16x32_bf16 v[24:27], a[216:219], v[60:63], v[24:27]
    v_mfma_f32_16x16x32_bf16 v[28:31], a[220:223], v[60:63], v[28:31]
    s_waitcnt vmcnt(3)
    v_mfma_f32_16x16x32_bf16 v[24:27], a[224:227], v[64:67], v[24:27]
    v_mfma_f32_16x16x32_bf16 v[28:31], a[228:231], v[64:67], v[28:31]
    s_waitcnt vmcnt(2)
    v_mfma_f32_16x16x32_bf16 v[24:27], a[232:235], v[68:71], v[24:27]
    v_mfma_f32_16x16x32_bf16 v[28:31], a[236:239], v[68:71], v[28:31]
    s_waitcnt vmcnt(1)
    v_mfma_f32_16x16x32_bf16 v[24:27], a[240:243], v[72:75], v[24:27]
    v_mfma_f32_16x16x32_bf16 v[28:31], a[244:247], v[72:75], v[28:31]
    s_waitcnt vmcnt(0)
    v_mfma_f32_16x16x32_bf16 v[24:27], a[248:251], v[76:79], v[24:27]
    v_mfma_f32_16x16x32_bf16 v[28:31], a[252:255], v[76:79], v[28:31]
    s_nop 7
    ds_write_b128 v3, v[16:19] offset:0
    ds_write_b128 v3, v[20:23] offset:1024
    ds_write_b128 v3, v[24:27] offset:2048
    ds_write_b128 v3, v[28:31] offset:3072
    s_waitcnt lgkmcnt(0)
    s_barrier
    ds_read_b128 v[48:51], v4 offset:0
    ds_read_b128 v[64:67], v4 offset:2048
    ds_read_b128 v[52:55], v4 offset:8192
    ds_read_b128 v[68:71], v4 offset:10240
    ds_read_b128 v[56:59], v4 offset:16384
    ds_read_b128 v[72:75], v4 offset:18432
    ds_read_b128 v[60:63], v4 offset:24576
    ds_read_b128 v[76:79], v4 offset:26624
    v_lshlrev_b32 v12, 16, v8
    v_and_b32 v13, 0xffff0000, v8
    v_lshlrev_b32 v14, 16, v9
    v_and_b32 v15, 0xffff0000, v9
    s_waitcnt lgkmcnt(0)
    s_barrier
    s_cmp_ge_u32 s26, 2
    s_cbranch_scc1 Lg2sk_183
    v_add_f32 v48, v48, v52
    v_add_f32 v56, v56, v60
    v_add_f32 v49, v49, v53
    v_add_f32 v57, v57, v61
    v_add_f32 v50, v50, v54
    v_add_f32 v58, v58, v62
    v_add_f32 v51, v51, v55
    v_add_f32 v59, v59, v63
    v_add_f32 v48, v48, v56
    v_add_f32 v49, v49, v57
    v_add_f32 v50, v50, v58
    v_add_f32 v51, v51, v59
    v_add_f32 v64, v64, v68
    v_add_f32 v72, v72, v76
    v_add_f32 v65, v65, v69
    v_add_f32 v73, v73, v77
    v_add_f32 v66, v66, v70
    v_add_f32 v74, v74, v78
    v_add_f32 v67, v67, v71
    v_add_f32 v75, v75, v79
    v_add_f32 v64, v64, v72
    v_add_f32 v65, v65, v73
    v_add_f32 v66, v66, v74
    v_add_f32 v67, v67, v75
    v_mul_f32 v52, s50, v48
    v_mul_f32 v53, s50, v49
    v_mul_f32 v54, s50, v50
    v_mul_f32 v55, s50, v51
    v_exp_f32 v52, v52
    v_exp_f32 v53, v53
    v_exp_f32 v54, v54
    v_exp_f32 v55, v55
    v_add_f32 v52, 1.0, v52
    v_add_f32 v53, 1.0, v53
    v_add_f32 v54, 1.0, v54
    v_add_f32 v55, 1.0, v55
    v_rcp_f32 v52, v52
    v_rcp_f32 v53, v53
    v_rcp_f32 v54, v54
    v_rcp_f32 v55, v55
    v_mul_f32 v48, v48, v64
    v_mul_f32 v49, v49, v65
    v_mul_f32 v50, v50, v66
    v_mul_f32 v51, v51, v67
    v_fma_f32 v12, v48, v52, v12
    v_fma_f32 v13, v49, v53, v13
    v_fma_f32 v14, v50, v54, v14
    v_fma_f32 v15, v51, v55, v15
    v_cvt_pk_bf16_f32 v12, v12, v13
    v_cvt_pk_bf16_f32 v13, v14, v15
    buffer_store_dwordx2 v[12:13], v2, s[16:19], s40 offen
Lg2sk_183:
    s_add_u32 s47, s47, 8
    s_cmp_lt_u32 s47, 128
    s_cbranch_scc1 L_g2_loop
    s_branch L_end
L_att_role:
    v_lshlrev_b32 v1, 4, v0
    v_lshlrev_b32 v2, 2, v0
    v_and_b32 v3, 15, v0
    v_lshrrev_b32 v8, 4, v0
    v_lshlrev_b32 v8, 2, v8
    v_add_u32 v9, 0, v8
    v_cmp_gt_u32 s[20:21], v9, v3
    v_add_u32 v9, 1, v8
    v_cmp_gt_u32 s[22:23], v9, v3
    v_add_u32 v9, 2, v8
    v_cmp_gt_u32 s[24:25], v9, v3
    v_add_u32 v9, 3, v8
    v_cmp_gt_u32 s[26:27], v9, v3
    v_mov_b32 v4, 0x3f803f80
    v_mov_b32 v5, 0x3f803f80
    v_mov_b32 v6, 0x3f803f80
    v_mov_b32 v7, 0x3f803f80
    s_mov_b32 s51, 0x3e0293ee
    v_mov_b32 v3, 0xf149f2ca
    v_lshrrev_b32 v0, 6, v0
    s_mov_b32 s47, s73
L_att_loop:
    s_lshl_b32 s30, s71, 6
    s_add_u32 s30, s30, s47
    s_lshl_b32 s33, s30, 13
    s_add_u32 s34, s33, 0x400000
    s_add_u32 s35, s34, 4096
    s_add_u32 s40, s33, 0x6000000
    s_add_u32 s41, s40, 4096
    s_lshl_b32 s33, s30, 14
    s_add_u32 s36, s33, 0x1400000
    s_add_u32 s37, s36, 4096
    s_add_u32 s38, s36, 8192
    s_add_u32 s39, s38, 4096
    s_lshr_b32 s44, s47, 2
    s_lshl_b32 s44, s44, 2
Lp_184:
    v_mov_b32 v15, 0
    buffer_load_dword v15, v15, s[64:67], s44 offen offset:64 sc1
    s_waitcnt vmcnt(0)
    v_readfirstlane_b32 s68, v15
    s_nop 3
    s_bfe_u32 s69, s68, 0xa0000
    s_cmp_lt_u32 s69, 128
    s_cbranch_scc1 Lp_184_n
    s_bfe_u32 s69, s68, 0xa000a
    s_cmp_lt_u32 s69, 64
    s_cbranch_scc1 Lp_184_n
    s_branch Lpok_185
Lp_184_n:
    s_add_u32 s74, s74, 1
    s_cmp_gt_u32 s74, 60000
    s_cbranch_scc1 L_wabort
    s_sleep 32
    s_branch Lp_184
Lpok_185:
    buffer_load_dwordx4 v[16:19], v1, s[4:7], s34 offen offset:0 sc1
    buffer_load_dwordx4 v[20:23], v1, s[4:7], s34 offen offset:1024 sc1
    buffer_load_dwordx4 v[24:27], v1, s[4:7], s34 offen offset:2048 sc1
    buffer_load_dwordx4 v[28:31], v1, s[4:7], s34 offen offset:3072 sc1
    buffer_load_dwordx4 v[32:35], v1, s[4:7], s35 offen offset:0 sc1
    buffer_load_dwordx4 v[36:39], v1, s[4:7], s35 offen offset:1024 sc1
    buffer_load_dwordx4 v[40:43], v1, s[4:7], s35 offen offset:2048 sc1
    buffer_load_dwordx4 v[44:47], v1, s[4:7], s35 offen offset:3072 sc1
    buffer_load_dwordx4 v[48:51], v1, s[4:7], s36 offen offset:0 sc1
    buffer_load_dwordx4 v[52:55], v1, s[4:7], s36 offen offset:1024 sc1
    buffer_load_dwordx4 v[56:59], v1, s[4:7], s36 offen offset:2048 sc1
    buffer_load_dwordx4 v[60:63], v1, s[4:7], s36 offen offset:3072 sc1
    buffer_load_dwordx4 v[64:67], v1, s[4:7], s37 offen offset:0 sc1
    buffer_load_dwordx4 v[68:71], v1, s[4:7], s37 offen offset:1024 sc1
    buffer_load_dwordx4 v[72:75], v1, s[4:7], s37 offen offset:2048 sc1
    buffer_load_dwordx4 v[76:79], v1, s[4:7], s37 offen offset:3072 sc1
    buffer_load_dwordx4 v[96:99], v1, s[4:7], s38 offen offset:0 sc1
    buffer_load_dwordx4 v[100:103], v1, s[4:7], s38 offen offset:1024 sc1
    buffer_load_dwordx4 v[104:107], v1, s[4:7], s38 offen offset:2048 sc1
    buffer_load_dwordx4 v[108:111], v1, s[4:7], s38 offen offset:3072 sc1
    buffer_load_dwordx4 v[112:115], v1, s[4:7], s39 offen offset:0 sc1
    buffer_load_dwordx4 v[116:119], v1, s[4:7], s39 offen offset:1024 sc1
    buffer_load_dwordx4 v[120:123], v1, s[4:7], s39 offen offset:2048 sc1
    buffer_load_dwordx4 v[124:127], v1, s[4:7], s39 offen offset:3072 sc1
    s_min_u32 s75, s47, 55
Lpp_186:
    v_mov_b32 v14, 0
    s_mov_b32 s69, 0x5c00000
    buffer_load_dword v14, v14, s[4:7], s69 offen sc1
    s_waitcnt vmcnt(0)
    v_readfirstlane_b32 s68, v14
    s_nop 3
    s_cmp_gt_u32 s68, s75
    s_cbranch_scc1 Lppok_187
    s_add_u32 s74, s74, 1
    s_cmp_gt_u32 s74, 60000
    s_cbranch_scc1 L_wabort
    s_sleep 8
    s_cmp_ge_u32 s68, s75
    s_cbranch_scc1 Lpp_186
    s_sleep 40
    s_branch Lpp_186
Lppok_187:
    s_cmp_gt_u32 s68, s47
    s_cbranch_scc1 Lppd_188
Lpf_189:
    v_mov_b32 v14, 0
    s_lshl_b32 s69, s71, 7
    s_add_u32 s69, s69, 0x5c00080
    buffer_load_dwordx2 v[14:15], v14, s[4:7], s69 offen sc1
    s_waitcnt vmcnt(0)
    v_min_u32 v14, v14, v15
    s_nop 0
    v_readfirstlane_b32 s68, v14
    s_nop 3
    s_cmp_gt_u32 s68, s47
    s_cbranch_scc1 Lppd_188
    s_add_u32 s74, s74, 1
    s_cmp_gt_u32 s74, 60000
    s_cbranch_scc1 L_wabort
    s_sleep 4
    s_branch Lpf_189
Lppd_188:
    buffer_load_dwordx4 v[80:83], v1, s[4:7], s40 offen offset:0 sc1
    buffer_load_dwordx4 v[84:87], v1, s[4:7], s40 offen offset:1024 sc1
    buffer_load_dwordx4 v[88:91], v1, s[4:7], s40 offen offset:2048 sc1
    buffer_load_dwordx4 v[92:95], v1, s[4:7], s40 offen offset:3072 sc1
    buffer_load_dword v128, v2, s[4:7], s41 offen offset:0 sc1
    buffer_load_dword v130, v2, s[4:7], s41 offen offset:256 sc1
    buffer_load_dword v132, v2, s[4:7], s41 offen offset:512 sc1
    buffer_load_dword v134, v2, s[4:7], s41 offen offset:768 sc1
    buffer_load_dword v136, v2, s[4:7], s41 offen offset:1024 sc1
    buffer_load_dword v138, v2, s[4:7], s41 offen offset:1280 sc1
    buffer_load_dword v140, v2, s[4:7], s41 offen offset:1536 sc1
    buffer_load_dword v142, v2, s[4:7], s41 offen offset:1792 sc1
    v_mov_b32 v129, 0
    v_mov_b32 v131, 0
    v_mov_b32 v133, 0
    v_mov_b32 v135, 0
    v_mov_b32 v137, 0
    v_mov_b32 v139, 0
    v_mov_b32 v141, 0
    v_mov_b32 v143, 0
    s_and_b32 s42, s30, 63
    s_lshl_b32 s42, s42, 18
    s_lshr_b32 s43, s30, 6
    s_lshl_b32 s43, s43, 12
    s_add_u32 s42, s42, s43
    s_add_u32 s42, s42, 0x3c00000
    s_add_u32 s43, s42, 0x20000
    s_waitcnt vmcnt(8)
    v_mfma_f32_16x16x32_bf16 v[168:171], v[80:83], v[16:19], 0
    v_mfma_f32_16x16x32_bf16 v[168:171], v[84:87], v[20:23], v[168:171]
    v_mfma_f32_16x16x32_bf16 v[168:171], v[88:91], v[24:27], v[168:171]
    v_mfma_f32_16x16x32_bf16 v[168:171], v[92:95], v[28:31], v[168:171]
    v_mfma_f32_16x16x32_bf16 v[172:175], v[48:51], v[16:19], 0
    v_mfma_f32_16x16x32_bf16 v[172:175], v[52:55], v[20:23], v[172:175]
    v_mfma_f32_16x16x32_bf16 v[172:175], v[56:59], v[24:27], v[172:175]
    v_mfma_f32_16x16x32_bf16 v[172:175], v[60:63], v[28:31], v[172:175]
    v_mfma_f32_16x16x32_bf16 v[144:147], v[80:83], v[32:35], 0
    v_mfma_f32_16x16x32_bf16 v[144:147], v[84:87], v[36:39], v[144:147]
    v_mfma_f32_16x16x32_bf16 v[144:147], v[88:91], v[40:43], v[144:147]
    v_mfma_f32_16x16x32_bf16 v[144:147], v[92:95], v[44:47], v[144:147]
    v_mfma_f32_16x16x32_bf16 v[148:151], v[48:51], v[32:35], 0
    v_mfma_f32_16x16x32_bf16 v[148:151], v[52:55], v[36:39], v[148:151]
    v_mfma_f32_16x16x32_bf16 v[148:151], v[56:59], v[40:43], v[148:151]
    v_mfma_f32_16x16x32_bf16 v[148:151], v[60:63], v[44:47], v[148:151]
    v_mfma_f32_16x16x32_bf16 v[152:155], v[64:67], v[32:35], 0
    v_mfma_f32_16x16x32_bf16 v[152:155], v[68:71], v[36:39], v[152:155]
    v_mfma_f32_16x16x32_bf16 v[152:155], v[72:75], v[40:43], v[152:155]
    v_mfma_f32_16x16x32_bf16 v[152:155], v[76:79], v[44:47], v[152:155]
    v_cndmask_b32 v172, v172, v3, s[20:21]
    v_cndmask_b32 v173, v173, v3, s[22:23]
    v_cndmask_b32 v174, v174, v3, s[24:25]
    v_cndmask_b32 v175, v175, v3, s[26:27]
    v_max3_f32 v170, v168, v169, v172
    v_max3_f32 v170, v170, v173, v174
    v_max_f32 v170, v170, v175
    v_mov_b32 v171, v170
    s_nop 1
    v_permlane16_swap_b32 v170, v171
    v_max_f32 v170, v170, v171
    v_mov_b32 v171, v170
    s_nop 1
    v_permlane32_swap_b32 v170, v171
    v_max_f32 v170, v170, v171
    v_mul_f32 v170, s51, v170
    v_fma_f32 v168, v168, s51, -v170
    v_fma_f32 v169, v169, s51, -v170
    v_fma_f32 v172, v172, s51, -v170
    v_fma_f32 v173, v173, s51, -v170
    v_fma_f32 v174, v174, s51, -v170
    v_fma_f32 v175, v175, s51, -v170
    v_exp_f32 v168, v168
    v_exp_f32 v169, v169
    v_exp_f32 v172, v172
    v_exp_f32 v173, v173
    v_exp_f32 v174, v174
    v_exp_f32 v175, v175
    v_mov_b32 v13, 0
    v_cvt_pk_bf16_f32 v12, v168, v169
    v_cvt_pk_bf16_f32 v8, v172, v173
    v_cvt_pk_bf16_f32 v9, v174, v175
    v_mov_b32 v10, 0
    v_mov_b32 v11, 0
    s_nop 4
    v_cndmask_b32 v152, v152, v3, s[20:21]
    v_cndmask_b32 v153, v153, v3, s[22:23]
    v_cndmask_b32 v154, v154, v3, s[24:25]
    v_cndmask_b32 v155, v155, v3, s[26:27]
    v_max3_f32 v146, v144, v145, v148
    v_max3_f32 v146, v146, v149, v150
    v_max3_f32 v146, v146, v151, v152
    v_max3_f32 v146, v146, v153, v154
    v_max_f32 v146, v146, v155
    v_mov_b32 v147, v146
    s_nop 1
    v_permlane16_swap_b32 v146, v147
    v_max_f32 v146, v146, v147
    v_mov_b32 v147, v146
    s_nop 1
    v_permlane32_swap_b32 v146, v147
    v_max_f32 v146, v146, v147
    v_mul_f32 v146, s51, v146
    v_fma_f32 v144, v144, s51, -v146
    v_fma_f32 v145, v145, s51, -v146
    v_fma_f32 v148, v148, s51, -v146
    v_fma_f32 v149, v149, s51, -v146
    v_fma_f32 v150, v150, s51, -v146
    v_fma_f32 v151, v151, s51, -v146
    v_fma_f32 v152, v152, s51, -v146
    v_fma_f32 v153, v153, s51, -v146
    v_fma_f32 v154, v154, s51, -v146
    v_fma_f32 v155, v155, s51, -v146
    v_exp_f32 v144, v144
    v_exp_f32 v145, v145
    v_exp_f32 v148, v148
    v_exp_f32 v149, v149
    v_exp_f32 v150, v150
    v_exp_f32 v151, v151
    v_exp_f32 v152, v152
    v_exp_f32 v153, v153
    v_exp_f32 v154, v154
    v_exp_f32 v155, v155
    v_mov_b32 v161, 0
    v_cvt_pk_bf16_f32 v160, v144, v145
    v_cvt_pk_bf16_f32 v156, v148, v149
    v_cvt_pk_bf16_f32 v157, v150, v151
    v_cvt_pk_bf16_f32 v158, v152, v153
    v_cvt_pk_bf16_f32 v159, v154, v155
    s_waitcnt vmcnt(0)
    v_mfma_f32_16x16x16_bf16 v[164:167], v[4:5], v[12:13], 0
    v_mfma_f32_16x16x16_bf16 v[16:19], v[128:129], v[12:13], 0
    v_mfma_f32_16x16x16_bf16 v[20:23], v[130:131], v[12:13], 0
    v_mfma_f32_16x16x16_bf16 v[24:27], v[132:133], v[12:13], 0
    v_mfma_f32_16x16x16_bf16 v[28:31], v[134:135], v[12:13], 0
    v_mfma_f32_16x16x16_bf16 v[32:35], v[136:137], v[12:13], 0
    v_mfma_f32_16x16x16_bf16 v[36:39], v[138:139], v[12:13], 0
    v_mfma_f32_16x16x16_bf16 v[40:43], v[140:141], v[12:13], 0
    v_mfma_f32_16x16x16_bf16 v[44:47], v[142:143], v[12:13], 0
    v_mfma_f32_16x16x32_bf16 v[164:167], v[4:7], v[8:11], v[164:167]
    v_mfma_f32_16x16x32_bf16 v[16:19], v[96:99], v[8:11], v[16:19]
    v_mfma_f32_16x16x32_bf16 v[20:23], v[100:103], v[8:11], v[20:23]
    v_mfma_f32_16x16x32_bf16 v[24:27], v[104:107], v[8:11], v[24:27]
    v_mfma_f32_16x16x32_bf16 v[28:31], v[108:111], v[8:11], v[28:31]
    v_mfma_f32_16x16x32_bf16 v[32:35], v[112:115], v[8:11], v[32:35]
    v_mfma_f32_16x16x32_bf16 v[36:39], v[116:119], v[8:11], v[36:39]
    v_mfma_f32_16x16x32_bf16 v[40:43], v[120:123], v[8:11], v[40:43]
    v_mfma_f32_16x16x32_bf16 v[44:47], v[124:127], v[8:11], v[44:47]
    v_rcp_f32 v14, v164
    s_nop 1
    v_mul_f32 v16, v16, v14
    v_mul_f32 v17, v17, v14
    v_mul_f32 v18, v18, v14
    v_mul_f32 v19, v19, v14
    v_mul_f32 v20, v20, v14
    v_mul_f32 v21, v21, v14
    v_mul_f32 v22, v22, v14
    v_mul_f32 v23, v23, v14
    v_cvt_pk_bf16_f32 v16, v16, v17
    v_cvt_pk_bf16_f32 v17, v18, v19
    v_cvt_pk_bf16_f32 v18, v20, v21
    v_cvt_pk_bf16_f32 v19, v22, v23
    buffer_store_dwordx4 v[16:19], v1, s[4:7], s42 offen offset:0 sc1
    v_mul_f32 v24, v24, v14
    v_mul_f32 v25, v25, v14
    v_mul_f32 v26, v26, v14
    v_mul_f32 v27, v27, v14
    v_mul_f32 v28, v28, v14
    v_mul_f32 v29, v29, v14
    v_mul_f32 v30, v30, v14
    v_mul_f32 v31, v31, v14
    v_cvt_pk_bf16_f32 v24, v24, v25
    v_cvt_pk_bf16_f32 v25, v26, v27
    v_cvt_pk_bf16_f32 v26, v28, v29
    v_cvt_pk_bf16_f32 v27, v30, v31
    buffer_store_dwordx4 v[24:27], v1, s[4:7], s42 offen offset:1024 sc1
    v_mul_f32 v32, v32, v14
    v_mul_f32 v33, v33, v14
    v_mul_f32 v34, v34, v14
    v_mul_f32 v35, v35, v14
    v_mul_f32 v36, v36, v14
    v_mul_f32 v37, v37, v14
    v_mul_f32 v38, v38, v14
    v_mul_f32 v39, v39, v14
    v_cvt_pk_bf16_f32 v32, v32, v33
    v_cvt_pk_bf16_f32 v33, v34, v35
    v_cvt_pk_bf16_f32 v34, v36, v37
    v_cvt_pk_bf16_f32 v35, v38, v39
    buffer_store_dwordx4 v[32:35], v1, s[4:7], s42 offen offset:2048 sc1
    s_nop 0
    v_mul_f32 v40, v40, v14
    v_mul_f32 v41, v41, v14
    v_mul_f32 v42, v42, v14
    v_mul_f32 v43, v43, v14
    v_mul_f32 v44, v44, v14
    v_mul_f32 v45, v45, v14
    v_mul_f32 v46, v46, v14
    v_mul_f32 v47, v47, v14
    v_cvt_pk_bf16_f32 v40, v40, v41
    v_cvt_pk_bf16_f32 v41, v42, v43
    v_cvt_pk_bf16_f32 v42, v44, v45
    v_cvt_pk_bf16_f32 v43, v46, v47
    buffer_store_dwordx4 v[40:43], v1, s[4:7], s42 offen offset:3072 sc1
    v_mfma_f32_16x16x16_bf16 v[164:167], v[4:5], v[160:161], 0
    v_mfma_f32_16x16x16_bf16 v[48:51], v[128:129], v[160:161], 0
    v_mfma_f32_16x16x16_bf16 v[52:55], v[130:131], v[160:161], 0
    v_mfma_f32_16x16x16_bf16 v[56:59], v[132:133], v[160:161], 0
    v_mfma_f32_16x16x16_bf16 v[60:63], v[134:135], v[160:161], 0
    v_mfma_f32_16x16x16_bf16 v[64:67], v[136:137], v[160:161], 0
    v_mfma_f32_16x16x16_bf16 v[68:71], v[138:139], v[160:161], 0
    v_mfma_f32_16x16x16_bf16 v[72:75], v[140:141], v[160:161], 0
    v_mfma_f32_16x16x16_bf16 v[76:79], v[142:143], v[160:161], 0
    v_mfma_f32_16x16x32_bf16 v[164:167], v[4:7], v[156:159], v[164:167]
    v_mfma_f32_16x16x32_bf16 v[48:51], v[96:99], v[156:159], v[48:51]
    v_mfma_f32_16x16x32_bf16 v[52:55], v[100:103], v[156:159], v[52:55]
    v_mfma_f32_16x16x32_bf16 v[56:59], v[104:107], v[156:159], v[56:59]
    v_mfma_f32_16x16x32_bf16 v[60:63], v[108:111], v[156:159], v[60:63]
    v_mfma_f32_16x16x32_bf16 v[64:67], v[112:115], v[156:159], v[64:67]
    v_mfma_f32_16x16x32_bf16 v[68:71], v[116:119], v[156:159], v[68:71]
    v_mfma_f32_16x16x32_bf16 v[72:75], v[120:123], v[156:159], v[72:75]
    v_mfma_f32_16x16x32_bf16 v[76:79], v[124:127], v[156:159], v[76:79]
    v_rcp_f32 v14, v164
    s_nop 1
    v_mul_f32 v48, v48, v14
    v_mul_f32 v49, v49, v14
    v_mul_f32 v50, v50, v14
    v_mul_f32 v51, v51, v14
    v_mul_f32 v52, v52, v14
    v_mul_f32 v53, v53, v14
    v_mul_f32 v54, v54, v14
    v_mul_f32 v55, v55, v14
    v_cvt_pk_bf16_f32 v48, v48, v49
    v_cvt_pk_bf16_f32 v49, v50, v51
    v_cvt_pk_bf16_f32 v50, v52, v53
    v_cvt_pk_bf16_f32 v51, v54, v55
    buffer_store_dwordx4 v[48:51], v1, s[4:7], s43 offen offset:0 sc1
    v_mul_f32 v56, v56, v14
    v_mul_f32 v57, v57, v14
    v_mul_f32 v58, v58, v14
    v_mul_f32 v59, v59, v14
    v_mul_f32 v60, v60, v14
    v_mul_f32 v61, v61, v14
    v_mul_f32 v62, v62, v14
    v_mul_f32 v63, v63, v14
    v_cvt_pk_bf16_f32 v56, v56, v57
    v_cvt_pk_bf16_f32 v57, v58, v59
    v_cvt_pk_bf16_f32 v58, v60, v61
    v_cvt_pk_bf16_f32 v59, v62, v63
    buffer_store_dwordx4 v[56:59], v1, s[4:7], s43 offen offset:1024 sc1
    v_mul_f32 v64, v64, v14
    v_mul_f32 v65, v65, v14
    v_mul_f32 v66, v66, v14
    v_mul_f32 v67, v67, v14
    v_mul_f32 v68, v68, v14
    v_mul_f32 v69, v69, v14
    v_mul_f32 v70, v70, v14
    v_mul_f32 v71, v71, v14
    v_cvt_pk_bf16_f32 v64, v64, v65
    v_cvt_pk_bf16_f32 v65, v66, v67
    v_cvt_pk_bf16_f32 v66, v68, v69
    v_cvt_pk_bf16_f32 v67, v70, v71
    buffer_store_dwordx4 v[64:67], v1, s[4:7], s43 offen offset:2048 sc1
    s_nop 0
    v_mul_f32 v72, v72, v14
    v_mul_f32 v73, v73, v14
    v_mul_f32 v74, v74, v14
    v_mul_f32 v75, v75, v14
    v_mul_f32 v76, v76, v14
    v_mul_f32 v77, v77, v14
    v_mul_f32 v78, v78, v14
    v_mul_f32 v79, v79, v14
    v_cvt_pk_bf16_f32 v72, v72, v73
    v_cvt_pk_bf16_f32 v73, v74, v75
    v_cvt_pk_bf16_f32 v74, v76, v77
    v_cvt_pk_bf16_f32 v75, v78, v79
    buffer_store_dwordx4 v[72:75], v1, s[4:7], s43 offen offset:3072 sc1
    s_waitcnt vmcnt(0)
    s_lshl_b32 s44, s47, 7
    s_add_u32 s44, s44, 0x5c02000
    s_mov_b64 exec, 1
    v_mov_b32 v15, 1
    buffer_atomic_add v15, v0, s[4:7], s44 offen sc1
    s_mov_b64 exec, -1
    s_add_u32 s47, s47, 4
    s_cmp_lt_u32 s47, 64
    s_cbranch_scc1 L_att_loop
    s_branch L_end
L_wabort:
    s_mov_b64 exec, 1
    v_mov_b32 v0, 20
    v_mov_b32 v11, 1
    buffer_store_dword v11, v0, s[64:67], 0 offen
L_end:
    s_endpgm
.section .rodata,"a"
.p2align 6
.amdhsa_kernel recurrent_scan__memory_aug_recurrent_mem_tr__glu_gated_swiglu__prompt_kernel
  .amdhsa_next_free_vgpr 512
  .amdhsa_next_free_sgpr 102
  .amdhsa_accum_offset 256
  .amdhsa_group_segment_fixed_size 0
  .amdhsa_kernarg_size 112
  .amdhsa_user_sgpr_count 2
  .amdhsa_user_sgpr_kernarg_segment_ptr 1
  .amdhsa_system_sgpr_workgroup_id_x 1
.end_amdhsa_kernel
```
